```python
import torch

def _softmax(x, axis=-1):
    return torch.softmax(x, dim=axis)

def _gelu(x):
    return torch.nn.functional.gelu(x, approximate='tanh')

def _silu(x):
    return torch.nn.functional.silu(x)

def _sigmoid(x):
    return torch.sigmoid(x)

def _layernorm(x, axis=-1, eps=1e-05):
    m = x.mean(dim=axis, keepdim=True)
    v = x.var(dim=axis, keepdim=True, unbiased=False)
    return (x - m) / torch.sqrt(v + eps)

def _scatter_add(tgt, idx, src, axis=0):
    return tgt.clone().index_add_(axis, idx, src)

def _segment_sum(src, seg, n):
    out = torch.zeros((n,) + src.shape[1:], dtype=src.dtype)
    return out.index_add_(0, seg, src)

def _pad(x, pw):
    flat = tuple((v for pair in reversed(pw) for v in pair))
    return torch.nn.functional.pad(x, flat)
kernel_name = 'adaLN_cond__memory_aug_recurrent_mem_tr__dense_activation_gelu__prompt'

def setup_inputs():

    _w = lambda a: (lambda t: t.to(torch.bfloat16) if t.is_floating_point() else t)(torch.as_tensor(a))

    def _A_setup():
        B, S, Dm = (1, 2048, 640)
        H, Dh = (32, 192)
        M, seg = (8, 32)
        seg = min(seg, S)
        S = S // seg * seg
        return {'x': _w((lambda *s: torch.randn(*s, dtype=torch.bfloat16) * 0.05)(B, S, Dm)), 'mem0': _w((lambda *s: torch.randn(*s, dtype=torch.bfloat16) * 0.8)(B, M, Dm)), 'Wq': _w((lambda *s: torch.randn(*s, dtype=torch.bfloat16) * 1.6)(Dm, H, Dh) * Dm ** (-0.5)), 'Wk': _w((lambda *s: torch.randn(*s, dtype=torch.bfloat16) * 1.6)(Dm, H, Dh) * Dm ** (-0.5)), 'Wv': _w((lambda *s: torch.randn(*s, dtype=torch.bfloat16) * 0.8)(Dm, H, Dh) * Dm ** (-0.5)), 'Wo': _w((lambda *s: torch.randn(*s, dtype=torch.bfloat16) * 0.8)(H, Dh, Dm) * (H * Dh) ** (-0.5)), 'seg_len': seg}
    _A_in = _A_setup()

    def _B_setup():
        B, S, D, F = (1, 2048, 640, 1536)
        return {'x': _w((lambda *s: torch.randn(*s, dtype=torch.bfloat16) * 0.05)(B, S, D)), 'w1': _w((lambda *s: torch.randn(*s, dtype=torch.bfloat16) * 1.6)(D, F) * D ** (-0.5)), 'b1': _w((lambda *s: torch.randn(*s, dtype=torch.bfloat16) * 1.6)(F) * 0.01), 'w2': _w((lambda *s: torch.randn(*s, dtype=torch.bfloat16) * 0.2)(F, D) * F ** (-0.5)), 'b2': _w((lambda *s: torch.randn(*s, dtype=torch.bfloat16) * 0.2)(D) * 0.01)}
    _B_in = _B_setup()
    return {'A_x': _A_in['x'], 'A_mem0': _A_in['mem0'], 'A_Wq': _A_in['Wq'], 'A_Wk': _A_in['Wk'], 'A_Wv': _A_in['Wv'], 'A_Wo': _A_in['Wo'], 'A_seg_len': _A_in['seg_len'], 'B_x': _B_in['x'], 'B_w1': _B_in['w1'], 'B_b1': _B_in['b1'], 'B_w2': _B_in['w2'], 'B_b2': _B_in['b2'], 'c': _w((lambda *s: torch.randn(*s, dtype=torch.bfloat16) * 0.05)(1, 640) * 8.0), 'w_mod': _w((lambda *s: torch.randn(*s, dtype=torch.bfloat16) * 0.05)(640, 6 * 640) * 640 ** (-0.5) * 8.0)}

def reference(A_x, A_mem0, A_Wq, A_Wk, A_Wv, A_Wo, A_seg_len, B_x, B_w1, B_b1, B_w2, B_b2, c, w_mod):

    def _A_ref(x, mem0, Wq, Wk, Wv, Wo, seg_len):
        B, S, Dm = x.shape
        H, Dh = (Wq.shape[1], Wq.shape[2])
        M = mem0.shape[1]
        scale = Dh ** (-0.5)
        n_seg = S // seg_len
        L = M + seg_len
        idx = torch.arange(L)
        mask = (idx[:, None] < M) | (idx[:, None] >= idx[None, :])
        mem = mem0
        outs = []
        for s in range(n_seg):
            xs = x[:, s * seg_len:(s + 1) * seg_len, :].clone()
            h = torch.concatenate([mem, xs], axis=1)
            q = torch.einsum('btd,dhe->bhte', h, Wq)
            k = torch.einsum('btd,dhe->bhte', h, Wk)
            v = torch.einsum('btd,dhe->bhte', h, Wv)
            scores = torch.einsum('bhqe,bhke->bhqk', q, k) * scale
            scores = torch.where(mask[None, None], scores, -1000000000.0)
            p = _softmax(scores, axis=-1)
            o = torch.einsum('bhqk,bhke->bhqe', p, v)
            o = torch.einsum('bhte,hed->btd', o, Wo)
            mem = o[:, :M, :].clone()
            outs.append(o[:, M:, :])
        return torch.concatenate(outs, axis=1)

    def _B_ref(x, w1, b1, w2, b2):
        h = torch.einsum('bsd,df->bsf', x, w1) + b1
        h = _gelu(h)
        return torch.einsum('bsf,fd->bsd', h, w2) + b2
    x = A_x
    mod = (_silu(c) @ w_mod).reshape(c.shape[0], 6, 1, -1)
    sa, ca, ga, sb, cb, gb = (mod[:, 0].clone(), mod[:, 1].clone(), mod[:, 2].clone(), mod[:, 3].clone(), mod[:, 4].clone(), mod[:, 5].clone())
    h = _layernorm(x, axis=-1) * (1 + ca) + sa
    x = x + ga * _A_ref(h, A_mem0, A_Wq, A_Wk, A_Wv, A_Wo, A_seg_len)
    h = _layernorm(x, axis=-1) * (1 + cb) + sb
    x = x + gb * _B_ref(h, B_w1, B_b1, B_w2, B_b2)
    return x
```

```asm
; @launch grid=(256,1,1) block=(512,1,1) lds=147712
.amdgcn_target "amdgcn-amd-amdhsa--gfx950"
.text
.globl adaLN_cond__memory_aug_recurrent_mem_tr__dense_activation_gelu__prompt_kernel
.p2align 8
.type adaLN_cond__memory_aug_recurrent_mem_tr__dense_activation_gelu__prompt_kernel,@function
adaLN_cond__memory_aug_recurrent_mem_tr__dense_activation_gelu__prompt_kernel:
    s_cmp_ge_u32 s2, 256
    s_cbranch_scc1 LM_end
    s_load_dwordx2 s[4:5], s[0:1], 128
    s_load_dwordx2 s[22:23], s[0:1], 120
    s_getreg_b32 s17, hwreg(HW_REG_XCC_ID, 0, 4)
    v_lshrrev_b32 v1, 6, v0
    s_mov_b32 s6, 268435456
    v_readfirstlane_b32 s16, v1
    v_mov_b32 v89, v0
    v_and_b32 v0, 63, v0
    s_mov_b32 s7, 0x20000
    s_and_b32 s17, s17, 7
    s_mov_b32 s38, 131072
    s_mov_b32 s37, 0
    s_mov_b32 s19, 0
    s_getreg_b32 s24, hwreg(HW_REG_HW_ID, 4, 2)
    v_mov_b32 v4, 147616
    v_mov_b32 v8, 0
    v_mov_b32 v9, 0
    v_mov_b32 v10, 0
    v_mov_b32 v11, 0
    ds_write_b128 v4, v[8:11]
    s_lshl_b32 s25, s24, 2
    v_add_u32 v5, s25, v4
    v_mov_b32 v6, 1
    s_waitcnt lgkmcnt(0)
    s_barrier
    s_mov_b64 exec, 1
    ds_add_rtn_u32 v7, v5, v6
    s_waitcnt lgkmcnt(0)
    s_mov_b64 exec, -1
    v_readfirstlane_b32 s25, v7
    s_barrier
    ds_read_b128 v[8:11], v4
    s_lshl_b32 s25, s25, 2
    s_add_u32 s25, s25, s24
    s_waitcnt lgkmcnt(0)
    v_max3_u32 v8, v8, v9, v10
    v_max_u32 v8, v8, v11
    s_nop 0
    v_readfirstlane_b32 s26, v8
    s_cmp_eq_u32 s26, 2
    s_cselect_b32 s16, s25, s16
    s_and_b32 s16, s16, 7
    s_lshl_b32 s25, s16, 6
    v_add_u32 v89, s25, v0
    s_waitcnt lgkmcnt(0)
    v_mov_b32 v90, 1
    s_lshl_b32 s21, s17, 5
    v_mov_b32 v91, s21
    s_cmp_lg_u32 s16, 0
    s_cbranch_scc1 LM_notick0
    s_mov_b64 exec, 1
    global_atomic_add v92, v91, v90, s[22:23] sc0 sc1
    s_mov_b64 exec, -1
LM_notick0:
    s_load_dwordx2 s[8:9], s[0:1], 8
    s_mov_b32 s10, 10240
    s_mov_b32 s11, 0x20000
    s_waitcnt lgkmcnt(0)
    s_lshl_b32 s24, s16, 8
    s_add_u32 s24, s24, s2
    s_lshl_b32 s25, s24, 10
    s_add_u32 s25, s25, 81920
    s_cmp_ge_u32 s24, 1582
    s_cselect_b32 s25, 268435456, s25
    s_sub_u32 s28, 2047, s24
    s_lshl_b32 s26, s28, 10
    s_add_u32 s26, s26, 10485760
    s_cmp_ge_u32 s28, 640
    s_cselect_b32 s28, 268435456, s26
    v_mov_b32 v12, -1
    v_mov_b32 v13, -1
    v_mov_b32 v14, -1
    v_mov_b32 v15, -1
    s_cmp_ge_u32 s24, 1006
    s_cselect_b32 s26, -1, 0
    v_mov_b32 v8, s26
    v_mov_b32 v9, s26
    v_mov_b32 v10, s26
    v_mov_b32 v11, s26
    v_lshlrev_b32 v5, 4, v0
    buffer_store_dwordx4 v[12:15], v5, s[4:7], s28 offen sc1
    s_sub_u32 s26, s24, 1262
    s_cmp_ge_u32 s26, 80
    s_cbranch_scc1 LM_nom0
    s_mul_i32 s27, s26, 205
    s_lshr_b32 s27, s27, 11
    s_mul_i32 s27, s27, 10
    s_sub_u32 s27, s26, s27
    s_lshl_b32 s27, s27, 7
    v_bfe_u32 v6, v0, 2, 2
    v_and_b32 v7, 1, v0
    v_lshl_add_u32 v6, v6, 1, v7
    v_mul_u32_u24 v6, 1280, v6
    v_lshrrev_b32 v7, 4, v0
    v_lshl_add_u32 v6, v7, 5, v6
    v_bfe_u32 v7, v0, 1, 1
    v_lshl_add_u32 v6, v7, 4, v6
    buffer_load_dwordx4 v[8:11], v6, s[8:11], s27 offen
    s_waitcnt vmcnt(0)
    v_min_u32 v8, -2, v8
    v_min_u32 v9, -2, v9
    v_min_u32 v10, -2, v10
    v_min_u32 v11, -2, v11
LM_nom0:
    buffer_store_dwordx4 v[8:11], v5, s[4:7], s25 offen sc1
    s_cmp_lt_u32 s16, 4
    s_cselect_b32 s29, 32, 40
    s_load_dwordx2 s[12:13], s[0:1], s29
    s_mov_b32 s14, 7864320
    s_mov_b32 s15, 0x20000
    v_and_b32 v80, 255, v89
    v_min_u32 v80, 239, v80
    v_mul_u32_u24 v81, 5462, v80
    v_lshrrev_b32 v81, 16, v81
    v_mul_u32_u24 v82, 10752, v81
    s_lshr_b32 s30, s2, 3
    s_cmp_lt_u32 s16, 4
    s_cbranch_scc1 LM_wv
    v_mov_b32 v82, 0
    s_mul_i32 s30, s30, 30720
    s_mul_i32 s29, s17, 983040
    s_branch LM_wj
LM_wv:
    s_mul_i32 s30, s30, 245760
    s_mul_i32 s29, s17, 1536
LM_wj:
    s_add_u32 s30, s30, s29
    v_lshl_add_u32 v82, v80, 7, v82
    s_waitcnt lgkmcnt(0)
    s_barrier
    buffer_load_dword v83, v82, s[12:15], s30 offen
    s_waitcnt vmcnt(1)
    s_cmp_lg_u32 s16, 0
    s_cbranch_scc1 LM_notick
    v_readfirstlane_b32 s18, v92
    v_mov_b32 v2, 1
    s_and_b32 s18, s18, 0xffff
    s_cmp_lt_u32 s18, 32
    s_cbranch_scc1 LM_haverole
    v_mov_b32 v3, 8
    s_mov_b64 exec, 1
    global_atomic_add v4, v3, v2, s[22:23] sc0 sc1
    s_waitcnt vmcnt(0)
    v_readfirstlane_b32 s32, v4
    s_mov_b64 exec, -1
    v_and_b32 v6, 7, v0
    v_lshlrev_b32 v6, 5, v6
    s_mov_b32 s37, s38
L_pc_1:
    global_load_dword v7, v6, s[22:23] sc1
    s_waitcnt vmcnt(0)
    v_readlane_b32 s24, v7, 0
    v_readlane_b32 s25, v7, 1
    v_readlane_b32 s26, v7, 2
    v_readlane_b32 s27, v7, 3
    v_readlane_b32 s28, v7, 4
    v_readlane_b32 s29, v7, 5
    v_readlane_b32 s30, v7, 6
    v_readlane_b32 s31, v7, 7
    s_add_u32 s21, s24, s25
    s_add_u32 s21, s21, s26
    s_add_u32 s21, s21, s27
    s_add_u32 s21, s21, s28
    s_add_u32 s21, s21, s29
    s_add_u32 s21, s21, s30
    s_add_u32 s21, s21, s31
    s_and_b32 s21, s21, 0xffff
    s_cmp_ge_u32 s21, 256
    s_cbranch_scc1 L_pcd_2
    s_sub_u32 s37, s37, 1
    s_cbranch_scc1 L_pcd_2
    s_sleep 8
    s_branch L_pc_1
L_pcd_2:
    s_and_b32 s24, s24, 0xffff
    s_and_b32 s25, s25, 0xffff
    s_and_b32 s26, s26, 0xffff
    s_and_b32 s27, s27, 0xffff
    s_and_b32 s28, s28, 0xffff
    s_and_b32 s29, s29, 0xffff
    s_and_b32 s30, s30, 0xffff
    s_and_b32 s31, s31, 0xffff
    s_mov_b32 s17, 0
    s_mov_b32 s18, 0
    s_min_u32 s21, s24, 32
    s_sub_u32 s33, 32, s21
    s_cmp_ge_u32 s32, s33
    s_cbranch_scc1 L_nx_3
    s_mov_b32 s17, 0
    s_add_u32 s18, s21, s32
    s_branch LM_haverole
L_nx_3:
    s_sub_u32 s32, s32, s33
    s_min_u32 s21, s25, 32
    s_sub_u32 s33, 32, s21
    s_cmp_ge_u32 s32, s33
    s_cbranch_scc1 L_nx_4
    s_mov_b32 s17, 1
    s_add_u32 s18, s21, s32
    s_branch LM_haverole
L_nx_4:
    s_sub_u32 s32, s32, s33
    s_min_u32 s21, s26, 32
    s_sub_u32 s33, 32, s21
    s_cmp_ge_u32 s32, s33
    s_cbranch_scc1 L_nx_5
    s_mov_b32 s17, 2
    s_add_u32 s18, s21, s32
    s_branch LM_haverole
L_nx_5:
    s_sub_u32 s32, s32, s33
    s_min_u32 s21, s27, 32
    s_sub_u32 s33, 32, s21
    s_cmp_ge_u32 s32, s33
    s_cbranch_scc1 L_nx_6
    s_mov_b32 s17, 3
    s_add_u32 s18, s21, s32
    s_branch LM_haverole
L_nx_6:
    s_sub_u32 s32, s32, s33
    s_min_u32 s21, s28, 32
    s_sub_u32 s33, 32, s21
    s_cmp_ge_u32 s32, s33
    s_cbranch_scc1 L_nx_7
    s_mov_b32 s17, 4
    s_add_u32 s18, s21, s32
    s_branch LM_haverole
L_nx_7:
    s_sub_u32 s32, s32, s33
    s_min_u32 s21, s29, 32
    s_sub_u32 s33, 32, s21
    s_cmp_ge_u32 s32, s33
    s_cbranch_scc1 L_nx_8
    s_mov_b32 s17, 5
    s_add_u32 s18, s21, s32
    s_branch LM_haverole
L_nx_8:
    s_sub_u32 s32, s32, s33
    s_min_u32 s21, s30, 32
    s_sub_u32 s33, 32, s21
    s_cmp_ge_u32 s32, s33
    s_cbranch_scc1 L_nx_9
    s_mov_b32 s17, 6
    s_add_u32 s18, s21, s32
    s_branch LM_haverole
L_nx_9:
    s_sub_u32 s32, s32, s33
    s_min_u32 s21, s31, 32
    s_sub_u32 s33, 32, s21
    s_cmp_ge_u32 s32, s33
    s_cbranch_scc1 L_nx_10
    s_mov_b32 s17, 7
    s_add_u32 s18, s21, s32
    s_branch LM_haverole
L_nx_10:
    s_sub_u32 s32, s32, s33
LM_haverole:
    v_mov_b32 v5, 147456
    v_mov_b32 v6, s17
    v_mov_b32 v7, s18
    ds_write_b64 v5, v[6:7]
    v_mov_b32 v6, 0
    v_lshl_add_u32 v5, v0, 2, v5
    s_mov_b32 exec_hi, 0
    ds_write_b32 v5, v6 offset:16
    s_mov_b64 exec, -1
    s_waitcnt lgkmcnt(0)
LM_notick:
    s_barrier
    s_cmp_lg_u32 s16, 0
    s_cbranch_scc1 LM_noarm
    v_mov_b32 v90, 0x10000
    s_mov_b64 exec, 1
    global_atomic_add v91, v90, s[22:23] sc1
    s_mov_b64 exec, -1
LM_noarm:
    v_mov_b32 v5, 147456
    ds_read_b64 v[6:7], v5
    s_waitcnt lgkmcnt(0)
    v_readfirstlane_b32 s17, v6
    v_readfirstlane_b32 s18, v7
    s_nop 1
    s_and_b32 s17, s17, 7
    s_and_b32 s18, s18, 31
    v_lshrrev_b32 v1, 4, v0
    v_and_b32 v2, 15, v0
    v_and_b32 v3, 7, v0
    v_bfe_u32 v4, v0, 3, 1
    v_lshlrev_b32 v5, 4, v0
    s_cmp_lt_u32 s18, 20
    s_cbranch_scc1 LM_VO
    s_sub_u32 s21, s18, 20
    s_mul_i32 s24, s21, 11
    s_lshr_b32 s24, s24, 5
    s_mul_i32 s25, s24, 3
    s_sub_u32 s42, s21, s25
    s_lshl_b32 s41, s17, 2
    s_add_u32 s41, s41, s24
    v_lshrrev_b32 v8, 3, v0
    s_mul_i32 s21, s16, 80
    v_add_u32 v8, s21, v8
    s_mov_b32 s21, 12288
    v_mul_lo_u32 v8, v8, s21
    s_mul_i32 s24, s41, 384
    s_lshl_b32 s25, s42, 7
    s_add_u32 s24, s24, s25
    v_lshl_add_u32 v8, v3, 4, v8
    v_add_u32 v8, s24, v8
    v_lshrrev_b32 v6, 1, v1
    v_lshlrev_b32 v9, 4, v6
    v_and_b32 v6, 1, v1
    v_lshl_add_u32 v9, v6, 2, v9
    v_bfe_u32 v6, v0, 2, 1
    v_add_u32 v9, v9, v6
    v_lshl_add_u32 v9, v4, 3, v9
    v_lshlrev_b32 v9, 7, v9
    v_and_b32 v6, 3, v0
    v_lshl_add_u32 v9, v6, 3, v9
    s_lshl_b32 s21, s16, 5
    v_add_u32 v9, s21, v9
    v_add_u32 v10, 40960, v9
    s_load_dwordx2 s[8:9], s[0:1], 104
    s_mov_b32 s10, 4915200
    s_mov_b32 s11, 0x20000
    s_waitcnt lgkmcnt(0)
    s_load_dwordx2 s[12:13], s[0:1], 96
    s_mov_b32 s14, 1280
    s_mov_b32 s15, 0x20000
    s_waitcnt lgkmcnt(0)
    s_mul_i32 s46, s17, 12
    s_add_u32 s46, s46, s18
    s_sub_u32 s46, s46, 20
    v_lshrrev_b32 v11, 3, v89
    v_mul_u32_u24 v12, 7680, v11
    v_lshl_add_u32 v12, v3, 4, v12
    v_lshlrev_b32 v11, 1, v11
    s_lshl_b32 s24, s46, 7
    s_cmp_lt_u32 s46, 60
    s_cselect_b32 s24, s24, 4915200
    buffer_load_dwordx4 v[16:19], v12, s[8:11], s24 offen
    buffer_load_ushort v56, v11, s[12:15], 0 offen offset:0
    s_add_u32 s24, s24, 491520
    buffer_load_dwordx4 v[20:23], v12, s[8:11], s24 offen
    buffer_load_ushort v57, v11, s[12:15], 0 offen offset:128
    s_add_u32 s24, s24, 491520
    buffer_load_dwordx4 v[24:27], v12, s[8:11], s24 offen
    buffer_load_ushort v58, v11, s[12:15], 0 offen offset:256
    s_add_u32 s24, s24, 491520
    buffer_load_dwordx4 v[28:31], v12, s[8:11], s24 offen
    buffer_load_ushort v59, v11, s[12:15], 0 offen offset:384
    s_add_u32 s24, s24, 491520
    buffer_load_dwordx4 v[32:35], v12, s[8:11], s24 offen
    buffer_load_ushort v60, v11, s[12:15], 0 offen offset:512
    s_add_u32 s24, s24, 491520
    buffer_load_dwordx4 v[36:39], v12, s[8:11], s24 offen
    buffer_load_ushort v61, v11, s[12:15], 0 offen offset:640
    s_add_u32 s24, s24, 491520
    buffer_load_dwordx4 v[40:43], v12, s[8:11], s24 offen
    buffer_load_ushort v62, v11, s[12:15], 0 offen offset:768
    s_add_u32 s24, s24, 491520
    buffer_load_dwordx4 v[44:47], v12, s[8:11], s24 offen
    buffer_load_ushort v63, v11, s[12:15], 0 offen offset:896
    s_add_u32 s24, s24, 491520
    buffer_load_dwordx4 v[48:51], v12, s[8:11], s24 offen
    buffer_load_ushort v64, v11, s[12:15], 0 offen offset:1024
    s_add_u32 s24, s24, 491520
    buffer_load_dwordx4 v[52:55], v12, s[8:11], s24 offen
    buffer_load_ushort v65, v11, s[12:15], 0 offen offset:1152
    s_load_dwordx2 s[12:13], s[0:1], 0
    s_mov_b32 s14, 2621440
    s_mov_b32 s15, 0x20000
    s_waitcnt lgkmcnt(0)
    v_mov_b32 v13, 0x40000000
    v_cmp_gt_u32 s[48:49], 40, v0
    v_lshlrev_b32 v14, 5, v0
    s_lshl_b32 s24, s46, 3
    s_add_u32 s24, s24, s16
    s_mul_i32 s24, s24, 1280
    v_cndmask_b32 v14, v13, v14, s[48:49]
    buffer_load_dwordx4 v[176:179], v14, s[12:15], s24 offen
    buffer_load_dwordx4 v[180:183], v14, s[12:15], s24 offen offset:16
    s_add_u32 s24, s24, 983040
    buffer_load_dwordx4 v[184:187], v14, s[12:15], s24 offen
    buffer_load_dwordx4 v[188:191], v14, s[12:15], s24 offen offset:16
    s_add_u32 s24, s24, 983040
    buffer_load_dwordx4 v[192:195], v14, s[12:15], s24 offen
    buffer_load_dwordx4 v[196:199], v14, s[12:15], s24 offen offset:16
    s_load_dwordx2 s[8:9], s[0:1], 16
    s_mov_b32 s10, 7864320
    s_mov_b32 s11, 0x20000
    s_waitcnt lgkmcnt(0)
    s_mul_i32 s24, s16, 10240
    s_mov_b32 s25, 0
L_stg_11:
    s_mov_b32 m0, s24
    s_add_u32 s24, s24, 1024
    buffer_load_dwordx4 v8, s[8:11], s25 offen lds
    s_add_u32 s25, s25, 98304
    s_cmp_lt_u32 s25, 983040
    s_cbranch_scc1 L_stg_11
    s_waitcnt vmcnt(16)
    v_lshlrev_b32 v56, 16, v56
    v_mul_f32 v66, 0xbfb8aa3b, v56
    v_lshlrev_b32 v57, 16, v57
    v_mul_f32 v67, 0xbfb8aa3b, v57
    v_lshlrev_b32 v58, 16, v58
    v_mul_f32 v68, 0xbfb8aa3b, v58
    v_lshlrev_b32 v59, 16, v59
    v_mul_f32 v69, 0xbfb8aa3b, v59
    v_lshlrev_b32 v60, 16, v60
    v_mul_f32 v70, 0xbfb8aa3b, v60
    v_lshlrev_b32 v61, 16, v61
    v_mul_f32 v71, 0xbfb8aa3b, v61
    v_lshlrev_b32 v62, 16, v62
    v_mul_f32 v72, 0xbfb8aa3b, v62
    v_lshlrev_b32 v63, 16, v63
    v_mul_f32 v73, 0xbfb8aa3b, v63
    v_lshlrev_b32 v64, 16, v64
    v_mul_f32 v74, 0xbfb8aa3b, v64
    v_lshlrev_b32 v65, 16, v65
    v_mul_f32 v75, 0xbfb8aa3b, v65
    v_exp_f32 v66, v66
    v_exp_f32 v67, v67
    v_exp_f32 v68, v68
    v_exp_f32 v69, v69
    v_exp_f32 v70, v70
    v_exp_f32 v71, v71
    v_exp_f32 v72, v72
    v_exp_f32 v73, v73
    v_exp_f32 v74, v74
    v_exp_f32 v75, v75
    v_add_f32 v66, 1.0, v66
    v_add_f32 v67, 1.0, v67
    v_add_f32 v68, 1.0, v68
    v_add_f32 v69, 1.0, v69
    v_add_f32 v70, 1.0, v70
    v_add_f32 v71, 1.0, v71
    v_add_f32 v72, 1.0, v72
    v_add_f32 v73, 1.0, v73
    v_add_f32 v74, 1.0, v74
    v_add_f32 v75, 1.0, v75
    v_rcp_f32 v66, v66
    v_rcp_f32 v67, v67
    v_rcp_f32 v68, v68
    v_rcp_f32 v69, v69
    v_rcp_f32 v70, v70
    v_rcp_f32 v71, v71
    v_rcp_f32 v72, v72
    v_rcp_f32 v73, v73
    v_rcp_f32 v74, v74
    v_rcp_f32 v75, v75
    v_mul_f32 v56, v56, v66
    v_mul_f32 v57, v57, v67
    v_mul_f32 v58, v58, v68
    v_mul_f32 v59, v59, v69
    v_mul_f32 v60, v60, v70
    v_mul_f32 v61, v61, v71
    v_mul_f32 v62, v62, v72
    v_mul_f32 v63, v63, v73
    v_mul_f32 v64, v64, v74
    v_mul_f32 v65, v65, v75
    v_cvt_pk_bf16_f32 v56, v56, v56
    v_lshlrev_b32 v56, 16, v56
    v_cvt_pk_bf16_f32 v57, v57, v57
    v_lshlrev_b32 v57, 16, v57
    v_cvt_pk_bf16_f32 v58, v58, v58
    v_lshlrev_b32 v58, 16, v58
    v_cvt_pk_bf16_f32 v59, v59, v59
    v_lshlrev_b32 v59, 16, v59
    v_cvt_pk_bf16_f32 v60, v60, v60
    v_lshlrev_b32 v60, 16, v60
    v_cvt_pk_bf16_f32 v61, v61, v61
    v_lshlrev_b32 v61, 16, v61
    v_cvt_pk_bf16_f32 v62, v62, v62
    v_lshlrev_b32 v62, 16, v62
    v_cvt_pk_bf16_f32 v63, v63, v63
    v_lshlrev_b32 v63, 16, v63
    v_cvt_pk_bf16_f32 v64, v64, v64
    v_lshlrev_b32 v64, 16, v64
    v_cvt_pk_bf16_f32 v65, v65, v65
    v_lshlrev_b32 v65, 16, v65
    v_lshlrev_b32 v66, 16, v16
    v_and_b32 v67, 0xffff0000, v16
    v_mul_f32 v76, v66, v56
    v_mul_f32 v77, v67, v56
    v_lshlrev_b32 v66, 16, v17
    v_and_b32 v67, 0xffff0000, v17
    v_mul_f32 v78, v66, v56
    v_mul_f32 v79, v67, v56
    v_lshlrev_b32 v66, 16, v18
    v_and_b32 v67, 0xffff0000, v18
    v_mul_f32 v80, v66, v56
    v_mul_f32 v81, v67, v56
    v_lshlrev_b32 v66, 16, v19
    v_and_b32 v67, 0xffff0000, v19
    v_mul_f32 v82, v66, v56
    v_mul_f32 v83, v67, v56
    v_lshlrev_b32 v66, 16, v20
    v_and_b32 v67, 0xffff0000, v20
    v_fmac_f32 v76, v66, v57
    v_fmac_f32 v77, v67, v57
    v_lshlrev_b32 v66, 16, v21
    v_and_b32 v67, 0xffff0000, v21
    v_fmac_f32 v78, v66, v57
    v_fmac_f32 v79, v67, v57
    v_lshlrev_b32 v66, 16, v22
    v_and_b32 v67, 0xffff0000, v22
    v_fmac_f32 v80, v66, v57
    v_fmac_f32 v81, v67, v57
    v_lshlrev_b32 v66, 16, v23
    v_and_b32 v67, 0xffff0000, v23
    v_fmac_f32 v82, v66, v57
    v_fmac_f32 v83, v67, v57
    v_lshlrev_b32 v66, 16, v24
    v_and_b32 v67, 0xffff0000, v24
    v_fmac_f32 v76, v66, v58
    v_fmac_f32 v77, v67, v58
    v_lshlrev_b32 v66, 16, v25
    v_and_b32 v67, 0xffff0000, v25
    v_fmac_f32 v78, v66, v58
    v_fmac_f32 v79, v67, v58
    v_lshlrev_b32 v66, 16, v26
    v_and_b32 v67, 0xffff0000, v26
    v_fmac_f32 v80, v66, v58
    v_fmac_f32 v81, v67, v58
    v_lshlrev_b32 v66, 16, v27
    v_and_b32 v67, 0xffff0000, v27
    v_fmac_f32 v82, v66, v58
    v_fmac_f32 v83, v67, v58
    v_lshlrev_b32 v66, 16, v28
    v_and_b32 v67, 0xffff0000, v28
    v_fmac_f32 v76, v66, v59
    v_fmac_f32 v77, v67, v59
    v_lshlrev_b32 v66, 16, v29
    v_and_b32 v67, 0xffff0000, v29
    v_fmac_f32 v78, v66, v59
    v_fmac_f32 v79, v67, v59
    v_lshlrev_b32 v66, 16, v30
    v_and_b32 v67, 0xffff0000, v30
    v_fmac_f32 v80, v66, v59
    v_fmac_f32 v81, v67, v59
    v_lshlrev_b32 v66, 16, v31
    v_and_b32 v67, 0xffff0000, v31
    v_fmac_f32 v82, v66, v59
    v_fmac_f32 v83, v67, v59
    v_lshlrev_b32 v66, 16, v32
    v_and_b32 v67, 0xffff0000, v32
    v_fmac_f32 v76, v66, v60
    v_fmac_f32 v77, v67, v60
    v_lshlrev_b32 v66, 16, v33
    v_and_b32 v67, 0xffff0000, v33
    v_fmac_f32 v78, v66, v60
    v_fmac_f32 v79, v67, v60
    v_lshlrev_b32 v66, 16, v34
    v_and_b32 v67, 0xffff0000, v34
    v_fmac_f32 v80, v66, v60
    v_fmac_f32 v81, v67, v60
    v_lshlrev_b32 v66, 16, v35
    v_and_b32 v67, 0xffff0000, v35
    v_fmac_f32 v82, v66, v60
    v_fmac_f32 v83, v67, v60
    v_lshlrev_b32 v66, 16, v36
    v_and_b32 v67, 0xffff0000, v36
    v_fmac_f32 v76, v66, v61
    v_fmac_f32 v77, v67, v61
    v_lshlrev_b32 v66, 16, v37
    v_and_b32 v67, 0xffff0000, v37
    v_fmac_f32 v78, v66, v61
    v_fmac_f32 v79, v67, v61
    v_lshlrev_b32 v66, 16, v38
    v_and_b32 v67, 0xffff0000, v38
    v_fmac_f32 v80, v66, v61
    v_fmac_f32 v81, v67, v61
    v_lshlrev_b32 v66, 16, v39
    v_and_b32 v67, 0xffff0000, v39
    v_fmac_f32 v82, v66, v61
    v_fmac_f32 v83, v67, v61
    v_lshlrev_b32 v66, 16, v40
    v_and_b32 v67, 0xffff0000, v40
    v_fmac_f32 v76, v66, v62
    v_fmac_f32 v77, v67, v62
    v_lshlrev_b32 v66, 16, v41
    v_and_b32 v67, 0xffff0000, v41
    v_fmac_f32 v78, v66, v62
    v_fmac_f32 v79, v67, v62
    v_lshlrev_b32 v66, 16, v42
    v_and_b32 v67, 0xffff0000, v42
    v_fmac_f32 v80, v66, v62
    v_fmac_f32 v81, v67, v62
    v_lshlrev_b32 v66, 16, v43
    v_and_b32 v67, 0xffff0000, v43
    v_fmac_f32 v82, v66, v62
    v_fmac_f32 v83, v67, v62
    v_lshlrev_b32 v66, 16, v44
    v_and_b32 v67, 0xffff0000, v44
    v_fmac_f32 v76, v66, v63
    v_fmac_f32 v77, v67, v63
    v_lshlrev_b32 v66, 16, v45
    v_and_b32 v67, 0xffff0000, v45
    v_fmac_f32 v78, v66, v63
    v_fmac_f32 v79, v67, v63
    v_lshlrev_b32 v66, 16, v46
    v_and_b32 v67, 0xffff0000, v46
    v_fmac_f32 v80, v66, v63
    v_fmac_f32 v81, v67, v63
    v_lshlrev_b32 v66, 16, v47
    v_and_b32 v67, 0xffff0000, v47
    v_fmac_f32 v82, v66, v63
    v_fmac_f32 v83, v67, v63
    v_lshlrev_b32 v66, 16, v48
    v_and_b32 v67, 0xffff0000, v48
    v_fmac_f32 v76, v66, v64
    v_fmac_f32 v77, v67, v64
    v_lshlrev_b32 v66, 16, v49
    v_and_b32 v67, 0xffff0000, v49
    v_fmac_f32 v78, v66, v64
    v_fmac_f32 v79, v67, v64
    v_lshlrev_b32 v66, 16, v50
    v_and_b32 v67, 0xffff0000, v50
    v_fmac_f32 v80, v66, v64
    v_fmac_f32 v81, v67, v64
    v_lshlrev_b32 v66, 16, v51
    v_and_b32 v67, 0xffff0000, v51
    v_fmac_f32 v82, v66, v64
    v_fmac_f32 v83, v67, v64
    v_lshlrev_b32 v66, 16, v52
    v_and_b32 v67, 0xffff0000, v52
    v_fmac_f32 v76, v66, v65
    v_fmac_f32 v77, v67, v65
    v_lshlrev_b32 v66, 16, v53
    v_and_b32 v67, 0xffff0000, v53
    v_fmac_f32 v78, v66, v65
    v_fmac_f32 v79, v67, v65
    v_lshlrev_b32 v66, 16, v54
    v_and_b32 v67, 0xffff0000, v54
    v_fmac_f32 v80, v66, v65
    v_fmac_f32 v81, v67, v65
    v_lshlrev_b32 v66, 16, v55
    v_and_b32 v67, 0xffff0000, v55
    v_fmac_f32 v82, v66, v65
    v_fmac_f32 v83, v67, v65
    v_add_f32_dpp v76, v76, v76 row_ror:8 row_mask:0xf bank_mask:0xf
    v_add_f32_dpp v77, v77, v77 row_ror:8 row_mask:0xf bank_mask:0xf
    v_add_f32_dpp v78, v78, v78 row_ror:8 row_mask:0xf bank_mask:0xf
    v_add_f32_dpp v79, v79, v79 row_ror:8 row_mask:0xf bank_mask:0xf
    v_add_f32_dpp v80, v80, v80 row_ror:8 row_mask:0xf bank_mask:0xf
    v_add_f32_dpp v81, v81, v81 row_ror:8 row_mask:0xf bank_mask:0xf
    v_add_f32_dpp v82, v82, v82 row_ror:8 row_mask:0xf bank_mask:0xf
    v_add_f32_dpp v83, v83, v83 row_ror:8 row_mask:0xf bank_mask:0xf
    v_lshlrev_b32 v12, 5, v3
    v_lshl_add_u32 v12, v1, 8, v12
    s_lshl_b32 s21, s16, 10
    s_add_u32 s21, s21, 81920
    v_add_u32 v12, s21, v12
    ds_write_b128 v12, v[76:79]
    ds_write_b128 v12, v[80:83] offset:16
    s_waitcnt lgkmcnt(0)
    s_barrier
    s_cmp_eq_u32 s16, 7
    s_cbranch_scc1 LQ_mode
    s_cmp_lg_u32 s16, 4
    s_cbranch_scc1 LQ_mj
    v_lshlrev_b32 v12, 2, v0
    v_add_u32 v11, 81920, v12
    ds_read_b32 v16, v11 offset:0
    ds_read_b32 v17, v11 offset:256
    ds_read_b32 v18, v11 offset:512
    ds_read_b32 v19, v11 offset:768
    ds_read_b32 v20, v11 offset:1024
    ds_read_b32 v21, v11 offset:1280
    ds_read_b32 v22, v11 offset:1536
    ds_read_b32 v23, v11 offset:1792
    ds_read_b32 v24, v11 offset:2048
    ds_read_b32 v25, v11 offset:2304
    ds_read_b32 v26, v11 offset:2560
    ds_read_b32 v27, v11 offset:2816
    ds_read_b32 v28, v11 offset:3072
    ds_read_b32 v29, v11 offset:3328
    ds_read_b32 v30, v11 offset:3584
    ds_read_b32 v31, v11 offset:3840
    ds_read_b32 v32, v11 offset:4096
    ds_read_b32 v33, v11 offset:4352
    ds_read_b32 v34, v11 offset:4608
    ds_read_b32 v35, v11 offset:4864
    ds_read_b32 v36, v11 offset:5120
    ds_read_b32 v37, v11 offset:5376
    ds_read_b32 v38, v11 offset:5632
    ds_read_b32 v39, v11 offset:5888
    ds_read_b32 v40, v11 offset:6144
    ds_read_b32 v41, v11 offset:6400
    ds_read_b32 v42, v11 offset:6656
    ds_read_b32 v43, v11 offset:6912
    ds_read_b32 v44, v11 offset:7168
    ds_read_b32 v45, v11 offset:7424
    ds_read_b32 v46, v11 offset:7680
    ds_read_b32 v47, v11 offset:7936
    s_waitcnt lgkmcnt(0)
    v_pk_add_f32 v[16:17], v[16:17], v[32:33]
    v_pk_add_f32 v[18:19], v[18:19], v[34:35]
    v_pk_add_f32 v[20:21], v[20:21], v[36:37]
    v_pk_add_f32 v[22:23], v[22:23], v[38:39]
    v_pk_add_f32 v[24:25], v[24:25], v[40:41]
    v_pk_add_f32 v[26:27], v[26:27], v[42:43]
    v_pk_add_f32 v[28:29], v[28:29], v[44:45]
    v_pk_add_f32 v[30:31], v[30:31], v[46:47]
    v_pk_add_f32 v[16:17], v[16:17], v[24:25]
    v_pk_add_f32 v[18:19], v[18:19], v[26:27]
    v_pk_add_f32 v[20:21], v[20:21], v[28:29]
    v_pk_add_f32 v[22:23], v[22:23], v[30:31]
    v_pk_add_f32 v[16:17], v[16:17], v[20:21]
    v_pk_add_f32 v[18:19], v[18:19], v[22:23]
    v_pk_add_f32 v[16:17], v[16:17], v[18:19]
    v_add_f32 v16, v16, v17
    v_cvt_pk_bf16_f32 v16, v16, v16
    v_lshlrev_b32 v16, 16, v16
    s_lshl_b32 s24, s46, 8
    s_add_u32 s24, s24, 0
    s_cmp_lt_u32 s46, 60
    s_cselect_b32 s24, s24, 268435456
    buffer_store_dword v16, v12, s[4:7], s24 offen sc1
    s_branch LQ_mj
LQ_mode:
    v_and_b32 v6, 7, v0
    v_lshlrev_b32 v6, 5, v6
    s_mov_b32 s37, s38
L_pc_12:
    global_load_dword v7, v6, s[22:23] sc1
    s_waitcnt vmcnt(0)
    v_readlane_b32 s24, v7, 0
    v_readlane_b32 s25, v7, 1
    v_readlane_b32 s26, v7, 2
    v_readlane_b32 s27, v7, 3
    v_readlane_b32 s28, v7, 4
    v_readlane_b32 s29, v7, 5
    v_readlane_b32 s30, v7, 6
    v_readlane_b32 s31, v7, 7
    s_add_u32 s21, s24, s25
    s_add_u32 s21, s21, s26
    s_add_u32 s21, s21, s27
    s_add_u32 s21, s21, s28
    s_add_u32 s21, s21, s29
    s_add_u32 s21, s21, s30
    s_add_u32 s21, s21, s31
    s_lshr_b32 s21, s21, 16
    s_cmp_ge_u32 s21, 256
    s_cbranch_scc1 L_pcd_13
    s_sub_u32 s37, s37, 1
    s_cbranch_scc1 L_pcd_13
    s_sleep 8
    s_branch L_pc_12
L_pcd_13:
    s_and_b32 s24, s24, 0xffff
    s_and_b32 s25, s25, 0xffff
    s_and_b32 s26, s26, 0xffff
    s_and_b32 s27, s27, 0xffff
    s_and_b32 s28, s28, 0xffff
    s_and_b32 s29, s29, 0xffff
    s_and_b32 s30, s30, 0xffff
    s_and_b32 s31, s31, 0xffff
    s_mov_b32 s21, 0
    s_cmp_lg_u32 s24, 32
    s_cselect_b32 s21, 1, s21
    s_cmp_lg_u32 s25, 32
    s_cselect_b32 s21, 1, s21
    s_cmp_lg_u32 s26, 32
    s_cselect_b32 s21, 1, s21
    s_cmp_lg_u32 s27, 32
    s_cselect_b32 s21, 1, s21
    s_cmp_lg_u32 s28, 32
    s_cselect_b32 s21, 1, s21
    s_cmp_lg_u32 s29, 32
    s_cselect_b32 s21, 1, s21
    s_cmp_lg_u32 s30, 32
    s_cselect_b32 s21, 1, s21
    s_cmp_lg_u32 s31, 32
    s_cselect_b32 s21, 1, s21
    v_mov_b32 v6, 147456
    v_mov_b32 v7, s21
    ds_write_b32 v6, v7 offset:8
    s_waitcnt lgkmcnt(0)
LQ_mj:
    s_waitcnt vmcnt(0)
    s_barrier
    s_cmp_lg_u32 s16, 4
    s_cbranch_scc1 LQ_mf
    s_lshl_b32 s21, s46, 7
    s_add_u32 s21, s21, 1103872
    s_cmp_lt_u32 s46, 60
    s_cselect_b32 s21, s21, 268435456
    v_mov_b32 v16, 0
    v_mov_b32 v17, 1
    s_mov_b64 exec, 1
    buffer_store_dword v17, v16, s[4:7], s21 offen sc1
    s_mov_b64 exec, -1
    v_min_u32 v16, 59, v0
    v_lshlrev_b32 v16, 7, v16
    v_add_u32 v16, 1103872, v16
    s_mov_b32 s21, 1
    s_mov_b32 s37, s38
L_f_14:
    buffer_load_dword v17, v16, s[4:7], 0 offen sc1
    s_waitcnt vmcnt(0)
    v_cmp_gt_u32 vcc, s21, v17
    s_cbranch_vccz L_fd_15
    s_sub_u32 s37, s37, 1
    s_cbranch_scc1 L_fd_15
    s_sleep 4
    s_branch L_f_14
L_fd_15:
    s_cmp_lt_i32 s37, 0
    s_cselect_b32 s38, 4, s38
    s_mov_b32 s24, 0
    s_mov_b32 s25, 4096
    v_add_u32 v11, 98304, v5
    buffer_load_dwordx4 v[16:19], v5, s[4:7], s24 offen offset:0 sc1
    buffer_load_dwordx4 v[20:23], v5, s[4:7], s24 offen offset:1024 sc1
    buffer_load_dwordx4 v[24:27], v5, s[4:7], s24 offen offset:2048 sc1
    buffer_load_dwordx4 v[28:31], v5, s[4:7], s24 offen offset:3072 sc1
    buffer_load_dwordx4 v[32:35], v5, s[4:7], s25 offen offset:0 sc1
    s_waitcnt vmcnt(4)
    ds_write_b128 v11, v[16:19] offset:0
    s_waitcnt vmcnt(3)
    ds_write_b128 v11, v[20:23] offset:1024
    s_waitcnt vmcnt(2)
    ds_write_b128 v11, v[24:27] offset:2048
    s_waitcnt vmcnt(1)
    ds_write_b128 v11, v[28:31] offset:3072
    s_waitcnt vmcnt(0)
    ds_write_b128 v11, v[32:35] offset:4096
    s_waitcnt lgkmcnt(0)
LQ_mf:
    s_cmp_ge_u32 s16, 4
    s_cbranch_scc1 L_stgs_16
    ds_read_b64_tr_b16 v[96:97], v9 offset:0
    ds_read_b64_tr_b16 v[98:99], v9 offset:256
    ds_read_b64_tr_b16 v[100:101], v9 offset:4096
    ds_read_b64_tr_b16 v[102:103], v9 offset:4352
    ds_read_b64_tr_b16 v[104:105], v9 offset:8192
    ds_read_b64_tr_b16 v[106:107], v9 offset:8448
    ds_read_b64_tr_b16 v[108:109], v9 offset:12288
    ds_read_b64_tr_b16 v[110:111], v9 offset:12544
    ds_read_b64_tr_b16 v[112:113], v9 offset:16384
    ds_read_b64_tr_b16 v[114:115], v9 offset:16640
    ds_read_b64_tr_b16 v[116:117], v9 offset:20480
    ds_read_b64_tr_b16 v[118:119], v9 offset:20736
    ds_read_b64_tr_b16 v[120:121], v9 offset:24576
    ds_read_b64_tr_b16 v[122:123], v9 offset:24832
    ds_read_b64_tr_b16 v[124:125], v9 offset:28672
    ds_read_b64_tr_b16 v[126:127], v9 offset:28928
    ds_read_b64_tr_b16 v[128:129], v9 offset:32768
    ds_read_b64_tr_b16 v[130:131], v9 offset:33024
    ds_read_b64_tr_b16 v[132:133], v9 offset:36864
    ds_read_b64_tr_b16 v[134:135], v9 offset:37120
    ds_read_b64_tr_b16 v[136:137], v10 offset:0
    ds_read_b64_tr_b16 v[138:139], v10 offset:256
    ds_read_b64_tr_b16 v[140:141], v10 offset:4096
    ds_read_b64_tr_b16 v[142:143], v10 offset:4352
    ds_read_b64_tr_b16 v[144:145], v10 offset:8192
    ds_read_b64_tr_b16 v[146:147], v10 offset:8448
    ds_read_b64_tr_b16 v[148:149], v10 offset:12288
    ds_read_b64_tr_b16 v[150:151], v10 offset:12544
    ds_read_b64_tr_b16 v[152:153], v10 offset:16384
    ds_read_b64_tr_b16 v[154:155], v10 offset:16640
    ds_read_b64_tr_b16 v[156:157], v10 offset:20480
    ds_read_b64_tr_b16 v[158:159], v10 offset:20736
    ds_read_b64_tr_b16 v[160:161], v10 offset:24576
    ds_read_b64_tr_b16 v[162:163], v10 offset:24832
    ds_read_b64_tr_b16 v[164:165], v10 offset:28672
    ds_read_b64_tr_b16 v[166:167], v10 offset:28928
    ds_read_b64_tr_b16 v[168:169], v10 offset:32768
    ds_read_b64_tr_b16 v[170:171], v10 offset:33024
    ds_read_b64_tr_b16 v[172:173], v10 offset:36864
    ds_read_b64_tr_b16 v[174:175], v10 offset:37120
    s_waitcnt lgkmcnt(0)
L_stgs_16:
    s_barrier
    s_load_dwordx2 s[8:9], s[0:1], 24
    s_mov_b32 s10, 7864320
    s_mov_b32 s11, 0x20000
    s_waitcnt lgkmcnt(0)
    s_mul_i32 s24, s16, 10240
    s_mov_b32 s25, 0
L_stg_17:
    s_mov_b32 m0, s24
    s_add_u32 s24, s24, 1024
    buffer_load_dwordx4 v8, s[8:11], s25 offen lds
    s_add_u32 s25, s25, 98304
    s_cmp_lt_u32 s25, 983040
    s_cbranch_scc1 L_stg_17
    v_min_u32 v7, 39, v0
    v_lshlrev_b32 v7, 6, v7
    v_add_u32 v7, 98304, v7
    ds_read_b128 v[48:51], v7 offset:0
    ds_read_b128 v[52:55], v7 offset:16
    ds_read_b128 v[56:59], v7 offset:32
    ds_read_b128 v[60:63], v7 offset:48
    ds_read_b128 v[64:67], v7 offset:2560
    ds_read_b128 v[68:71], v7 offset:2576
    ds_read_b128 v[72:75], v7 offset:2592
    ds_read_b128 v[76:79], v7 offset:2608
    v_min_u32 v12, 39, v0
    v_lshlrev_b32 v12, 8, v12
    s_lshl_b32 s26, s16, 4
    s_add_u32 s26, s26, 104448
    v_add_u32 v12, s26, v12
    s_mov_b32 s27, 0
    s_waitcnt lgkmcnt(0)
    v_pk_add_f32 v[64:65], v[64:65], 1.0 op_sel_hi:[1,0]
    v_pk_add_f32 v[66:67], v[66:67], 1.0 op_sel_hi:[1,0]
    v_pk_add_f32 v[68:69], v[68:69], 1.0 op_sel_hi:[1,0]
    v_pk_add_f32 v[70:71], v[70:71], 1.0 op_sel_hi:[1,0]
    v_pk_add_f32 v[72:73], v[72:73], 1.0 op_sel_hi:[1,0]
    v_pk_add_f32 v[74:75], v[74:75], 1.0 op_sel_hi:[1,0]
    v_pk_add_f32 v[76:77], v[76:77], 1.0 op_sel_hi:[1,0]
    v_pk_add_f32 v[78:79], v[78:79], 1.0 op_sel_hi:[1,0]
LQ_ln:
    v_lshlrev_b32 v16, 16, v176
    v_and_b32 v17, 0xffff0000, v176
    v_lshlrev_b32 v18, 16, v177
    v_and_b32 v19, 0xffff0000, v177
    v_lshlrev_b32 v20, 16, v178
    v_and_b32 v21, 0xffff0000, v178
    v_lshlrev_b32 v22, 16, v179
    v_and_b32 v23, 0xffff0000, v179
    v_lshlrev_b32 v24, 16, v180
    v_and_b32 v25, 0xffff0000, v180
    v_lshlrev_b32 v26, 16, v181
    v_and_b32 v27, 0xffff0000, v181
    v_lshlrev_b32 v28, 16, v182
    v_and_b32 v29, 0xffff0000, v182
    v_lshlrev_b32 v30, 16, v183
    v_and_b32 v31, 0xffff0000, v183
    v_mov_b32 v176, v184
    v_mov_b32 v177, v185
    v_mov_b32 v178, v186
    v_mov_b32 v179, v187
    v_mov_b32 v180, v188
    v_mov_b32 v181, v189
    v_mov_b32 v182, v190
    v_mov_b32 v183, v191
    v_mov_b32 v184, v192
    v_mov_b32 v185, v193
    v_mov_b32 v186, v194
    v_mov_b32 v187, v195
    v_mov_b32 v188, v196
    v_mov_b32 v189, v197
    v_mov_b32 v190, v198
    v_mov_b32 v191, v199
    v_pk_add_f32 v[32:33], v[16:17], v[18:19]
    v_pk_add_f32 v[32:33], v[32:33], v[20:21]
    v_pk_add_f32 v[32:33], v[32:33], v[22:23]
    v_pk_add_f32 v[32:33], v[32:33], v[24:25]
    v_pk_add_f32 v[32:33], v[32:33], v[26:27]
    v_pk_add_f32 v[32:33], v[32:33], v[28:29]
    v_pk_add_f32 v[32:33], v[32:33], v[30:31]
    v_add_f32 v32, v32, v33
    s_nop 1
    v_add_f32_dpp v32, v32, v32 row_ror:8 row_mask:0xf bank_mask:0xf
    s_nop 1
    v_add_f32_dpp v32, v32, v32 row_ror:4 row_mask:0xf bank_mask:0xf
    s_nop 1
    v_add_f32_dpp v32, v32, v32 row_ror:2 row_mask:0xf bank_mask:0xf
    s_nop 1
    v_add_f32_dpp v32, v32, v32 row_ror:1 row_mask:0xf bank_mask:0xf
    v_mov_b32 v33, v32
    s_nop 1
    v_permlane32_swap_b32 v33, v32
    v_add_f32 v32, v32, v33
    v_mov_b32 v33, v32
    s_nop 1
    v_permlane16_swap_b32 v33, v32
    v_add_f32 v32, v32, v33
    v_mul_f32 v32, 0x3acccccd, v32
    v_pk_add_f32 v[16:17], v[16:17], v[32:33] op_sel_hi:[1,0] neg_lo:[0,1] neg_hi:[0,1]
    v_pk_add_f32 v[18:19], v[18:19], v[32:33] op_sel_hi:[1,0] neg_lo:[0,1] neg_hi:[0,1]
    v_pk_add_f32 v[20:21], v[20:21], v[32:33] op_sel_hi:[1,0] neg_lo:[0,1] neg_hi:[0,1]
    v_pk_add_f32 v[22:23], v[22:23], v[32:33] op_sel_hi:[1,0] neg_lo:[0,1] neg_hi:[0,1]
    v_pk_add_f32 v[24:25], v[24:25], v[32:33] op_sel_hi:[1,0] neg_lo:[0,1] neg_hi:[0,1]
    v_pk_add_f32 v[26:27], v[26:27], v[32:33] op_sel_hi:[1,0] neg_lo:[0,1] neg_hi:[0,1]
    v_pk_add_f32 v[28:29], v[28:29], v[32:33] op_sel_hi:[1,0] neg_lo:[0,1] neg_hi:[0,1]
    v_pk_add_f32 v[30:31], v[30:31], v[32:33] op_sel_hi:[1,0] neg_lo:[0,1] neg_hi:[0,1]
    v_pk_mul_f32 v[34:35], v[16:17], v[16:17]
    v_pk_fma_f32 v[34:35], v[18:19], v[18:19], v[34:35]
    v_pk_fma_f32 v[34:35], v[20:21], v[20:21], v[34:35]
    v_pk_fma_f32 v[34:35], v[22:23], v[22:23], v[34:35]
    v_pk_fma_f32 v[34:35], v[24:25], v[24:25], v[34:35]
    v_pk_fma_f32 v[34:35], v[26:27], v[26:27], v[34:35]
    v_pk_fma_f32 v[34:35], v[28:29], v[28:29], v[34:35]
    v_pk_fma_f32 v[34:35], v[30:31], v[30:31], v[34:35]
    v_add_f32 v34, v34, v35
    v_cndmask_b32 v34, 0, v34, s[48:49]
    s_nop 1
    v_add_f32_dpp v34, v34, v34 row_ror:8 row_mask:0xf bank_mask:0xf
    s_nop 1
    v_add_f32_dpp v34, v34, v34 row_ror:4 row_mask:0xf bank_mask:0xf
    s_nop 1
    v_add_f32_dpp v34, v34, v34 row_ror:2 row_mask:0xf bank_mask:0xf
    s_nop 1
    v_add_f32_dpp v34, v34, v34 row_ror:1 row_mask:0xf bank_mask:0xf
    v_mov_b32 v35, v34
    s_nop 1
    v_permlane32_swap_b32 v35, v34
    v_add_f32 v34, v34, v35
    v_mov_b32 v35, v34
    s_nop 1
    v_permlane16_swap_b32 v35, v34
    v_add_f32 v34, v34, v35
    v_mov_b32 v35, 0x3727c5ac
    v_fmac_f32 v35, 0x3acccccd, v34
    v_rsq_f32 v34, v35
    s_nop 0
    v_pk_mul_f32 v[16:17], v[16:17], v[34:35] op_sel_hi:[1,0]
    v_pk_mul_f32 v[18:19], v[18:19], v[34:35] op_sel_hi:[1,0]
    v_pk_mul_f32 v[20:21], v[20:21], v[34:35] op_sel_hi:[1,0]
    v_pk_mul_f32 v[22:23], v[22:23], v[34:35] op_sel_hi:[1,0]
    v_pk_mul_f32 v[24:25], v[24:25], v[34:35] op_sel_hi:[1,0]
    v_pk_mul_f32 v[26:27], v[26:27], v[34:35] op_sel_hi:[1,0]
    v_pk_mul_f32 v[28:29], v[28:29], v[34:35] op_sel_hi:[1,0]
    v_pk_mul_f32 v[30:31], v[30:31], v[34:35] op_sel_hi:[1,0]
    v_pk_fma_f32 v[16:17], v[16:17], v[64:65], v[48:49]
    v_pk_fma_f32 v[18:19], v[18:19], v[66:67], v[50:51]
    v_pk_fma_f32 v[20:21], v[20:21], v[68:69], v[52:53]
    v_pk_fma_f32 v[22:23], v[22:23], v[70:71], v[54:55]
    v_pk_fma_f32 v[24:25], v[24:25], v[72:73], v[56:57]
    v_pk_fma_f32 v[26:27], v[26:27], v[74:75], v[58:59]
    v_pk_fma_f32 v[28:29], v[28:29], v[76:77], v[60:61]
    v_pk_fma_f32 v[30:31], v[30:31], v[78:79], v[62:63]
    v_cvt_pk_bf16_f32 v40, v16, v17
    v_cvt_pk_bf16_f32 v41, v24, v25
    v_cvt_pk_bf16_f32 v42, v18, v19
    v_cvt_pk_bf16_f32 v43, v26, v27
    v_cvt_pk_bf16_f32 v44, v20, v21
    v_cvt_pk_bf16_f32 v45, v28, v29
    v_cvt_pk_bf16_f32 v46, v22, v23
    v_cvt_pk_bf16_f32 v47, v30, v31
    s_mov_b64 exec, s[48:49]
    ds_write_b128 v12, v[40:43]
    ds_write_b128 v12, v[44:47] offset:128
    s_mov_b64 exec, -1
    v_add_u32 v12, 10240, v12
    s_add_u32 s27, s27, 1
    s_cmp_lt_u32 s27, 3
    s_cbranch_scc1 LQ_ln
    s_waitcnt lgkmcnt(0)
    s_barrier
    v_lshlrev_b32 v12, 4, v89
    v_add_u32 v12, 104448, v12
    ds_read_b128 v[16:19], v12 offset:0
    ds_read_b128 v[20:23], v12 offset:8192
    ds_read_b128 v[24:27], v12 offset:10240
    ds_read_b128 v[28:31], v12 offset:18432
    ds_read_b128 v[32:35], v12 offset:20480
    ds_read_b128 v[36:39], v12 offset:28672
    v_lshrrev_b32 v6, 3, v89
    v_lshlrev_b32 v6, 8, v6
    v_lshl_add_u32 v6, v3, 4, v6
    v_add_u32 v7, 16384, v6
    s_cmp_lt_u32 s16, 2
    s_cselect_b32 s28, 0, 0x40000000
    v_add_u32 v7, s28, v7
    s_lshr_b32 s26, s46, 1
    s_mul_i32 s26, s26, 20480
    s_and_b32 s27, s46, 1
    s_lshl_b32 s27, s27, 7
    s_add_u32 s26, s26, s27
    s_add_u32 s26, s26, 4194304
    s_waitcnt lgkmcnt(0)
    buffer_store_dwordx4 v[16:19], v6, s[4:7], s26 offen sc1
    buffer_store_dwordx4 v[20:23], v7, s[4:7], s26 offen sc1
    s_add_u32 s26, s26, 983040
    buffer_store_dwordx4 v[24:27], v6, s[4:7], s26 offen sc1
    buffer_store_dwordx4 v[28:31], v7, s[4:7], s26 offen sc1
    s_add_u32 s26, s26, 983040
    s_cmp_ge_u32 s46, 64
    s_cbranch_scc1 LQ_lnx
    buffer_store_dwordx4 v[32:35], v6, s[4:7], s26 offen sc1
    buffer_store_dwordx4 v[36:39], v7, s[4:7], s26 offen sc1
LQ_lnx:
    s_waitcnt vmcnt(0)
    s_barrier
    s_cmp_lg_u32 s16, 4
    s_cbranch_scc1 L_nohf_18
    s_cmp_ge_u32 s46, 16
    s_cbranch_scc1 L_nohf_18
    s_lshl_b32 s21, s46, 7
    s_add_u32 s21, s21, 1101824
    v_mov_b32 v90, 0
    v_mov_b32 v91, 1
    s_mov_b64 exec, 1
    buffer_store_dword v91, v90, s[4:7], s21 offen sc1
    s_mov_b64 exec, -1
L_nohf_18:
    s_cmp_ge_u32 s16, 4
    s_cbranch_scc1 L_stgs_19
    ds_read_b64_tr_b16 v[176:177], v9 offset:0
    ds_read_b64_tr_b16 v[178:179], v9 offset:256
    ds_read_b64_tr_b16 v[180:181], v9 offset:4096
    ds_read_b64_tr_b16 v[182:183], v9 offset:4352
    ds_read_b64_tr_b16 v[184:185], v9 offset:8192
    ds_read_b64_tr_b16 v[186:187], v9 offset:8448
    ds_read_b64_tr_b16 v[188:189], v9 offset:12288
    ds_read_b64_tr_b16 v[190:191], v9 offset:12544
    ds_read_b64_tr_b16 v[192:193], v9 offset:16384
    ds_read_b64_tr_b16 v[194:195], v9 offset:16640
    ds_read_b64_tr_b16 v[196:197], v9 offset:20480
    ds_read_b64_tr_b16 v[198:199], v9 offset:20736
    ds_read_b64_tr_b16 v[200:201], v9 offset:24576
    ds_read_b64_tr_b16 v[202:203], v9 offset:24832
    ds_read_b64_tr_b16 v[204:205], v9 offset:28672
    ds_read_b64_tr_b16 v[206:207], v9 offset:28928
    ds_read_b64_tr_b16 v[208:209], v9 offset:32768
    ds_read_b64_tr_b16 v[210:211], v9 offset:33024
    ds_read_b64_tr_b16 v[212:213], v9 offset:36864
    ds_read_b64_tr_b16 v[214:215], v9 offset:37120
    ds_read_b64_tr_b16 v[216:217], v10 offset:0
    ds_read_b64_tr_b16 v[218:219], v10 offset:256
    ds_read_b64_tr_b16 v[220:221], v10 offset:4096
    ds_read_b64_tr_b16 v[222:223], v10 offset:4352
    ds_read_b64_tr_b16 v[224:225], v10 offset:8192
    ds_read_b64_tr_b16 v[226:227], v10 offset:8448
    ds_read_b64_tr_b16 v[228:229], v10 offset:12288
    ds_read_b64_tr_b16 v[230:231], v10 offset:12544
    ds_read_b64_tr_b16 v[232:233], v10 offset:16384
    ds_read_b64_tr_b16 v[234:235], v10 offset:16640
    ds_read_b64_tr_b16 v[236:237], v10 offset:20480
    ds_read_b64_tr_b16 v[238:239], v10 offset:20736
    ds_read_b64_tr_b16 v[240:241], v10 offset:24576
    ds_read_b64_tr_b16 v[242:243], v10 offset:24832
    ds_read_b64_tr_b16 v[244:245], v10 offset:28672
    ds_read_b64_tr_b16 v[246:247], v10 offset:28928
    ds_read_b64_tr_b16 v[248:249], v10 offset:32768
    ds_read_b64_tr_b16 v[250:251], v10 offset:33024
    ds_read_b64_tr_b16 v[252:253], v10 offset:36864
    ds_read_b64_tr_b16 v[254:255], v10 offset:37120
    s_waitcnt lgkmcnt(0)
L_stgs_19:
    s_barrier
    s_cmp_eq_u32 s16, 4
    s_cbranch_scc1 LQ_C0
    s_cmp_eq_u32 s16, 5
    s_cbranch_scc1 LQ_C1
    s_cmp_eq_u32 s16, 6
    s_cbranch_scc1 LQ_C2
    s_cmp_eq_u32 s16, 7
    s_cbranch_scc1 LQ_C3
    s_lshl_b32 s21, s16, 10
    v_add_u32 v8, s21, v5
    v_add_u32 v9, 81920, v5
    v_mov_b32 v39, 0x4444
    v_mov_b32 v6, 0xeeee
    v_and_b32 v7, 2, v0
    v_cmp_ne_u32 vcc, 0, v7
    s_mul_i32 s21, s16, 10240
    s_nop 0
    v_cndmask_b32 v39, v39, v6, vcc
    v_mov_b32 v38, 147456
    v_add_u32 v15, s21, v5
    s_mul_i32 s40, s17, 10240
    s_add_u32 s40, s40, 1374208
    v_lshlrev_b32 v16, 7, v2
    v_add_u32 v16, 1101824, v16
    s_mov_b32 s21, 1
    s_mov_b32 s37, s38
L_f_20:
    buffer_load_dword v17, v16, s[4:7], 0 offen sc1
    s_waitcnt vmcnt(0)
    v_cmp_gt_u32 vcc, s21, v17
    s_cbranch_vccz L_fd_21
    s_sub_u32 s37, s37, 1
    s_cbranch_scc1 L_fd_21
    s_sleep 1
    s_branch L_f_20
L_fd_21:
    s_cmp_lt_i32 s37, 0
    s_cselect_b32 s38, 4, s38
    s_mov_b32 s28, 0
    s_mul_i32 s24, s28, 40960
    s_add_u32 s24, s24, 4194304
    s_and_b32 s25, s28, 1
    s_mul_i32 s25, s25, 40960
    s_mul_i32 s26, s16, 10240
    s_add_u32 s25, s25, s26
    s_add_u32 m0, s25, 0
    s_nop 0
    buffer_load_dwordx4 v15, s[4:7], s24 offen offset:0 lds
    buffer_load_dwordx4 v15, s[4:7], s24 offen offset:1024 lds
    buffer_load_dwordx4 v15, s[4:7], s24 offen offset:2048 lds
    buffer_load_dwordx4 v15, s[4:7], s24 offen offset:3072 lds
    s_add_u32 m0, s25, 4096
    s_add_u32 s24, s24, 4096
    buffer_load_dwordx4 v15, s[4:7], s24 offen offset:0 lds
    buffer_load_dwordx4 v15, s[4:7], s24 offen offset:1024 lds
    buffer_load_dwordx4 v15, s[4:7], s24 offen offset:2048 lds
    buffer_load_dwordx4 v15, s[4:7], s24 offen offset:3072 lds
    s_add_u32 m0, s25, 8192
    s_add_u32 s24, s24, 4096
    buffer_load_dwordx4 v15, s[4:7], s24 offen offset:0 lds
    buffer_load_dwordx4 v15, s[4:7], s24 offen offset:1024 lds
    s_mov_b32 s28, 1
    s_mul_i32 s24, s28, 40960
    s_add_u32 s24, s24, 4194304
    s_and_b32 s25, s28, 1
    s_mul_i32 s25, s25, 40960
    s_mul_i32 s26, s16, 10240
    s_add_u32 s25, s25, s26
    s_add_u32 m0, s25, 0
    s_nop 0
    buffer_load_dwordx4 v15, s[4:7], s24 offen offset:0 lds
    buffer_load_dwordx4 v15, s[4:7], s24 offen offset:1024 lds
    buffer_load_dwordx4 v15, s[4:7], s24 offen offset:2048 lds
    buffer_load_dwordx4 v15, s[4:7], s24 offen offset:3072 lds
    s_add_u32 m0, s25, 4096
    s_add_u32 s24, s24, 4096
    buffer_load_dwordx4 v15, s[4:7], s24 offen offset:0 lds
    buffer_load_dwordx4 v15, s[4:7], s24 offen offset:1024 lds
    buffer_load_dwordx4 v15, s[4:7], s24 offen offset:2048 lds
    buffer_load_dwordx4 v15, s[4:7], s24 offen offset:3072 lds
    s_add_u32 m0, s25, 8192
    s_add_u32 s24, s24, 4096
    buffer_load_dwordx4 v15, s[4:7], s24 offen offset:0 lds
    buffer_load_dwordx4 v15, s[4:7], s24 offen offset:1024 lds
    v_mul_u32_u24 v13, 384, v1
    v_lshl_add_u32 v13, v2, 4, v13
    s_mul_i32 s21, s16, 1536
    s_add_u32 s21, s21, 92160
    v_add_u32 v13, s21, v13
    s_lshr_b32 s21, s16, 1
    s_lshl_b32 s21, s21, 11
    s_and_b32 s24, s16, 1
    s_lshl_b32 s24, s24, 3
    s_add_u32 s21, s21, s24
    s_add_u32 s21, s21, 98304
    v_add_u32 v14, s21, v5
    v_lshrrev_b32 v6, 1, v0
    v_lshlrev_b32 v6, 3, v6
    v_and_b32 v7, 1, v0
    v_add_u32 v6, v6, v7
    s_lshl_b32 s21, s16, 1
    v_add_u32 v6, s21, v6
    s_lshl_b32 s21, s17, 5
    s_add_u32 s21, s21, s18
    s_mul_i32 s21, s21, 2560
    s_add_u32 s21, s21, 409600
    v_lshlrev_b32 v6, 7, v6
    v_add_u32 v36, s21, v6
    s_cmp_lt_u32 s16, 2
    s_cselect_b32 s44, 63, 15
    s_mov_b32 s45, 0
    s_waitcnt vmcnt(0)
    s_barrier
    s_mov_b32 s20, -1
    s_branch LQ_Wtok
LQ_Wloop:
    s_setprio 2
    s_and_b32 s21, s20, 3
    s_mul_i32 s21, s21, 81920
    s_add_u32 s24, s21, s40
    s_add_u32 s25, s24, 4096
    s_add_u32 s26, s24, 8192
    v_mov_b32 v40, 0
    v_mov_b32 v41, 0
    v_mov_b32 v42, 0
    v_mov_b32 v43, 0
    v_mov_b32 v44, 0
    v_mov_b32 v45, 0
    v_mov_b32 v46, 0
    v_mov_b32 v47, 0
    s_cmp_eq_u32 s16, 1
    s_cbranch_scc1 LQ_W1
    s_cmp_eq_u32 s16, 2
    s_cbranch_scc1 LQ_W2
    s_cmp_eq_u32 s16, 3
    s_cbranch_scc1 LQ_W3
LQ_W0:
    v_mov_b32 v12, 0
    s_mov_b64 exec, s[44:45]
    s_mov_b32 s37, s38
L_ns_22:
    buffer_load_dword v12, v36, s[4:7], 0 offen sc1
    s_sub_u32 s37, s37, 1
    s_cbranch_scc1 L_nsd_23
    s_waitcnt vmcnt(3)
    v_cmp_gt_u32 vcc, s20, v12
    s_cbranch_vccnz L_ns_22
L_nsd_23:
    s_mov_b64 exec, -1
    buffer_load_dwordx4 v[56:59], v8, s[4:7], s24 offen offset:0 sc1
    buffer_load_dwordx4 v[72:75], v8, s[4:7], s25 offen offset:0 sc1
    buffer_load_dwordx4 v[88:91], v8, s[4:7], s26 offen offset:0 sc1
    s_nop 15
    s_nop 15
    s_nop 2
    s_mov_b32 s37, s38
L_g2_24:
    buffer_load_dwordx4 v[56:59], v8, s[4:7], s24 offen offset:0 sc1
    buffer_load_dwordx4 v[72:75], v8, s[4:7], s25 offen offset:0 sc1
    buffer_load_dwordx4 v[88:91], v8, s[4:7], s26 offen offset:0 sc1
    s_sub_u32 s37, s37, 1
    s_cbranch_scc1 L_g2d_25
    s_waitcnt vmcnt(5)
    v_max3_u32 v11, v56, v57, v58
    v_max_u32 v11, v11, v59
    s_waitcnt vmcnt(4)
    v_max3_u32 v11, v11, v72, v73
    v_max3_u32 v11, v11, v74, v75
    s_waitcnt vmcnt(3)
    v_max3_u32 v11, v11, v88, v89
    v_max3_u32 v11, v11, v90, v91
    v_cmp_eq_u32 vcc, -1, v11
    s_cbranch_vccnz L_g2_24
L_g2d_25:
    ds_write_b128 v9, v[56:59] offset:0
    ds_write_b128 v9, v[72:75] offset:4096
    ds_write_b128 v9, v[88:91] offset:8192
    v_smfmac_f32_16x16x64_bf16 v[40:43], v[56:59], v[96:103], v39
    v_smfmac_f32_16x16x64_bf16 v[44:47], v[56:59], v[176:183], v39
    v_smfmac_f32_16x16x64_bf16 v[40:43], v[72:75], v[128:135], v39
    v_smfmac_f32_16x16x64_bf16 v[44:47], v[72:75], v[208:215], v39
    s_waitcnt lgkmcnt(0)
    s_barrier
    ds_read_b128 v[60:63], v9 offset:1024
    ds_read_b128 v[64:67], v9 offset:2048
    ds_read_b128 v[68:71], v9 offset:3072
    ds_read_b128 v[76:79], v9 offset:5120
    ds_read_b128 v[80:83], v9 offset:6144
    ds_read_b128 v[84:87], v9 offset:7168
    ds_read_b128 v[92:95], v9 offset:9216
    v_smfmac_f32_16x16x64_bf16 v[40:43], v[88:91], v[160:167], v39
    v_smfmac_f32_16x16x64_bf16 v[44:47], v[88:91], v[240:247], v39
    s_waitcnt lgkmcnt(6)
    v_smfmac_f32_16x16x64_bf16 v[40:43], v[60:63], v[104:111], v39
    v_smfmac_f32_16x16x64_bf16 v[44:47], v[60:63], v[184:191], v39
    s_waitcnt lgkmcnt(5)
    v_smfmac_f32_16x16x64_bf16 v[40:43], v[64:67], v[112:119], v39
    v_smfmac_f32_16x16x64_bf16 v[44:47], v[64:67], v[192:199], v39
    s_waitcnt lgkmcnt(4)
    v_smfmac_f32_16x16x64_bf16 v[40:43], v[68:71], v[120:127], v39
    v_smfmac_f32_16x16x64_bf16 v[44:47], v[68:71], v[200:207], v39
    s_waitcnt lgkmcnt(3)
    v_smfmac_f32_16x16x64_bf16 v[40:43], v[76:79], v[136:143], v39
    v_smfmac_f32_16x16x64_bf16 v[44:47], v[76:79], v[216:223], v39
    s_waitcnt lgkmcnt(2)
    v_smfmac_f32_16x16x64_bf16 v[40:43], v[80:83], v[144:151], v39
    v_smfmac_f32_16x16x64_bf16 v[44:47], v[80:83], v[224:231], v39
    s_waitcnt lgkmcnt(1)
    v_smfmac_f32_16x16x64_bf16 v[40:43], v[84:87], v[152:159], v39
    v_smfmac_f32_16x16x64_bf16 v[44:47], v[84:87], v[232:239], v39
    s_waitcnt lgkmcnt(0)
    v_smfmac_f32_16x16x64_bf16 v[40:43], v[92:95], v[168:175], v39
    v_smfmac_f32_16x16x64_bf16 v[44:47], v[92:95], v[248:255], v39
    s_nop 5
    s_branch LQ_Wjoin
LQ_W1:
    v_mov_b32 v12, 0
    s_mov_b64 exec, s[44:45]
    s_mov_b32 s37, s38
L_ns_26:
    buffer_load_dword v12, v36, s[4:7], 0 offen sc1
    s_sub_u32 s37, s37, 1
    s_cbranch_scc1 L_nsd_27
    s_waitcnt vmcnt(3)
    v_cmp_gt_u32 vcc, s20, v12
    s_cbranch_vccnz L_ns_26
L_nsd_27:
    s_mov_b64 exec, -1
    buffer_load_dwordx4 v[60:63], v8, s[4:7], s24 offen offset:0 sc1
    buffer_load_dwordx4 v[76:79], v8, s[4:7], s25 offen offset:0 sc1
    buffer_load_dwordx4 v[92:95], v8, s[4:7], s26 offen offset:0 sc1
    s_nop 15
    s_nop 15
    s_nop 2
    s_mov_b32 s37, s38
L_g2_28:
    buffer_load_dwordx4 v[60:63], v8, s[4:7], s24 offen offset:0 sc1
    buffer_load_dwordx4 v[76:79], v8, s[4:7], s25 offen offset:0 sc1
    buffer_load_dwordx4 v[92:95], v8, s[4:7], s26 offen offset:0 sc1
    s_sub_u32 s37, s37, 1
    s_cbranch_scc1 L_g2d_29
    s_waitcnt vmcnt(5)
    v_max3_u32 v11, v60, v61, v62
    v_max_u32 v11, v11, v63
    s_waitcnt vmcnt(4)
    v_max3_u32 v11, v11, v76, v77
    v_max3_u32 v11, v11, v78, v79
    s_waitcnt vmcnt(3)
    v_max3_u32 v11, v11, v92, v93
    v_max3_u32 v11, v11, v94, v95
    v_cmp_eq_u32 vcc, -1, v11
    s_cbranch_vccnz L_g2_28
L_g2d_29:
    ds_write_b128 v9, v[60:63] offset:1024
    ds_write_b128 v9, v[76:79] offset:5120
    ds_write_b128 v9, v[92:95] offset:9216
    v_smfmac_f32_16x16x64_bf16 v[40:43], v[60:63], v[104:111], v39
    v_smfmac_f32_16x16x64_bf16 v[44:47], v[60:63], v[184:191], v39
    v_smfmac_f32_16x16x64_bf16 v[40:43], v[76:79], v[136:143], v39
    v_smfmac_f32_16x16x64_bf16 v[44:47], v[76:79], v[216:223], v39
    s_waitcnt lgkmcnt(0)
    s_barrier
    ds_read_b128 v[56:59], v9 offset:0
    ds_read_b128 v[64:67], v9 offset:2048
    ds_read_b128 v[68:71], v9 offset:3072
    ds_read_b128 v[72:75], v9 offset:4096
    ds_read_b128 v[80:83], v9 offset:6144
    ds_read_b128 v[84:87], v9 offset:7168
    ds_read_b128 v[88:91], v9 offset:8192
    v_smfmac_f32_16x16x64_bf16 v[40:43], v[92:95], v[168:175], v39
    v_smfmac_f32_16x16x64_bf16 v[44:47], v[92:95], v[248:255], v39
    s_waitcnt lgkmcnt(6)
    v_smfmac_f32_16x16x64_bf16 v[40:43], v[56:59], v[96:103], v39
    v_smfmac_f32_16x16x64_bf16 v[44:47], v[56:59], v[176:183], v39
    s_waitcnt lgkmcnt(5)
    v_smfmac_f32_16x16x64_bf16 v[40:43], v[64:67], v[112:119], v39
    v_smfmac_f32_16x16x64_bf16 v[44:47], v[64:67], v[192:199], v39
    s_waitcnt lgkmcnt(4)
    v_smfmac_f32_16x16x64_bf16 v[40:43], v[68:71], v[120:127], v39
    v_smfmac_f32_16x16x64_bf16 v[44:47], v[68:71], v[200:207], v39
    s_waitcnt lgkmcnt(3)
    v_smfmac_f32_16x16x64_bf16 v[40:43], v[72:75], v[128:135], v39
    v_smfmac_f32_16x16x64_bf16 v[44:47], v[72:75], v[208:215], v39
    s_waitcnt lgkmcnt(2)
    v_smfmac_f32_16x16x64_bf16 v[40:43], v[80:83], v[144:151], v39
    v_smfmac_f32_16x16x64_bf16 v[44:47], v[80:83], v[224:231], v39
    s_waitcnt lgkmcnt(1)
    v_smfmac_f32_16x16x64_bf16 v[40:43], v[84:87], v[152:159], v39
    v_smfmac_f32_16x16x64_bf16 v[44:47], v[84:87], v[232:239], v39
    s_waitcnt lgkmcnt(0)
    v_smfmac_f32_16x16x64_bf16 v[40:43], v[88:91], v[160:167], v39
    v_smfmac_f32_16x16x64_bf16 v[44:47], v[88:91], v[240:247], v39
    s_nop 5
    s_branch LQ_Wjoin
LQ_W2:
    v_mov_b32 v12, 0
    s_mov_b64 exec, s[44:45]
    s_mov_b32 s37, s38
L_ns_30:
    buffer_load_dword v12, v36, s[4:7], 0 offen sc1
    s_sub_u32 s37, s37, 1
    s_cbranch_scc1 L_nsd_31
    s_waitcnt vmcnt(3)
    v_cmp_gt_u32 vcc, s20, v12
    s_cbranch_vccnz L_ns_30
L_nsd_31:
    s_mov_b64 exec, -1
    buffer_load_dwordx4 v[64:67], v8, s[4:7], s24 offen offset:0 sc1
    buffer_load_dwordx4 v[80:83], v8, s[4:7], s25 offen offset:0 sc1
    s_nop 15
    s_nop 15
    s_nop 2
    s_mov_b32 s37, s38
L_g2_32:
    buffer_load_dwordx4 v[64:67], v8, s[4:7], s24 offen offset:0 sc1
    buffer_load_dwordx4 v[80:83], v8, s[4:7], s25 offen offset:0 sc1
    s_sub_u32 s37, s37, 1
    s_cbranch_scc1 L_g2d_33
    s_waitcnt vmcnt(3)
    v_max3_u32 v11, v64, v65, v66
    v_max_u32 v11, v11, v67
    s_waitcnt vmcnt(2)
    v_max3_u32 v11, v11, v80, v81
    v_max3_u32 v11, v11, v82, v83
    v_cmp_eq_u32 vcc, -1, v11
    s_cbranch_vccnz L_g2_32
L_g2d_33:
    ds_write_b128 v9, v[64:67] offset:2048
    ds_write_b128 v9, v[80:83] offset:6144
    v_smfmac_f32_16x16x64_bf16 v[40:43], v[64:67], v[112:119], v39
    v_smfmac_f32_16x16x64_bf16 v[44:47], v[64:67], v[192:199], v39
    s_waitcnt lgkmcnt(0)
    s_barrier
    ds_read_b128 v[56:59], v9 offset:0
    ds_read_b128 v[60:63], v9 offset:1024
    ds_read_b128 v[68:71], v9 offset:3072
    ds_read_b128 v[72:75], v9 offset:4096
    ds_read_b128 v[76:79], v9 offset:5120
    ds_read_b128 v[84:87], v9 offset:7168
    ds_read_b128 v[88:91], v9 offset:8192
    ds_read_b128 v[92:95], v9 offset:9216
    v_smfmac_f32_16x16x64_bf16 v[40:43], v[80:83], v[144:151], v39
    v_smfmac_f32_16x16x64_bf16 v[44:47], v[80:83], v[224:231], v39
    s_waitcnt lgkmcnt(7)
    v_smfmac_f32_16x16x64_bf16 v[40:43], v[56:59], v[96:103], v39
    v_smfmac_f32_16x16x64_bf16 v[44:47], v[56:59], v[176:183], v39
    s_waitcnt lgkmcnt(6)
    v_smfmac_f32_16x16x64_bf16 v[40:43], v[60:63], v[104:111], v39
    v_smfmac_f32_16x16x64_bf16 v[44:47], v[60:63], v[184:191], v39
    s_waitcnt lgkmcnt(5)
    v_smfmac_f32_16x16x64_bf16 v[40:43], v[68:71], v[120:127], v39
    v_smfmac_f32_16x16x64_bf16 v[44:47], v[68:71], v[200:207], v39
    s_waitcnt lgkmcnt(4)
    v_smfmac_f32_16x16x64_bf16 v[40:43], v[72:75], v[128:135], v39
    v_smfmac_f32_16x16x64_bf16 v[44:47], v[72:75], v[208:215], v39
    s_waitcnt lgkmcnt(3)
    v_smfmac_f32_16x16x64_bf16 v[40:43], v[76:79], v[136:143], v39
    v_smfmac_f32_16x16x64_bf16 v[44:47], v[76:79], v[216:223], v39
    s_waitcnt lgkmcnt(2)
    v_smfmac_f32_16x16x64_bf16 v[40:43], v[84:87], v[152:159], v39
    v_smfmac_f32_16x16x64_bf16 v[44:47], v[84:87], v[232:239], v39
    s_waitcnt lgkmcnt(1)
    v_smfmac_f32_16x16x64_bf16 v[40:43], v[88:91], v[160:167], v39
    v_smfmac_f32_16x16x64_bf16 v[44:47], v[88:91], v[240:247], v39
    s_waitcnt lgkmcnt(0)
    v_smfmac_f32_16x16x64_bf16 v[40:43], v[92:95], v[168:175], v39
    v_smfmac_f32_16x16x64_bf16 v[44:47], v[92:95], v[248:255], v39
    s_nop 5
    s_branch LQ_Wjoin
LQ_W3:
    v_mov_b32 v12, 0
    s_mov_b64 exec, s[44:45]
    s_mov_b32 s37, s38
L_ns_34:
    buffer_load_dword v12, v36, s[4:7], 0 offen sc1
    s_sub_u32 s37, s37, 1
    s_cbranch_scc1 L_nsd_35
    s_waitcnt vmcnt(3)
    v_cmp_gt_u32 vcc, s20, v12
    s_cbranch_vccnz L_ns_34
L_nsd_35:
    s_mov_b64 exec, -1
    buffer_load_dwordx4 v[68:71], v8, s[4:7], s24 offen offset:0 sc1
    buffer_load_dwordx4 v[84:87], v8, s[4:7], s25 offen offset:0 sc1
    s_nop 15
    s_nop 15
    s_nop 2
    s_mov_b32 s37, s38
L_g2_36:
    buffer_load_dwordx4 v[68:71], v8, s[4:7], s24 offen offset:0 sc1
    buffer_load_dwordx4 v[84:87], v8, s[4:7], s25 offen offset:0 sc1
    s_sub_u32 s37, s37, 1
    s_cbranch_scc1 L_g2d_37
    s_waitcnt vmcnt(3)
    v_max3_u32 v11, v68, v69, v70
    v_max_u32 v11, v11, v71
    s_waitcnt vmcnt(2)
    v_max3_u32 v11, v11, v84, v85
    v_max3_u32 v11, v11, v86, v87
    v_cmp_eq_u32 vcc, -1, v11
    s_cbranch_vccnz L_g2_36
L_g2d_37:
    ds_write_b128 v9, v[68:71] offset:3072
    ds_write_b128 v9, v[84:87] offset:7168
    v_smfmac_f32_16x16x64_bf16 v[40:43], v[68:71], v[120:127], v39
    v_smfmac_f32_16x16x64_bf16 v[44:47], v[68:71], v[200:207], v39
    s_waitcnt lgkmcnt(0)
    s_barrier
    ds_read_b128 v[56:59], v9 offset:0
    ds_read_b128 v[60:63], v9 offset:1024
    ds_read_b128 v[64:67], v9 offset:2048
    ds_read_b128 v[72:75], v9 offset:4096
    ds_read_b128 v[76:79], v9 offset:5120
    ds_read_b128 v[80:83], v9 offset:6144
    ds_read_b128 v[88:91], v9 offset:8192
    ds_read_b128 v[92:95], v9 offset:9216
    v_smfmac_f32_16x16x64_bf16 v[40:43], v[84:87], v[152:159], v39
    v_smfmac_f32_16x16x64_bf16 v[44:47], v[84:87], v[232:239], v39
    s_waitcnt lgkmcnt(7)
    v_smfmac_f32_16x16x64_bf16 v[40:43], v[56:59], v[96:103], v39
    v_smfmac_f32_16x16x64_bf16 v[44:47], v[56:59], v[176:183], v39
    s_waitcnt lgkmcnt(6)
    v_smfmac_f32_16x16x64_bf16 v[40:43], v[60:63], v[104:111], v39
    v_smfmac_f32_16x16x64_bf16 v[44:47], v[60:63], v[184:191], v39
    s_waitcnt lgkmcnt(5)
    v_smfmac_f32_16x16x64_bf16 v[40:43], v[64:67], v[112:119], v39
    v_smfmac_f32_16x16x64_bf16 v[44:47], v[64:67], v[192:199], v39
    s_waitcnt lgkmcnt(4)
    v_smfmac_f32_16x16x64_bf16 v[40:43], v[72:75], v[128:135], v39
    v_smfmac_f32_16x16x64_bf16 v[44:47], v[72:75], v[208:215], v39
    s_waitcnt lgkmcnt(3)
    v_smfmac_f32_16x16x64_bf16 v[40:43], v[76:79], v[136:143], v39
    v_smfmac_f32_16x16x64_bf16 v[44:47], v[76:79], v[216:223], v39
    s_waitcnt lgkmcnt(2)
    v_smfmac_f32_16x16x64_bf16 v[40:43], v[80:83], v[144:151], v39
    v_smfmac_f32_16x16x64_bf16 v[44:47], v[80:83], v[224:231], v39
    s_waitcnt lgkmcnt(1)
    v_smfmac_f32_16x16x64_bf16 v[40:43], v[88:91], v[160:167], v39
    v_smfmac_f32_16x16x64_bf16 v[44:47], v[88:91], v[240:247], v39
    s_waitcnt lgkmcnt(0)
    v_smfmac_f32_16x16x64_bf16 v[40:43], v[92:95], v[168:175], v39
    v_smfmac_f32_16x16x64_bf16 v[44:47], v[92:95], v[248:255], v39
    s_nop 6
LQ_Wjoin:
    v_pk_add_f32 v[40:41], v[40:41], v[42:43]
    v_pk_add_f32 v[44:45], v[44:45], v[46:47]
    v_cvt_pk_bf16_f32 v48, v40, v41
    v_cvt_pk_bf16_f32 v49, v40, v41
    v_cvt_pk_bf16_f32 v50, v44, v45
    v_cvt_pk_bf16_f32 v51, v44, v45
    ds_write_b128 v13, v[48:51]
    s_waitcnt lgkmcnt(0)
    s_barrier
    s_setprio 0
    s_waitcnt vmcnt(0)
    s_cmp_lt_i32 s37, 0
    s_cselect_b32 s38, 4, s38
    s_cmp_eq_u32 s20, 63
    s_cbranch_scc1 LQ_Wend
    s_sleep 4
LQ_Wtok:
    s_add_u32 s21, s20, 1
    s_and_b32 s27, s21, 1
    s_mul_i32 s24, s27, 40960
    v_add_u32 v10, s24, v5
    ds_read_b128 v[56:59], v10 offset:0
    ds_read_b128 v[60:63], v10 offset:20480
    ds_read_b128 v[64:67], v10 offset:1024
    ds_read_b128 v[68:71], v10 offset:21504
    ds_read_b128 v[72:75], v10 offset:2048
    ds_read_b128 v[76:79], v10 offset:22528
    ds_read_b128 v[80:83], v10 offset:3072
    ds_read_b128 v[84:87], v10 offset:23552
    ds_read_b128 v[88:91], v10 offset:4096
    ds_read_b128 v[92:95], v10 offset:24576
    s_waitcnt lgkmcnt(8)
    v_mfma_f32_16x16x32_bf16 v[40:43], v[96:99], v[56:59], 0
    v_mfma_f32_16x16x32_bf16 v[48:51], v[176:179], v[56:59], 0
    v_mfma_f32_16x16x32_bf16 v[44:47], v[96:99], v[60:63], 0
    v_mfma_f32_16x16x32_bf16 v[52:55], v[176:179], v[60:63], 0
    ds_read_b128 v[56:59], v10 offset:5120
    ds_read_b128 v[60:63], v10 offset:25600
    s_waitcnt lgkmcnt(8)
    v_mfma_f32_16x16x32_bf16 v[40:43], v[100:103], v[64:67], v[40:43]
    v_mfma_f32_16x16x32_bf16 v[48:51], v[180:183], v[64:67], v[48:51]
    v_mfma_f32_16x16x32_bf16 v[44:47], v[100:103], v[68:71], v[44:47]
    v_mfma_f32_16x16x32_bf16 v[52:55], v[180:183], v[68:71], v[52:55]
    ds_read_b128 v[64:67], v10 offset:6144
    ds_read_b128 v[68:71], v10 offset:26624
    s_waitcnt lgkmcnt(8)
    v_mfma_f32_16x16x32_bf16 v[40:43], v[104:107], v[72:75], v[40:43]
    v_mfma_f32_16x16x32_bf16 v[48:51], v[184:187], v[72:75], v[48:51]
    v_mfma_f32_16x16x32_bf16 v[44:47], v[104:107], v[76:79], v[44:47]
    v_mfma_f32_16x16x32_bf16 v[52:55], v[184:187], v[76:79], v[52:55]
    ds_read_b128 v[72:75], v10 offset:7168
    ds_read_b128 v[76:79], v10 offset:27648
    s_waitcnt lgkmcnt(8)
    v_mfma_f32_16x16x32_bf16 v[40:43], v[108:111], v[80:83], v[40:43]
    v_mfma_f32_16x16x32_bf16 v[48:51], v[188:191], v[80:83], v[48:51]
    v_mfma_f32_16x16x32_bf16 v[44:47], v[108:111], v[84:87], v[44:47]
    v_mfma_f32_16x16x32_bf16 v[52:55], v[188:191], v[84:87], v[52:55]
    ds_read_b128 v[80:83], v10 offset:8192
    ds_read_b128 v[84:87], v10 offset:28672
    s_waitcnt lgkmcnt(8)
    v_mfma_f32_16x16x32_bf16 v[40:43], v[112:115], v[88:91], v[40:43]
    v_mfma_f32_16x16x32_bf16 v[48:51], v[192:195], v[88:91], v[48:51]
    v_mfma_f32_16x16x32_bf16 v[44:47], v[112:115], v[92:95], v[44:47]
    v_mfma_f32_16x16x32_bf16 v[52:55], v[192:195], v[92:95], v[52:55]
    ds_read_b128 v[88:91], v10 offset:9216
    ds_read_b128 v[92:95], v10 offset:29696
    s_waitcnt lgkmcnt(8)
    v_mfma_f32_16x16x32_bf16 v[40:43], v[116:119], v[56:59], v[40:43]
    v_mfma_f32_16x16x32_bf16 v[48:51], v[196:199], v[56:59], v[48:51]
    v_mfma_f32_16x16x32_bf16 v[44:47], v[116:119], v[60:63], v[44:47]
    v_mfma_f32_16x16x32_bf16 v[52:55], v[196:199], v[60:63], v[52:55]
    ds_read_b128 v[56:59], v10 offset:10240
    ds_read_b128 v[60:63], v10 offset:30720
    s_waitcnt lgkmcnt(8)
    v_mfma_f32_16x16x32_bf16 v[40:43], v[120:123], v[64:67], v[40:43]
    v_mfma_f32_16x16x32_bf16 v[48:51], v[200:203], v[64:67], v[48:51]
    v_mfma_f32_16x16x32_bf16 v[44:47], v[120:123], v[68:71], v[44:47]
    v_mfma_f32_16x16x32_bf16 v[52:55], v[200:203], v[68:71], v[52:55]
    ds_read_b128 v[64:67], v10 offset:11264
    ds_read_b128 v[68:71], v10 offset:31744
    s_waitcnt lgkmcnt(8)
    v_mfma_f32_16x16x32_bf16 v[40:43], v[124:127], v[72:75], v[40:43]
    v_mfma_f32_16x16x32_bf16 v[48:51], v[204:207], v[72:75], v[48:51]
    v_mfma_f32_16x16x32_bf16 v[44:47], v[124:127], v[76:79], v[44:47]
    v_mfma_f32_16x16x32_bf16 v[52:55], v[204:207], v[76:79], v[52:55]
    ds_read_b128 v[72:75], v10 offset:12288
    ds_read_b128 v[76:79], v10 offset:32768
    s_waitcnt lgkmcnt(8)
    v_mfma_f32_16x16x32_bf16 v[40:43], v[128:131], v[80:83], v[40:43]
    v_mfma_f32_16x16x32_bf16 v[48:51], v[208:211], v[80:83], v[48:51]
    v_mfma_f32_16x16x32_bf16 v[44:47], v[128:131], v[84:87], v[44:47]
    v_mfma_f32_16x16x32_bf16 v[52:55], v[208:211], v[84:87], v[52:55]
    ds_read_b128 v[80:83], v10 offset:13312
    ds_read_b128 v[84:87], v10 offset:33792
    s_waitcnt lgkmcnt(8)
    v_mfma_f32_16x16x32_bf16 v[40:43], v[132:135], v[88:91], v[40:43]
    v_mfma_f32_16x16x32_bf16 v[48:51], v[212:215], v[88:91], v[48:51]
    v_mfma_f32_16x16x32_bf16 v[44:47], v[132:135], v[92:95], v[44:47]
    v_mfma_f32_16x16x32_bf16 v[52:55], v[212:215], v[92:95], v[52:55]
    ds_read_b128 v[88:91], v10 offset:14336
    ds_read_b128 v[92:95], v10 offset:34816
    s_waitcnt lgkmcnt(8)
    v_mfma_f32_16x16x32_bf16 v[40:43], v[136:139], v[56:59], v[40:43]
    v_mfma_f32_16x16x32_bf16 v[48:51], v[216:219], v[56:59], v[48:51]
    v_mfma_f32_16x16x32_bf16 v[44:47], v[136:139], v[60:63], v[44:47]
    v_mfma_f32_16x16x32_bf16 v[52:55], v[216:219], v[60:63], v[52:55]
    ds_read_b128 v[56:59], v10 offset:15360
    ds_read_b128 v[60:63], v10 offset:35840
    s_waitcnt lgkmcnt(8)
    v_mfma_f32_16x16x32_bf16 v[40:43], v[140:143], v[64:67], v[40:43]
    v_mfma_f32_16x16x32_bf16 v[48:51], v[220:223], v[64:67], v[48:51]
    v_mfma_f32_16x16x32_bf16 v[44:47], v[140:143], v[68:71], v[44:47]
    v_mfma_f32_16x16x32_bf16 v[52:55], v[220:223], v[68:71], v[52:55]
    ds_read_b128 v[64:67], v10 offset:16384
    ds_read_b128 v[68:71], v10 offset:36864
    s_waitcnt lgkmcnt(8)
    v_mfma_f32_16x16x32_bf16 v[40:43], v[144:147], v[72:75], v[40:43]
    v_mfma_f32_16x16x32_bf16 v[48:51], v[224:227], v[72:75], v[48:51]
    v_mfma_f32_16x16x32_bf16 v[44:47], v[144:147], v[76:79], v[44:47]
    v_mfma_f32_16x16x32_bf16 v[52:55], v[224:227], v[76:79], v[52:55]
    ds_read_b128 v[72:75], v10 offset:17408
    ds_read_b128 v[76:79], v10 offset:37888
    s_waitcnt lgkmcnt(8)
    v_mfma_f32_16x16x32_bf16 v[40:43], v[148:151], v[80:83], v[40:43]
    v_mfma_f32_16x16x32_bf16 v[48:51], v[228:231], v[80:83], v[48:51]
    v_mfma_f32_16x16x32_bf16 v[44:47], v[148:151], v[84:87], v[44:47]
    v_mfma_f32_16x16x32_bf16 v[52:55], v[228:231], v[84:87], v[52:55]
    ds_read_b128 v[80:83], v10 offset:18432
    ds_read_b128 v[84:87], v10 offset:38912
    s_waitcnt lgkmcnt(8)
    v_mfma_f32_16x16x32_bf16 v[40:43], v[152:155], v[88:91], v[40:43]
    v_mfma_f32_16x16x32_bf16 v[48:51], v[232:235], v[88:91], v[48:51]
    v_mfma_f32_16x16x32_bf16 v[44:47], v[152:155], v[92:95], v[44:47]
    v_mfma_f32_16x16x32_bf16 v[52:55], v[232:235], v[92:95], v[52:55]
    ds_read_b128 v[88:91], v10 offset:19456
    ds_read_b128 v[92:95], v10 offset:39936
    s_waitcnt lgkmcnt(8)
    v_mfma_f32_16x16x32_bf16 v[40:43], v[156:159], v[56:59], v[40:43]
    v_mfma_f32_16x16x32_bf16 v[48:51], v[236:239], v[56:59], v[48:51]
    v_mfma_f32_16x16x32_bf16 v[44:47], v[156:159], v[60:63], v[44:47]
    v_mfma_f32_16x16x32_bf16 v[52:55], v[236:239], v[60:63], v[52:55]
    s_waitcnt lgkmcnt(6)
    v_mfma_f32_16x16x32_bf16 v[40:43], v[160:163], v[64:67], v[40:43]
    v_mfma_f32_16x16x32_bf16 v[48:51], v[240:243], v[64:67], v[48:51]
    v_mfma_f32_16x16x32_bf16 v[44:47], v[160:163], v[68:71], v[44:47]
    v_mfma_f32_16x16x32_bf16 v[52:55], v[240:243], v[68:71], v[52:55]
    s_waitcnt lgkmcnt(4)
    v_mfma_f32_16x16x32_bf16 v[40:43], v[164:167], v[72:75], v[40:43]
    v_mfma_f32_16x16x32_bf16 v[48:51], v[244:247], v[72:75], v[48:51]
    v_mfma_f32_16x16x32_bf16 v[44:47], v[164:167], v[76:79], v[44:47]
    v_mfma_f32_16x16x32_bf16 v[52:55], v[244:247], v[76:79], v[52:55]
    s_waitcnt lgkmcnt(2)
    v_mfma_f32_16x16x32_bf16 v[40:43], v[168:171], v[80:83], v[40:43]
    v_mfma_f32_16x16x32_bf16 v[48:51], v[248:251], v[80:83], v[48:51]
    v_mfma_f32_16x16x32_bf16 v[44:47], v[168:171], v[84:87], v[44:47]
    v_mfma_f32_16x16x32_bf16 v[52:55], v[248:251], v[84:87], v[52:55]
    s_waitcnt lgkmcnt(0)
    v_mfma_f32_16x16x32_bf16 v[40:43], v[172:175], v[88:91], v[40:43]
    v_mfma_f32_16x16x32_bf16 v[48:51], v[252:255], v[88:91], v[48:51]
    v_mfma_f32_16x16x32_bf16 v[44:47], v[172:175], v[92:95], v[44:47]
    v_mfma_f32_16x16x32_bf16 v[52:55], v[252:255], v[92:95], v[52:55]
    s_nop 7
    s_lshl_b32 s27, s27, 13
    v_add_u32 v6, s27, v14
    v_cvt_pk_bf16_f32 v40, v40, v41
    v_cvt_pk_bf16_f32 v41, v42, v43
    ds_write_b64 v6, v[40:41] offset:0
    v_cvt_pk_bf16_f32 v44, v44, v45
    v_cvt_pk_bf16_f32 v45, v46, v47
    ds_write_b64 v6, v[44:45] offset:1024
    v_cvt_pk_bf16_f32 v48, v48, v49
    v_cvt_pk_bf16_f32 v49, v50, v51
    ds_write_b64 v6, v[48:49] offset:4096
    v_cvt_pk_bf16_f32 v52, v52, v53
    v_cvt_pk_bf16_f32 v53, v54, v55
    ds_write_b64 v6, v[52:53] offset:5120
    s_waitcnt vmcnt(0) lgkmcnt(0)
    s_add_u32 s20, s20, 1
    s_branch LQ_Wloop
LQ_Wend:
    s_branch LM_tail
LQ_C0:
    s_setprio 3
    v_and_b32 v6, 3, v0
    v_mul_u32_u24 v8, 384, v6
    v_lshrrev_b32 v6, 2, v0
    v_lshl_add_u32 v8, v6, 4, v8
    v_add_u32 v8, 92160, v8
    v_bfe_u32 v12, v0, 2, 2
    v_and_b32 v6, 1, v0
    v_lshl_add_u32 v12, v12, 1, v6
    v_bfe_u32 v13, v0, 1, 1
    v_lshlrev_b32 v10, 4, v12
    s_and_b32 s21, s41, 1
    s_lshl_b32 s21, s21, 7
    v_add_u32 v10, s21, v10
    v_and_b32 v6, 1, v1
    v_lshl_add_u32 v9, v6, 3, v10
    v_lshl_add_u32 v10, v1, 2, v10
    v_lshrrev_b32 v6, 1, v1
    v_lshl_add_u32 v9, v6, 8, v9
    s_cmp_eq_u32 s42, 2
    s_cselect_b32 s24, 9, 10
    s_lshl_b32 s25, s42, 9
    s_cmp_eq_u32 s42, 2
    s_cselect_b32 s25, 2048, s25
    v_lshlrev_b32 v6, s24, v13
    v_add_u32 v9, v9, v6
    v_add_u32 v9, s25, v9
    s_lshl_b32 s25, s42, 8
    s_add_u32 s25, s25, 3072
    v_add_u32 v10, s25, v10
    s_lshl_b32 s43, s17, 13
    s_bfe_u32 s21, s41, 0x10001
    s_lshl_b32 s21, s21, 12
    s_add_u32 s43, s43, s21
    s_add_u32 s43, s43, 1112064
    v_cmp_eq_u32 s[44:45], 1, v13
    v_mov_b32 v60, -1
    v_mov_b32 v61, -1
    s_mul_i32 s21, s17, 81920
    s_sub_u32 s24, s18, 20
    s_lshl_b32 s24, s24, 7
    s_add_u32 s21, s21, s24
    s_add_u32 s21, s21, 409600
    v_mul_u32_u24 v14, 2560, v0
    v_add_u32 v14, s21, v14
    v_mov_b32 v6, 0x40000000
    v_cmp_gt_u32 vcc, 20, v0
    s_nop 1
    v_cndmask_b32 v14, v6, v14, vcc
    s_barrier
    v_mov_b32 v6, 147456
    ds_read_b32 v6, v6 offset:8
    s_waitcnt lgkmcnt(0)
    v_readfirstlane_b32 s19, v6
    s_mov_b32 s20, 0
LQ_C0loop:
    s_and_b32 s21, s20, 1
    s_lshl_b32 s21, s21, 13
    s_add_u32 s21, s21, 102400
    v_add_u32 v11, s21, v5
    s_and_b32 s21, s20, 3
    s_mul_i32 s24, s21, 65536
    s_add_u32 s24, s24, s43
    s_xor_b32 s21, s21, 2
    s_mul_i32 s25, s21, 65536
    s_add_u32 s25, s25, s43
    s_add_u32 s21, s20, 1
    v_mov_b32 v15, s21
    s_barrier
    ds_read_b128 v[16:19], v11 offset:0
    ds_read_b128 v[20:23], v11 offset:2048
    ds_read_b128 v[24:27], v11 offset:1024
    ds_read_b128 v[28:31], v11 offset:3072
    s_waitcnt vmcnt(0) lgkmcnt(0)
    s_barrier
    ds_read_b64_tr_b16 v[32:33], v8 offset:0
    ds_read_b64_tr_b16 v[34:35], v8 offset:1536
    ds_read_b64_tr_b16 v[36:37], v8 offset:3072
    ds_read_b64_tr_b16 v[38:39], v8 offset:4608
    ds_read_b64_tr_b16 v[40:41], v8 offset:8
    ds_read_b64_tr_b16 v[42:43], v8 offset:1544
    ds_read_b64_tr_b16 v[44:45], v8 offset:3080
    ds_read_b64_tr_b16 v[46:47], v8 offset:4616
    s_cmp_lg_u32 s19, 0
    s_cbranch_scc1 L_slow_38
    buffer_store_dword v15, v14, s[4:7], 0 offen
L_back_39:
    s_waitcnt lgkmcnt(6)
    v_mfma_f32_16x16x32_bf16 v[48:51], v[16:19], v[32:35], 0
    v_mfma_f32_16x16x32_bf16 v[52:55], v[24:27], v[32:35], 0
    s_waitcnt lgkmcnt(4)
    v_mfma_f32_16x16x32_bf16 v[48:51], v[20:23], v[36:39], v[48:51]
    v_mfma_f32_16x16x32_bf16 v[52:55], v[28:31], v[36:39], v[52:55]
    s_waitcnt lgkmcnt(2)
    v_mfma_f32_16x16x32_bf16 v[56:59], v[40:43], v[32:35], 0
    s_waitcnt lgkmcnt(0)
    v_mfma_f32_16x16x32_bf16 v[56:59], v[44:47], v[36:39], v[56:59]
    s_nop 3
    v_cvt_pk_bf16_f32 v48, v48, v49
    v_cvt_pk_bf16_f32 v49, v50, v51
    v_cvt_pk_bf16_f32 v52, v52, v53
    v_cvt_pk_bf16_f32 v53, v54, v55
    v_cvt_pk_bf16_f32 v56, v56, v57
    v_cndmask_b32 v48, v48, v52, s[44:45]
    v_cndmask_b32 v49, v49, v53, s[44:45]
    v_min_u32 v48, -2, v48
    v_min_u32 v49, -2, v49
    v_min_u32 v56, -2, v56
    s_cmp_lg_u32 s19, 0
    s_cbranch_scc1 L_slow_40
    buffer_store_dwordx2 v[48:49], v9, s[4:7], s24 offen
    buffer_store_dword v56, v10, s[4:7], s24 offen
L_back_41:
    s_cmp_lg_u32 s19, 0
    s_cbranch_scc1 L_slow_42
    buffer_store_dwordx2 v[60:61], v9, s[4:7], s25 offen
    buffer_store_dword v60, v10, s[4:7], s25 offen
L_back_43:
    s_add_u32 s27, s20, 2
    s_cmp_gt_u32 s27, 63
    s_cbranch_scc1 LQ_C0nd
    s_sleep 8
    s_mul_i32 s28, s27, 40960
    s_add_u32 s28, s28, 4194304
    s_and_b32 s29, s27, 1
    s_mul_i32 s29, s29, 40960
    s_add_u32 s30, s29, 40960
    s_add_u32 s29, s29, 0
L_dma_44:
    s_mov_b32 m0, s29
    s_add_u32 s29, s29, 4096
    buffer_load_dwordx4 v5, s[4:7], s28 offen offset:0 lds
    buffer_load_dwordx4 v5, s[4:7], s28 offen offset:1024 lds
    buffer_load_dwordx4 v5, s[4:7], s28 offen offset:2048 lds
    buffer_load_dwordx4 v5, s[4:7], s28 offen offset:3072 lds
    s_add_u32 s28, s28, 4096
    s_cmp_lt_u32 s29, s30
    s_cbranch_scc1 L_dma_44
LQ_C0nd:
    s_add_u32 s20, s20, 1
    s_cmp_lt_u32 s20, 63
    s_cbranch_scc1 LQ_C0loop
    s_waitcnt vmcnt(0)
    s_endpgm
LQ_C1:
    v_and_b32 v6, 3, v0
    v_mul_u32_u24 v8, 384, v6
    v_lshrrev_b32 v6, 2, v0
    v_lshl_add_u32 v8, v6, 4, v8
    v_add_u32 v8, 92160, v8
    s_mul_i32 s43, s41, 3
    s_add_u32 s43, s43, s42
    s_lshl_b32 s44, s43, 7
    s_add_u32 s44, s44, 1064960
    s_mul_i32 s43, s43, 5120
    s_add_u32 s43, s43, 2095104
    v_mov_b32 v9, 0
    v_lshlrev_b32 v12, 3, v0
    s_barrier
    v_mov_b32 v6, 147456
    ds_read_b32 v6, v6 offset:8
    s_waitcnt lgkmcnt(0)
    v_readfirstlane_b32 s19, v6
    s_mov_b32 s20, 0
LQ_C1loop:
    s_and_b32 s21, s20, 1
    s_lshl_b32 s21, s21, 13
    s_add_u32 s21, s21, 98304
    v_add_u32 v11, s21, v5
    s_and_b32 s21, s20, 3
    s_mul_i32 s24, s21, 491520
    s_add_u32 s24, s24, s43
    s_add_u32 s25, s24, 4096
    s_add_u32 s26, s20, 1
    v_mov_b32 v10, s26
    s_barrier
    s_barrier
    s_cmp_eq_u32 s20, 63
    s_cbranch_scc1 LQ_C1ns
    s_sleep 10
LQ_C1ns:
    ds_read_b128 v[16:19], v11 offset:0
    ds_read_b128 v[32:35], v11 offset:4096
    ds_read_b128 v[20:23], v11 offset:2048
    ds_read_b128 v[36:39], v11 offset:6144
    ds_read_b128 v[24:27], v11 offset:1024
    ds_read_b128 v[40:43], v11 offset:5120
    ds_read_b128 v[28:31], v11 offset:3072
    ds_read_b128 v[44:47], v11 offset:7168
    ds_read_b64_tr_b16 v[48:49], v8 offset:8
    ds_read_b64_tr_b16 v[50:51], v8 offset:1544
    ds_read_b64_tr_b16 v[52:53], v8 offset:3080
    ds_read_b64_tr_b16 v[54:55], v8 offset:4616
    s_waitcnt lgkmcnt(0)
    v_mfma_f32_16x16x32_bf16 v[56:59], v[32:35], v[16:19], 0
    v_mfma_f32_16x16x32_bf16 v[60:63], v[48:51], v[16:19], 0
    v_mfma_f32_16x16x32_bf16 v[64:67], v[32:35], v[24:27], 0
    v_mfma_f32_16x16x32_bf16 v[68:71], v[40:43], v[24:27], 0
    v_mfma_f32_16x16x32_bf16 v[72:75], v[48:51], v[24:27], 0
    v_mfma_f32_16x16x32_bf16 v[56:59], v[36:39], v[20:23], v[56:59]
    v_mfma_f32_16x16x32_bf16 v[60:63], v[52:55], v[20:23], v[60:63]
    v_mfma_f32_16x16x32_bf16 v[64:67], v[36:39], v[28:31], v[64:67]
    v_mfma_f32_16x16x32_bf16 v[68:71], v[44:47], v[28:31], v[68:71]
    v_mfma_f32_16x16x32_bf16 v[72:75], v[52:55], v[28:31], v[72:75]
    s_nop 7
    s_cmp_lg_u32 s19, 0
    s_cbranch_scc1 L_slow_45
    buffer_store_dwordx4 v[56:59], v5, s[4:7], s24 offen offset:0
    buffer_store_dwordx2 v[60:61], v12, s[4:7], s24 offen offset:1024
    buffer_store_dwordx4 v[64:67], v5, s[4:7], s24 offen offset:2048
    buffer_store_dwordx4 v[68:71], v5, s[4:7], s24 offen offset:3072
    buffer_store_dwordx2 v[72:73], v12, s[4:7], s25 offen
L_back_46:
    s_waitcnt vmcnt(0)
    s_mov_b64 exec, 1
    s_cmp_lg_u32 s19, 0
    s_cbranch_scc1 L_slow_47
    buffer_store_dword v10, v9, s[4:7], s44 offen
L_back_48:
    s_mov_b64 exec, -1
    s_add_u32 s20, s20, 1
    s_cmp_lt_u32 s20, 64
    s_cbranch_scc1 LQ_C1loop
    s_waitcnt vmcnt(0)
    s_endpgm
LQ_C2:
    s_cmp_eq_u32 s42, 2
    s_cbranch_scc1 LQ_exit1
    s_mul_i32 s43, s41, 15360
    s_add_u32 s43, s43, 2095104
    s_mul_i32 s21, s41, 384
    s_add_u32 s21, s21, 1064960
    v_min_u32 v8, 2, v0
    v_lshlrev_b32 v8, 7, v8
    v_add_u32 v8, s21, v8
    s_lshl_b32 s44, s41, 1
    s_add_u32 s44, s44, s42
    s_lshl_b32 s45, s44, 7
    s_add_u32 s45, s45, 1077248
    s_mul_i32 s44, s44, 1536
    s_add_u32 s44, s44, 1701888
    s_lshl_b32 s46, s42, 11
    s_mul_i32 s47, s42, 3072
    s_add_u32 s48, s47, 1024
    v_lshlrev_b32 v9, 3, v0
    v_mov_b32 v10, 0
    v_lshlrev_b32 v6, 2, v1
    s_lshl_b32 s21, s42, 4
    v_add_u32 v7, s21, v2
    v_add_u32 v11, 0, v6
    v_cmp_le_u32 s[50:51], v11, v7
    v_add_u32 v11, 1, v6
    v_cmp_le_u32 s[52:53], v11, v7
    v_add_u32 v11, 2, v6
    v_cmp_le_u32 s[54:55], v11, v7
    v_add_u32 v11, 3, v6
    v_cmp_le_u32 s[56:57], v11, v7
    v_add_u32 v11, 16, v6
    v_cmp_le_u32 s[58:59], v11, v7
    v_add_u32 v11, 17, v6
    v_cmp_le_u32 s[60:61], v11, v7
    v_add_u32 v11, 18, v6
    v_cmp_le_u32 s[62:63], v11, v7
    v_add_u32 v11, 19, v6
    v_cmp_le_u32 s[64:65], v11, v7
    v_mov_b32 v12, 3494803967
    v_lshlrev_b32 v14, 2, v0
    s_mov_b32 s66, 1037384597
    s_mov_b32 s67, 1037384597
    s_barrier
    v_mov_b32 v6, 147456
    ds_read_b32 v6, v6 offset:8
    s_waitcnt lgkmcnt(0)
    v_readfirstlane_b32 s19, v6
    s_barrier
    s_barrier
    s_mov_b32 s20, 1
LQ_C2loop:
    s_cmp_gt_u32 s20, 63
    s_cbranch_scc1 LQ_C2nb
    s_barrier
    s_barrier
    s_cmp_eq_u32 s20, 63
    s_cbranch_scc1 LQ_C2nb
    s_sleep 10
LQ_C2nb:
    s_sub_u32 s21, s20, 1
    s_and_b32 s21, s21, 3
    s_mul_i32 s24, s21, 491520
    s_add_u32 s24, s24, s43
    s_mul_i32 s30, s21, 98304
    s_add_u32 s30, s30, s44
    v_mov_b32 v13, s20
    s_mov_b32 s37, s38
L_f_49:
    buffer_load_dword v11, v8, s[4:7], 0 offen sc1
    s_waitcnt vmcnt(0)
    v_cmp_gt_u32 vcc, s20, v11
    s_cbranch_vccz L_fd_50
    s_sub_u32 s37, s37, 1
    s_cbranch_scc1 L_fd_50
    s_sleep 1
    s_branch L_f_49
L_fd_50:
    s_cmp_lt_i32 s37, 0
    s_cselect_b32 s38, 4, s38
    s_add_u32 s25, s24, s46
    buffer_load_dwordx4 v[16:19], v5, s[4:7], s25 offen sc1
    s_add_u32 s25, s24, s47
    buffer_load_dwordx4 v[20:23], v5, s[4:7], s25 offen sc1
    s_add_u32 s25, s24, s48
    buffer_load_dwordx2 v[24:25], v9, s[4:7], s25 offen sc1
    s_add_u32 s24, s24, 5120
    s_add_u32 s25, s24, s46
    buffer_load_dwordx4 v[28:31], v5, s[4:7], s25 offen sc1
    s_add_u32 s25, s24, s47
    buffer_load_dwordx4 v[32:35], v5, s[4:7], s25 offen sc1
    s_add_u32 s25, s24, s48
    buffer_load_dwordx2 v[36:37], v9, s[4:7], s25 offen sc1
    s_add_u32 s24, s24, 5120
    s_add_u32 s25, s24, s46
    buffer_load_dwordx4 v[40:43], v5, s[4:7], s25 offen sc1
    s_add_u32 s25, s24, s47
    buffer_load_dwordx4 v[44:47], v5, s[4:7], s25 offen sc1
    s_add_u32 s25, s24, s48
    buffer_load_dwordx2 v[48:49], v9, s[4:7], s25 offen sc1
    s_waitcnt vmcnt(3)
    v_pk_add_f32 v[16:17], v[16:17], v[28:29]
    v_pk_add_f32 v[18:19], v[18:19], v[30:31]
    v_pk_add_f32 v[20:21], v[20:21], v[32:33]
    v_pk_add_f32 v[22:23], v[22:23], v[34:35]
    v_pk_add_f32 v[24:25], v[24:25], v[36:37]
    s_waitcnt vmcnt(0)
    v_pk_add_f32 v[16:17], v[16:17], v[40:41]
    v_pk_add_f32 v[18:19], v[18:19], v[42:43]
    v_pk_add_f32 v[20:21], v[20:21], v[44:45]
    v_pk_add_f32 v[22:23], v[22:23], v[46:47]
    v_pk_add_f32 v[24:25], v[24:25], v[48:49]
    v_cndmask_b32 v16, v12, v16, s[50:51]
    v_cndmask_b32 v17, v12, v17, s[52:53]
    v_cndmask_b32 v18, v12, v18, s[54:55]
    v_cndmask_b32 v19, v12, v19, s[56:57]
    v_cndmask_b32 v20, v12, v20, s[58:59]
    v_cndmask_b32 v21, v12, v21, s[60:61]
    v_cndmask_b32 v22, v12, v22, s[62:63]
    v_cndmask_b32 v23, v12, v23, s[64:65]
    v_max3_f32 v52, v16, v17, v18
    v_max3_f32 v52, v52, v19, v20
    v_max3_f32 v52, v52, v21, v22
    v_max3_f32 v52, v52, v23, v24
    v_max_f32 v52, v52, v25
    v_mov_b32 v53, v52
    s_nop 1
    v_permlane32_swap_b32 v53, v52
    v_max_f32 v52, v52, v53
    v_mov_b32 v53, v52
    s_nop 1
    v_permlane16_swap_b32 v53, v52
    v_max_f32 v52, v52, v53
    v_mul_f32 v52, s66, v52
    v_pk_fma_f32 v[16:17], v[16:17], s[66:67], v[52:53] op_sel_hi:[1,1,0] neg_lo:[0,0,1] neg_hi:[0,0,1]
    v_pk_fma_f32 v[18:19], v[18:19], s[66:67], v[52:53] op_sel_hi:[1,1,0] neg_lo:[0,0,1] neg_hi:[0,0,1]
    v_pk_fma_f32 v[20:21], v[20:21], s[66:67], v[52:53] op_sel_hi:[1,1,0] neg_lo:[0,0,1] neg_hi:[0,0,1]
    v_pk_fma_f32 v[22:23], v[22:23], s[66:67], v[52:53] op_sel_hi:[1,1,0] neg_lo:[0,0,1] neg_hi:[0,0,1]
    v_pk_fma_f32 v[24:25], v[24:25], s[66:67], v[52:53] op_sel_hi:[1,1,0] neg_lo:[0,0,1] neg_hi:[0,0,1]
    v_exp_f32 v16, v16
    v_exp_f32 v17, v17
    v_exp_f32 v18, v18
    v_exp_f32 v19, v19
    v_exp_f32 v20, v20
    v_exp_f32 v21, v21
    v_exp_f32 v22, v22
    v_exp_f32 v23, v23
    v_exp_f32 v24, v24
    v_exp_f32 v25, v25
    v_pk_add_f32 v[52:53], v[16:17], v[18:19]
    v_pk_add_f32 v[52:53], v[52:53], v[20:21]
    v_pk_add_f32 v[52:53], v[52:53], v[22:23]
    v_pk_add_f32 v[52:53], v[52:53], v[24:25]
    v_add_f32 v52, v52, v53
    v_mov_b32 v53, v52
    s_nop 1
    v_permlane32_swap_b32 v53, v52
    v_add_f32 v52, v52, v53
    v_mov_b32 v53, v52
    s_nop 1
    v_permlane16_swap_b32 v53, v52
    v_add_f32 v52, v52, v53
    v_rcp_f32 v52, v52
    s_nop 0
    v_pk_mul_f32 v[16:17], v[16:17], v[52:53] op_sel_hi:[1,0]
    v_pk_mul_f32 v[18:19], v[18:19], v[52:53] op_sel_hi:[1,0]
    v_pk_mul_f32 v[20:21], v[20:21], v[52:53] op_sel_hi:[1,0]
    v_pk_mul_f32 v[22:23], v[22:23], v[52:53] op_sel_hi:[1,0]
    v_pk_mul_f32 v[24:25], v[24:25], v[52:53] op_sel_hi:[1,0]
    v_cvt_pk_bf16_f32 v28, v16, v17
    v_cvt_pk_bf16_f32 v29, v18, v19
    v_cvt_pk_bf16_f32 v30, v20, v21
    v_cvt_pk_bf16_f32 v31, v22, v23
    v_cvt_pk_bf16_f32 v32, v24, v25
    s_cmp_lg_u32 s19, 0
    s_cbranch_scc1 L_slow_51
    buffer_store_dwordx4 v[28:31], v5, s[4:7], s30 offen
    buffer_store_dword v32, v14, s[4:7], s30 offen offset:1024
L_back_52:
    s_waitcnt vmcnt(0)
    s_mov_b64 exec, 1
    s_cmp_lg_u32 s19, 0
    s_cbranch_scc1 L_slow_53
    buffer_store_dword v13, v10, s[4:7], s45 offen
L_back_54:
    s_mov_b64 exec, -1
    s_add_u32 s20, s20, 1
    s_cmp_lt_u32 s20, 65
    s_cbranch_scc1 LQ_C2loop
    s_waitcnt vmcnt(0)
    s_endpgm
LQ_exit1:
    s_load_dwordx2 s[48:49], s[0:1], 64
    s_load_dwordx2 s[50:51], s[0:1], 80
    s_mov_b32 s10, 1966080
    s_mov_b32 s11, 0x20000
    v_add_u32 v9, 114688, v5
    v_bfe_u32 v6, v0, 2, 2
    v_lshlrev_b32 v12, 7, v6
    v_and_b32 v6, 3, v0
    v_lshl_add_u32 v12, v6, 3, v12
    v_add_u32 v12, 114688, v12
    v_lshrrev_b32 v13, 3, v0
    s_waitcnt lgkmcnt(0)
    s_barrier
    s_mov_b32 s20, 0
LQ_rl:
    s_lshl_b32 s21, s20, 5
    s_add_u32 s21, s21, s41
    s_cmp_lt_u32 s21, 480
    s_cbranch_scc0 LQ_rl2
    s_mul_i32 s24, s21, 2731
    s_lshr_b32 s24, s24, 16
    s_mul_i32 s25, s24, 24
    s_sub_u32 s25, s21, s25
    s_mov_b64 s[8:9], s[48:49]
    s_mov_b32 s26, 3072
    s_mov_b32 s28, 20480
    s_mov_b32 s27, 29884416
    s_mov_b32 s29, 1024
    s_mov_b32 s30, 512
    s_branch LQ_rlj
LQ_rl2:
    s_sub_u32 s21, s21, 480
    s_mul_i32 s24, s21, 6554
    s_lshr_b32 s24, s24, 16
    s_mul_i32 s25, s24, 10
    s_sub_u32 s25, s21, s25
    s_mov_b64 s[8:9], s[50:51]
    s_mov_b32 s26, 1280
    s_mov_b32 s28, 49152
    s_mov_b32 s27, 31850496
    s_mov_b32 s29, 512
    s_mov_b32 s30, 2048
LQ_rlj:
    s_mul_i32 s31, s25, s28
    s_lshl_b32 s31, s31, 2
    s_add_u32 s27, s27, s31
    s_lshl_b32 s31, s24, 10
    s_add_u32 s27, s27, s31
    s_lshl_b32 s31, s24, 5
    v_add_u32 v8, s31, v13
    v_mul_lo_u32 v8, v8, s26
    v_lshl_add_u32 v8, v3, 4, v8
    s_lshl_b32 s31, s25, 7
    s_lshl_b32 s32, s26, 3
    v_mul_lo_u32 v10, v1, s29
    v_add_u32 v10, v10, v12
    v_add_u32 v11, s30, v10
    s_barrier
    s_barrier
    s_sleep 5
    buffer_load_dwordx4 v[16:19], v8, s[8:11], s31 offen
    s_add_u32 s31, s31, s32
    buffer_load_dwordx4 v[20:23], v8, s[8:11], s31 offen
    s_add_u32 s31, s31, s32
    buffer_load_dwordx4 v[24:27], v8, s[8:11], s31 offen
    s_add_u32 s31, s31, s32
    buffer_load_dwordx4 v[28:31], v8, s[8:11], s31 offen
    s_cmp_eq_u32 s20, 0
    s_cbranch_scc1 LQ_rl0
    buffer_store_dwordx4 v[32:35], v5, s[4:7], s33 offen sc1
    s_add_u32 s33, s33, s34
    buffer_store_dwordx4 v[36:39], v5, s[4:7], s33 offen sc1
    s_add_u32 s33, s33, s34
    buffer_store_dwordx4 v[40:43], v5, s[4:7], s33 offen sc1
    s_add_u32 s33, s33, s34
    buffer_store_dwordx4 v[44:47], v5, s[4:7], s33 offen sc1
LQ_rl0:
    s_mov_b32 s33, s27
    s_mov_b32 s34, s28
    s_waitcnt vmcnt(0)
    ds_write_b128 v9, v[16:19] offset:0
    ds_write_b128 v9, v[20:23] offset:1024
    ds_write_b128 v9, v[24:27] offset:2048
    ds_write_b128 v9, v[28:31] offset:3072
    ds_read_b64_tr_b16 v[32:33], v10 offset:0
    ds_read_b64_tr_b16 v[34:35], v11 offset:0
    ds_read_b64_tr_b16 v[36:37], v10 offset:32
    ds_read_b64_tr_b16 v[38:39], v11 offset:32
    ds_read_b64_tr_b16 v[40:41], v10 offset:64
    ds_read_b64_tr_b16 v[42:43], v11 offset:64
    ds_read_b64_tr_b16 v[44:45], v10 offset:96
    ds_read_b64_tr_b16 v[46:47], v11 offset:96
    s_waitcnt lgkmcnt(0)
    s_add_u32 s20, s20, 1
    s_cmp_lt_u32 s20, 31
    s_cbranch_scc1 LQ_rl
    s_endpgm
LQ_C3:
    s_sub_u32 s21, s18, 20
    s_cmp_ge_u32 s21, 10
    s_cbranch_scc1 LM_end
    s_lshl_b32 s43, s21, 12
    s_add_u32 s43, s43, 4276224
    v_lshlrev_b32 v8, 6, v0
    s_mul_i32 s24, s17, 10
    s_add_u32 s24, s24, s21
    s_lshl_b32 s44, s24, 12
    s_add_u32 s44, s44, 20971520
    s_lshr_b32 s45, s24, 2
    s_and_b32 s46, s24, 3
    v_and_b32 v6, 1, v0
    v_lshlrev_b32 v6, 4, v6
    v_mov_b32 v7, 0x3f80
    v_lshlrev_b32 v6, v6, v7
    v_lshrrev_b32 v7, 1, v3
    v_cmp_eq_u32 vcc, 0, v7
    s_nop 1
    v_cndmask_b32 v16, 0, v6, vcc
    v_cmp_eq_u32 vcc, 1, v7
    s_nop 1
    v_cndmask_b32 v17, 0, v6, vcc
    v_cmp_eq_u32 vcc, 2, v7
    s_nop 1
    v_cndmask_b32 v18, 0, v6, vcc
    v_cmp_eq_u32 vcc, 3, v7
    s_nop 1
    v_cndmask_b32 v19, 0, v6, vcc
    v_and_b32 v6, 1, v1
    v_cmp_eq_u32 vcc, v6, v4
    s_nop 1
    v_cndmask_b32 v20, 0, v16, vcc
    v_cndmask_b32 v21, 0, v17, vcc
    v_cndmask_b32 v22, 0, v18, vcc
    v_cndmask_b32 v23, 0, v19, vcc
    s_load_dwordx2 s[8:9], s[0:1], 0
    s_mov_b32 s10, 2621440
    s_mov_b32 s11, 0x20000
    s_waitcnt lgkmcnt(0)
    v_and_b32 v6, 3, v2
    v_lshlrev_b32 v10, 3, v6
    v_and_b32 v6, 1, v1
    v_lshl_add_u32 v10, v6, 2, v10
    s_lshl_b32 s21, s45, 5
    v_add_u32 v10, s21, v10
    v_lshlrev_b32 v11, 2, v10
    v_lshrrev_b32 v6, 1, v1
    v_lshlrev_b32 v6, 2, v6
    v_lshrrev_b32 v7, 2, v2
    v_add_u32 v6, v6, v7
    s_lshl_b32 s21, s46, 3
    v_add_u32 v6, s21, v6
    v_and_b32 v7, 15, v6
    v_lshlrev_b32 v15, 4, v7
    v_and_b32 v7, 3, v2
    v_lshl_add_u32 v15, v7, 8, v15
    v_and_b32 v7, 1, v1
    v_lshl_add_u32 v15, v7, 3, v15
    s_lshr_b32 s21, s46, 1
    s_mul_i32 s21, s21, 20480
    s_lshl_b32 s24, s45, 10
    s_add_u32 s21, s21, s24
    v_add_u32 v15, s21, v15
    v_mul_u32_u24 v6, 1280, v6
    v_lshl_add_u32 v10, v10, 1, v6
    v_mov_b32 v28, -1
    v_mov_b32 v29, -1
    v_mov_b32 v30, -1
    v_mov_b32 v31, -1
    s_mov_b32 s21, s44
    s_add_u32 s24, s44, 2621440
LQ_armo:
    buffer_store_dwordx4 v[28:31], v5, s[4:7], s21 offen sc1
    buffer_store_dwordx4 v[28:31], v5, s[4:7], s21 offen offset:1024 sc1
    buffer_store_dwordx4 v[28:31], v5, s[4:7], s21 offen offset:2048 sc1
    buffer_store_dwordx4 v[28:31], v5, s[4:7], s21 offen offset:3072 sc1
    s_add_u32 s21, s21, 327680
    s_cmp_lt_u32 s21, s24
    s_cbranch_scc1 LQ_armo
    s_mov_b32 s21, 9191424
LQ_armx:
    buffer_store_dwordx2 v[28:29], v15, s[4:7], s21 offen sc1
    s_add_u32 s21, s21, 40960
    s_cmp_lt_u32 s21, 9437184
    s_cbranch_scc1 LQ_armx
    s_sub_u32 s47, s44, 20971520
    s_lshr_b32 s47, s47, 1
    s_add_u32 s47, s47, 11141120
    s_mov_b32 s24, 5120
    s_waitcnt vmcnt(0)
    s_barrier
    buffer_load_dwordx4 v[24:27], v11, s[4:7], s24 offen sc1
    buffer_load_dword v9, v8, s[4:7], s43 offen
    s_mov_b32 s20, 0
LQ_C3loop:
    s_cmp_gt_u32 s20, 63
    s_cbranch_scc1 LQ_C3nb
    s_barrier
    s_barrier
    s_sleep 5
    s_cmp_lt_u32 s20, 59
    s_cbranch_scc1 LQ_C3np
    s_cmp_eq_u32 s20, 63
    s_cbranch_scc1 LQ_C3nb
    s_sub_u32 s21, s20, 59
    s_mul_i32 s21, s21, 10
    s_add_u32 s21, s21, s18
    s_mul_i32 s21, s21, 49152
    s_add_u32 s21, s21, 28901376
    s_add_u32 s24, s21, 49152
    v_lshlrev_b32 v57, 7, v0
LQ_pf:
    buffer_load_dword v56, v57, s[4:7], s21 offen
    s_add_u32 s21, s21, 8192
    s_cmp_lt_u32 s21, s24
    s_cbranch_scc1 LQ_pf
    s_getpc_b64 s[48:49]
LQ_pc:
    s_add_u32 s48, s48, LM_tail-LQ_pc
    s_addc_u32 s49, s49, 0
    s_sub_u32 s21, s20, 59
    s_lshl_b32 s21, s21, 13
    v_add_u32 v57, s21, v57
    v_min_u32 v57, LM_codeend-LM_tail, v57
    global_load_dword v56, v57, s[48:49]
LQ_C3np:
    s_cmp_gt_u32 s20, 60
    s_cbranch_scc1 LQ_C3nb
    s_add_u32 s43, s43, 40960
    buffer_load_dword v9, v8, s[4:7], s43 offen
    s_cmp_gt_u32 s20, 58
    s_cbranch_scc1 LQ_C3nb
    buffer_store_dwordx4 v[28:31], v5, s[4:7], s47 offen sc1
    buffer_store_dwordx4 v[28:31], v5, s[4:7], s47 offen offset:1024 sc1
    s_add_u32 s47, s47, 163840
LQ_C3nb:
    s_cmp_lt_u32 s20, 4
    s_cbranch_scc1 LQ_C3skip
    s_sub_u32 s26, s20, 4
    s_and_b32 s21, s26, 7
    s_mul_i32 s28, s21, 327680
    s_add_u32 s28, s28, s44
    s_mul_i32 s29, s26, 40960
    s_add_u32 s30, s29, 6815744
    buffer_load_dwordx2 v[12:13], v10, s[8:11], s29 offen
    s_add_u32 s21, s26, 7
    s_and_b32 s21, s21, 7
    s_mul_i32 s31, s21, 327680
    s_add_u32 s31, s31, s44
    s_cmp_gt_u32 s20, 60
    s_cselect_b32 s31, 268435456, s31
    buffer_store_dwordx4 v[28:31], v5, s[4:7], s31 offen offset:0 sc1
    buffer_store_dwordx4 v[28:31], v5, s[4:7], s31 offen offset:1024 sc1
    buffer_store_dwordx4 v[28:31], v5, s[4:7], s31 offen offset:2048 sc1
    buffer_store_dwordx4 v[28:31], v5, s[4:7], s31 offen offset:3072 sc1
    buffer_load_dwordx4 v[32:35], v5, s[4:7], s28 offen offset:0 sc1
    buffer_load_dwordx4 v[36:39], v5, s[4:7], s28 offen offset:1024 sc1
    buffer_load_dwordx4 v[40:43], v5, s[4:7], s28 offen offset:2048 sc1
    buffer_load_dwordx4 v[44:47], v5, s[4:7], s28 offen offset:3072 sc1
    s_waitcnt vmcnt(3)
    v_max3_u32 v14, v32, v33, v34
    v_max_u32 v14, v14, v35
    v_mfma_f32_16x16x32_bf16 v[48:51], v[20:23], v[32:35], 0
    s_waitcnt vmcnt(2)
    v_max3_u32 v14, v14, v36, v37
    v_max3_u32 v14, v14, v38, v39
    v_mfma_f32_16x16x32_bf16 v[48:51], v[20:23], v[36:39], v[48:51]
    s_waitcnt vmcnt(1)
    v_max3_u32 v14, v14, v40, v41
    v_max3_u32 v14, v14, v42, v43
    v_mfma_f32_16x16x32_bf16 v[48:51], v[20:23], v[40:43], v[48:51]
    s_waitcnt vmcnt(0)
    v_max3_u32 v14, v14, v44, v45
    v_max3_u32 v14, v14, v46, v47
    v_mfma_f32_16x16x32_bf16 v[48:51], v[20:23], v[44:47], v[48:51]
    v_cmp_eq_u32 vcc, -1, v14
    s_cbranch_vccnz L_gr_55
L_gd_58:
    s_nop 1
    v_lshlrev_b32 v52, 16, v12
    v_and_b32 v53, 0xffff0000, v12
    v_lshlrev_b32 v54, 16, v13
    v_and_b32 v55, 0xffff0000, v13
    v_fma_f32 v52, v48, v24, v52
    v_fma_f32 v53, v49, v25, v53
    v_fma_f32 v54, v50, v26, v54
    v_fma_f32 v55, v51, v27, v55
    v_cvt_pk_bf16_f32 v52, v52, v53
    v_cvt_pk_bf16_f32 v53, v54, v55
    v_min_u32 v52, -2, v52
    v_min_u32 v53, -2, v53
    buffer_store_dwordx2 v[52:53], v15, s[4:7], s30 offen sc1
LQ_C3skip:
    s_waitcnt vmcnt(0)
    s_add_u32 s20, s20, 1
    s_cmp_lt_u32 s20, 68
    s_cbranch_scc1 LQ_C3loop
    s_endpgm
LM_VO:
    s_and_b32 s41, s16, 3
    s_mul_i32 s42, s41, 36864
    s_lshl_b32 s21, s17, 2
    s_add_u32 s41, s41, s21
    s_cmp_lt_u32 s16, 4
    s_cbranch_scc1 LV_Wpro
    s_load_dwordx2 s[8:9], s[0:1], 40
    s_mov_b32 s10, 7864320
    s_mov_b32 s11, 0x20000
    s_waitcnt lgkmcnt(0)
    s_load_dwordx2 s[12:13], s[0:1], 32
    s_mov_b32 s14, 7864320
    s_mov_b32 s15, 0x20000
    s_waitcnt lgkmcnt(0)
    v_lshrrev_b32 v6, 2, v0
    v_mul_u32_u24 v12, 1280, v6
    v_and_b32 v7, 3, v0
    v_lshl_add_u32 v12, v7, 4, v12
    s_mul_i32 s21, s41, 245760
    s_lshl_b32 s24, s18, 6
    s_add_u32 s21, s21, s24
    v_add_u32 v12, s21, v12
    s_add_u32 s24, s42, 24576
    s_mov_b32 s25, 0
LV_wo:
    s_mov_b32 m0, s24
    s_add_u32 s24, s24, 1024
    buffer_load_dwordx4 v12, s[8:11], s25 offen lds
    s_add_u32 s25, s25, 20480
    s_cmp_lt_u32 s25, 245760
    s_cbranch_scc1 LV_wo
    v_lshrrev_b32 v6, 3, v0
    s_mov_b32 s21, 12288
    v_mul_lo_u32 v6, v6, s21
    s_mul_i32 s21, s41, 384
    v_add_u32 v6, s21, v6
    v_lshrrev_b32 v7, 5, v0
    v_lshlrev_b32 v7, 1, v7
    v_xor_b32 v7, v7, v3
    v_xor_b32 v13, 0, v7
    v_lshl_add_u32 v8, v13, 4, v6
    v_add_u32 v8, 0, v8
    v_xor_b32 v13, 1, v7
    v_lshl_add_u32 v9, v13, 4, v6
    v_add_u32 v9, 98304, v9
    v_xor_b32 v13, 4, v7
    v_lshl_add_u32 v10, v13, 4, v6
    v_add_u32 v10, 196608, v10
    v_xor_b32 v13, 5, v7
    v_lshl_add_u32 v11, v13, 4, v6
    v_add_u32 v11, 294912, v11
    s_mov_b32 s28, 0
    s_mov_b32 s29, 0
LV_ld:
    s_mul_i32 s24, s18, 1
    s_add_u32 s24, s24, s28
    s_sub_u32 s21, s24, 20
    s_cmp_ge_u32 s24, 20
    s_cselect_b32 s24, s21, s24
    s_mul_i32 s24, s24, 393216
    s_add_u32 s25, s29, s42
    s_add_u32 m0, s25, 0
    s_nop 0
    buffer_load_dwordx4 v8, s[12:15], s24 offen offset:0 lds
    s_add_u32 m0, s25, 896
    s_nop 0
    buffer_load_dwordx4 v8, s[12:15], s24 offen offset:128 lds
    s_add_u32 m0, s25, 1792
    s_nop 0
    buffer_load_dwordx4 v8, s[12:15], s24 offen offset:256 lds
    s_add_u32 m0, s25, 3072
    s_nop 0
    buffer_load_dwordx4 v9, s[12:15], s24 offen offset:0 lds
    s_add_u32 m0, s25, 3968
    s_nop 0
    buffer_load_dwordx4 v9, s[12:15], s24 offen offset:128 lds
    s_add_u32 m0, s25, 4864
    s_nop 0
    buffer_load_dwordx4 v9, s[12:15], s24 offen offset:256 lds
    s_add_u32 m0, s25, 6144
    s_nop 0
    buffer_load_dwordx4 v10, s[12:15], s24 offen offset:0 lds
    s_add_u32 m0, s25, 7040
    s_nop 0
    buffer_load_dwordx4 v10, s[12:15], s24 offen offset:128 lds
    s_add_u32 m0, s25, 7936
    s_nop 0
    buffer_load_dwordx4 v10, s[12:15], s24 offen offset:256 lds
    s_add_u32 m0, s25, 9216
    s_nop 0
    buffer_load_dwordx4 v11, s[12:15], s24 offen offset:0 lds
    s_add_u32 m0, s25, 10112
    s_nop 0
    buffer_load_dwordx4 v11, s[12:15], s24 offen offset:128 lds
    s_add_u32 m0, s25, 11008
    s_nop 0
    buffer_load_dwordx4 v11, s[12:15], s24 offen offset:256 lds
    s_add_u32 s29, s29, 12288
    s_cmp_eq_u32 s29, 36864
    s_cselect_b32 s29, 0, s29
    s_add_u32 s28, s28, 1
    s_cmp_eq_u32 s28, 1
    s_cbranch_scc1 LV_ld
    s_waitcnt vmcnt(12)
    s_cmp_lg_u32 s28, 2
    s_cbranch_scc1 LV_ld2
    s_barrier
LV_ld2:
    s_barrier
    s_cmp_lt_u32 s28, 20
    s_cbranch_scc1 LV_ld
    s_waitcnt vmcnt(0)
    s_barrier
    s_cmp_lg_u32 s16, 7
    s_cbranch_scc1 LV_nomode
    v_and_b32 v6, 7, v0
    v_lshlrev_b32 v6, 5, v6
    s_mov_b32 s37, s38
L_pc_59:
    global_load_dword v7, v6, s[22:23] sc1
    s_waitcnt vmcnt(0)
    v_readlane_b32 s24, v7, 0
    v_readlane_b32 s25, v7, 1
    v_readlane_b32 s26, v7, 2
    v_readlane_b32 s27, v7, 3
    v_readlane_b32 s28, v7, 4
    v_readlane_b32 s29, v7, 5
    v_readlane_b32 s30, v7, 6
    v_readlane_b32 s31, v7, 7
    s_add_u32 s21, s24, s25
    s_add_u32 s21, s21, s26
    s_add_u32 s21, s21, s27
    s_add_u32 s21, s21, s28
    s_add_u32 s21, s21, s29
    s_add_u32 s21, s21, s30
    s_add_u32 s21, s21, s31
    s_lshr_b32 s21, s21, 16
    s_cmp_ge_u32 s21, 256
    s_cbranch_scc1 L_pcd_60
    s_sub_u32 s37, s37, 1
    s_cbranch_scc1 L_pcd_60
    s_sleep 8
    s_branch L_pc_59
L_pcd_60:
    s_and_b32 s24, s24, 0xffff
    s_and_b32 s25, s25, 0xffff
    s_and_b32 s26, s26, 0xffff
    s_and_b32 s27, s27, 0xffff
    s_and_b32 s28, s28, 0xffff
    s_and_b32 s29, s29, 0xffff
    s_and_b32 s30, s30, 0xffff
    s_and_b32 s31, s31, 0xffff
    s_mov_b32 s21, 0
    s_cmp_lg_u32 s24, 32
    s_cselect_b32 s21, 1, s21
    s_cmp_lg_u32 s25, 32
    s_cselect_b32 s21, 1, s21
    s_cmp_lg_u32 s26, 32
    s_cselect_b32 s21, 1, s21
    s_cmp_lg_u32 s27, 32
    s_cselect_b32 s21, 1, s21
    s_cmp_lg_u32 s28, 32
    s_cselect_b32 s21, 1, s21
    s_cmp_lg_u32 s29, 32
    s_cselect_b32 s21, 1, s21
    s_cmp_lg_u32 s30, 32
    s_cselect_b32 s21, 1, s21
    s_cmp_lg_u32 s31, 32
    s_cselect_b32 s21, 1, s21
    v_mov_b32 v6, 147456
    v_mov_b32 v7, s21
    ds_write_b32 v6, v7 offset:8
    s_waitcnt lgkmcnt(0)
    v_lshlrev_b32 v16, 7, v2
    v_add_u32 v16, 1101824, v16
    s_mov_b32 s21, 1
    s_mov_b32 s37, s38
L_f_61:
    buffer_load_dword v17, v16, s[4:7], 0 offen sc1
    s_waitcnt vmcnt(0)
    v_cmp_gt_u32 vcc, s21, v17
    s_cbranch_vccz L_fd_62
    s_sub_u32 s37, s37, 1
    s_cbranch_scc1 L_fd_62
    s_sleep 1
    s_branch L_f_61
L_fd_62:
    s_cmp_lt_i32 s37, 0
    s_cselect_b32 s38, 4, s38
LV_nomode:
    s_barrier
    s_cmp_eq_u32 s16, 6
    s_cbranch_scc1 LV_C2
    s_cmp_eq_u32 s16, 7
    s_cbranch_scc1 LV_C3
    s_branch LV_C01
LV_Wpro:
    v_bfe_u32 v6, v0, 2, 2
    v_lshl_add_u32 v94, v1, 3, v6
    v_lshlrev_b32 v94, 6, v94
    v_and_b32 v7, 3, v0
    v_lshl_add_u32 v94, v7, 4, v94
    s_add_u32 s21, s42, 24576
    v_add_u32 v94, s21, v94
    v_bfe_u32 v6, v0, 1, 1
    v_lshl_add_u32 v6, v4, 1, v6
    v_mul_u32_u24 v6, 3072, v6
    v_bfe_u32 v7, v0, 2, 1
    v_lshl_add_u32 v6, v7, 9, v6
    v_and_b32 v7, 1, v0
    v_lshl_add_u32 v6, v7, 7, v6
    v_bfe_u32 v7, v0, 1, 3
    v_xor_b32 v7, v7, v1
    v_lshl_add_u32 v6, v7, 4, v6
    v_add_u32 v6, s42, v6
    v_xor_b32 v7, 64, v6
    s_barrier
    ds_read_b64_tr_b16 v[8:9], v94 offset:0
    ds_read_b64_tr_b16 v[10:11], v94 offset:256
    ds_read_b64_tr_b16 v[12:13], v94 offset:2048
    ds_read_b64_tr_b16 v[14:15], v94 offset:2304
    ds_read_b64_tr_b16 v[16:17], v94 offset:4096
    ds_read_b64_tr_b16 v[18:19], v94 offset:4352
    ds_read_b64_tr_b16 v[20:21], v94 offset:6144
    ds_read_b64_tr_b16 v[22:23], v94 offset:6400
    ds_read_b64_tr_b16 v[24:25], v94 offset:8192
    ds_read_b64_tr_b16 v[26:27], v94 offset:8448
    ds_read_b64_tr_b16 v[28:29], v94 offset:10240
    ds_read_b64_tr_b16 v[30:31], v94 offset:10496
    ds_read_b64_tr_b16 v[32:33], v94 offset:8
    ds_read_b64_tr_b16 v[34:35], v94 offset:264
    ds_read_b64_tr_b16 v[36:37], v94 offset:2056
    ds_read_b64_tr_b16 v[38:39], v94 offset:2312
    ds_read_b64_tr_b16 v[40:41], v94 offset:4104
    ds_read_b64_tr_b16 v[42:43], v94 offset:4360
    ds_read_b64_tr_b16 v[44:45], v94 offset:6152
    ds_read_b64_tr_b16 v[46:47], v94 offset:6408
    ds_read_b64_tr_b16 v[48:49], v94 offset:8200
    ds_read_b64_tr_b16 v[50:51], v94 offset:8456
    ds_read_b64_tr_b16 v[52:53], v94 offset:10248
    ds_read_b64_tr_b16 v[54:55], v94 offset:10504
    s_mov_b32 s28, 0
    s_mov_b32 s29, 0
    s_waitcnt lgkmcnt(0)
LV_it:
    s_barrier
    v_add_u32 v2, s29, v6
    v_add_u32 v3, s29, v7
    ds_read_b128 v[56:59], v2 offset:0
    ds_read_b128 v[60:63], v3 offset:0
    ds_read_b128 v[64:67], v2 offset:1024
    ds_read_b128 v[68:71], v3 offset:1024
    ds_read_b128 v[72:75], v2 offset:2048
    ds_read_b128 v[76:79], v3 offset:2048
    s_mul_i32 s26, s18, 1
    s_add_u32 s26, s26, s28
    s_sub_u32 s21, s26, 20
    s_cmp_ge_u32 s26, 20
    s_cselect_b32 s26, s21, s26
    s_lshl_b32 s26, s26, 2
    s_add_u32 s29, s29, 12288
    s_cmp_eq_u32 s29, 36864
    s_cselect_b32 s29, 0, s29
    s_waitcnt lgkmcnt(5)
    v_mfma_f32_16x16x32_bf16 v[80:83], v[56:59], v[8:11], 0
    v_mfma_f32_16x16x32_bf16 v[88:91], v[56:59], v[32:35], 0
    ds_read_b128 v[56:59], v2 offset:256
    s_waitcnt lgkmcnt(5)
    v_mfma_f32_16x16x32_bf16 v[80:83], v[60:63], v[12:15], v[80:83]
    v_mfma_f32_16x16x32_bf16 v[88:91], v[60:63], v[36:39], v[88:91]
    ds_read_b128 v[60:63], v3 offset:256
    s_waitcnt lgkmcnt(5)
    v_mfma_f32_16x16x32_bf16 v[80:83], v[64:67], v[16:19], v[80:83]
    v_mfma_f32_16x16x32_bf16 v[88:91], v[64:67], v[40:43], v[88:91]
    ds_read_b128 v[64:67], v2 offset:1280
    s_waitcnt lgkmcnt(5)
    v_mfma_f32_16x16x32_bf16 v[80:83], v[68:71], v[20:23], v[80:83]
    v_mfma_f32_16x16x32_bf16 v[88:91], v[68:71], v[44:47], v[88:91]
    ds_read_b128 v[68:71], v3 offset:1280
    s_waitcnt lgkmcnt(5)
    v_mfma_f32_16x16x32_bf16 v[80:83], v[72:75], v[24:27], v[80:83]
    v_mfma_f32_16x16x32_bf16 v[88:91], v[72:75], v[48:51], v[88:91]
    ds_read_b128 v[72:75], v2 offset:2304
    s_waitcnt lgkmcnt(5)
    v_mfma_f32_16x16x32_bf16 v[80:83], v[76:79], v[28:31], v[80:83]
    v_mfma_f32_16x16x32_bf16 v[88:91], v[76:79], v[52:55], v[88:91]
    ds_read_b128 v[76:79], v3 offset:2304
    s_waitcnt lgkmcnt(5)
    v_mfma_f32_16x16x32_bf16 v[84:87], v[56:59], v[8:11], 0
    v_mfma_f32_16x16x32_bf16 v[92:95], v[56:59], v[32:35], 0
    s_waitcnt lgkmcnt(4)
    v_mfma_f32_16x16x32_bf16 v[84:87], v[60:63], v[12:15], v[84:87]
    v_mfma_f32_16x16x32_bf16 v[92:95], v[60:63], v[36:39], v[92:95]
    s_waitcnt lgkmcnt(3)
    v_mfma_f32_16x16x32_bf16 v[84:87], v[64:67], v[16:19], v[84:87]
    v_mfma_f32_16x16x32_bf16 v[92:95], v[64:67], v[40:43], v[92:95]
    s_waitcnt lgkmcnt(2)
    v_mfma_f32_16x16x32_bf16 v[84:87], v[68:71], v[20:23], v[84:87]
    v_mfma_f32_16x16x32_bf16 v[92:95], v[68:71], v[44:47], v[92:95]
    s_waitcnt lgkmcnt(1)
    v_mfma_f32_16x16x32_bf16 v[84:87], v[72:75], v[24:27], v[84:87]
    v_mfma_f32_16x16x32_bf16 v[92:95], v[72:75], v[48:51], v[92:95]
    s_waitcnt lgkmcnt(0)
    v_mfma_f32_16x16x32_bf16 v[84:87], v[76:79], v[28:31], v[84:87]
    v_mfma_f32_16x16x32_bf16 v[92:95], v[76:79], v[52:55], v[92:95]
    s_add_u32 s28, s28, 1
    s_nop 6
    v_cvt_pk_bf16_f32 v80, v80, v81
    v_cvt_pk_bf16_f32 v81, v82, v83
    v_cvt_pk_bf16_f32 v82, v84, v85
    v_cvt_pk_bf16_f32 v83, v86, v87
    v_cvt_pk_bf16_f32 v88, v88, v89
    v_cvt_pk_bf16_f32 v89, v90, v91
    v_cvt_pk_bf16_f32 v90, v92, v93
    v_cvt_pk_bf16_f32 v91, v94, v95
    s_set_gpr_idx_on s26, gpr_idx(DST)
    s_nop 0
    v_mov_b32 v96, v80
    v_mov_b32 v97, v81
    v_mov_b32 v98, v82
    v_mov_b32 v99, v83
    v_mov_b32 v176, v88
    v_mov_b32 v177, v89
    v_mov_b32 v178, v90
    v_mov_b32 v179, v91
    s_set_gpr_idx_off
    s_cmp_lt_u32 s28, 20
    s_cbranch_scc1 LV_it
    s_barrier
    v_lshrrev_b32 v1, 4, v0
    v_and_b32 v2, 15, v0
    v_and_b32 v3, 7, v0
    v_bfe_u32 v4, v0, 3, 1
    v_lshlrev_b32 v5, 4, v0
    s_lshl_b32 s21, s16, 10
    v_add_u32 v8, s21, v5
    v_add_u32 v9, 81920, v5
    v_mov_b32 v39, 0x4444
    v_mov_b32 v6, 0xeeee
    v_and_b32 v7, 2, v0
    v_cmp_ne_u32 vcc, 0, v7
    s_mul_i32 s21, s16, 10240
    s_nop 0
    v_cndmask_b32 v39, v39, v6, vcc
    v_mov_b32 v38, 147456
    v_add_u32 v15, s21, v5
    s_mul_i32 s40, s17, 10240
    s_add_u32 s40, s40, 1374208
    s_mov_b32 s28, 0
    s_mul_i32 s24, s28, 40960
    s_add_u32 s24, s24, 4194304
    s_and_b32 s25, s28, 1
    s_mul_i32 s25, s25, 40960
    s_mul_i32 s26, s16, 10240
    s_add_u32 s25, s25, s26
    s_add_u32 m0, s25, 0
    s_nop 0
    buffer_load_dwordx4 v15, s[4:7], s24 offen offset:0 lds
    buffer_load_dwordx4 v15, s[4:7], s24 offen offset:1024 lds
    buffer_load_dwordx4 v15, s[4:7], s24 offen offset:2048 lds
    buffer_load_dwordx4 v15, s[4:7], s24 offen offset:3072 lds
    s_add_u32 m0, s25, 4096
    s_add_u32 s24, s24, 4096
    buffer_load_dwordx4 v15, s[4:7], s24 offen offset:0 lds
    buffer_load_dwordx4 v15, s[4:7], s24 offen offset:1024 lds
    buffer_load_dwordx4 v15, s[4:7], s24 offen offset:2048 lds
    buffer_load_dwordx4 v15, s[4:7], s24 offen offset:3072 lds
    s_add_u32 m0, s25, 8192
    s_add_u32 s24, s24, 4096
    buffer_load_dwordx4 v15, s[4:7], s24 offen offset:0 lds
    buffer_load_dwordx4 v15, s[4:7], s24 offen offset:1024 lds
    s_mov_b32 s28, 1
    s_mul_i32 s24, s28, 40960
    s_add_u32 s24, s24, 4194304
    s_and_b32 s25, s28, 1
    s_mul_i32 s25, s25, 40960
    s_mul_i32 s26, s16, 10240
    s_add_u32 s25, s25, s26
    s_add_u32 m0, s25, 0
    s_nop 0
    buffer_load_dwordx4 v15, s[4:7], s24 offen offset:0 lds
    buffer_load_dwordx4 v15, s[4:7], s24 offen offset:1024 lds
    buffer_load_dwordx4 v15, s[4:7], s24 offen offset:2048 lds
    buffer_load_dwordx4 v15, s[4:7], s24 offen offset:3072 lds
    s_add_u32 m0, s25, 4096
    s_add_u32 s24, s24, 4096
    buffer_load_dwordx4 v15, s[4:7], s24 offen offset:0 lds
    buffer_load_dwordx4 v15, s[4:7], s24 offen offset:1024 lds
    buffer_load_dwordx4 v15, s[4:7], s24 offen offset:2048 lds
    buffer_load_dwordx4 v15, s[4:7], s24 offen offset:3072 lds
    s_add_u32 m0, s25, 8192
    s_add_u32 s24, s24, 4096
    buffer_load_dwordx4 v15, s[4:7], s24 offen offset:0 lds
    buffer_load_dwordx4 v15, s[4:7], s24 offen offset:1024 lds
    s_lshl_b32 s21, s16, 9
    s_add_u32 s21, s21, 124928
    v_lshlrev_b32 v6, 3, v0
    v_add_u32 v13, s21, v6
    s_lshl_b32 s21, s16, 11
    s_add_u32 s21, s21, 92160
    v_add_u32 v14, s21, v5
    v_add_u32 v37, 81920, v8
    s_lshl_b32 s21, s16, 2
    s_add_u32 s21, s21, 147456
    v_mov_b32 v36, s21
    s_waitcnt vmcnt(10)
    s_barrier
    s_mov_b32 s20, -1
    s_branch LV_Wtok
LV_Wloop:
    s_add_u32 s27, s20, 1
    v_mov_b32 v7, s27
    s_and_b32 s21, s20, 3
    s_mul_i32 s21, s21, 81920
    s_add_u32 s24, s21, s40
    s_add_u32 s25, s24, 4096
    s_add_u32 s26, s24, 8192
    v_mov_b32 v40, 0
    v_mov_b32 v41, 0
    v_mov_b32 v42, 0
    v_mov_b32 v43, 0
    v_mov_b32 v44, 0
    v_mov_b32 v45, 0
    v_mov_b32 v46, 0
    v_mov_b32 v47, 0
    s_setprio 2
    s_mov_b32 s37, s38
    s_branch L_lws_65
L_lw_63:
    s_sleep 1
L_lws_65:
    ds_read_b32 v16, v38 offset:20
    s_sub_u32 s37, s37, 1
    s_cbranch_scc1 L_lwd_64
    s_waitcnt lgkmcnt(0)
    v_cmp_gt_u32 vcc, s20, v16
    s_cbranch_vccnz L_lw_63
L_lwd_64:
    s_and_b32 s21, s20, 3
    s_lshl_b32 s21, s21, 11
    v_add_u32 v6, s21, v13
    s_cmp_eq_u32 s16, 1
    s_cbranch_scc1 LV_W1
    s_cmp_eq_u32 s16, 2
    s_cbranch_scc1 LV_W2
    s_cmp_eq_u32 s16, 3
    s_cbranch_scc1 LV_W3
LV_W0:
    buffer_load_dwordx4 v[56:59], v8, s[4:7], s24 offen offset:0 sc1
    buffer_load_dwordx4 v[72:75], v8, s[4:7], s25 offen offset:0 sc1
    buffer_load_dwordx4 v[88:91], v8, s[4:7], s26 offen offset:0 sc1
    s_waitcnt vmcnt(2)
    v_max3_u32 v11, v56, v57, v58
    v_max_u32 v11, v11, v59
    s_waitcnt vmcnt(1)
    v_max3_u32 v11, v11, v72, v73
    v_max3_u32 v11, v11, v74, v75
    s_waitcnt vmcnt(0)
    v_max3_u32 v11, v11, v88, v89
    v_max3_u32 v11, v11, v90, v91
    v_cmp_eq_u32 vcc, -1, v11
    s_cbranch_vccnz L_gr_66
L_gd_69:
    ds_write_b128 v9, v[56:59] offset:0
    ds_write_b128 v9, v[72:75] offset:4096
    ds_write_b128 v9, v[88:91] offset:8192
    v_smfmac_f32_16x16x64_bf16 v[40:43], v[56:59], v[96:103], v39
    v_smfmac_f32_16x16x64_bf16 v[44:47], v[56:59], v[176:183], v39
    v_smfmac_f32_16x16x64_bf16 v[40:43], v[72:75], v[128:135], v39
    v_smfmac_f32_16x16x64_bf16 v[44:47], v[72:75], v[208:215], v39
    s_waitcnt lgkmcnt(0)
    s_barrier
    ds_read_b128 v[60:63], v9 offset:1024
    ds_read_b128 v[64:67], v9 offset:2048
    ds_read_b128 v[68:71], v9 offset:3072
    ds_read_b128 v[76:79], v9 offset:5120
    ds_read_b128 v[80:83], v9 offset:6144
    ds_read_b128 v[84:87], v9 offset:7168
    ds_read_b128 v[92:95], v9 offset:9216
    v_smfmac_f32_16x16x64_bf16 v[40:43], v[88:91], v[160:167], v39
    v_smfmac_f32_16x16x64_bf16 v[44:47], v[88:91], v[240:247], v39
    s_waitcnt lgkmcnt(6)
    v_smfmac_f32_16x16x64_bf16 v[40:43], v[60:63], v[104:111], v39
    v_smfmac_f32_16x16x64_bf16 v[44:47], v[60:63], v[184:191], v39
    s_waitcnt lgkmcnt(5)
    v_smfmac_f32_16x16x64_bf16 v[40:43], v[64:67], v[112:119], v39
    v_smfmac_f32_16x16x64_bf16 v[44:47], v[64:67], v[192:199], v39
    s_waitcnt lgkmcnt(4)
    v_smfmac_f32_16x16x64_bf16 v[40:43], v[68:71], v[120:127], v39
    v_smfmac_f32_16x16x64_bf16 v[44:47], v[68:71], v[200:207], v39
    s_waitcnt lgkmcnt(3)
    v_smfmac_f32_16x16x64_bf16 v[40:43], v[76:79], v[136:143], v39
    v_smfmac_f32_16x16x64_bf16 v[44:47], v[76:79], v[216:223], v39
    s_waitcnt lgkmcnt(2)
    v_smfmac_f32_16x16x64_bf16 v[40:43], v[80:83], v[144:151], v39
    v_smfmac_f32_16x16x64_bf16 v[44:47], v[80:83], v[224:231], v39
    s_waitcnt lgkmcnt(1)
    v_smfmac_f32_16x16x64_bf16 v[40:43], v[84:87], v[152:159], v39
    v_smfmac_f32_16x16x64_bf16 v[44:47], v[84:87], v[232:239], v39
    s_waitcnt lgkmcnt(0)
    v_smfmac_f32_16x16x64_bf16 v[40:43], v[92:95], v[168:175], v39
    v_smfmac_f32_16x16x64_bf16 v[44:47], v[92:95], v[248:255], v39
    s_nop 5
    s_branch LV_Wjoin
LV_W1:
    buffer_load_dwordx4 v[60:63], v8, s[4:7], s24 offen offset:0 sc1
    buffer_load_dwordx4 v[76:79], v8, s[4:7], s25 offen offset:0 sc1
    buffer_load_dwordx4 v[92:95], v8, s[4:7], s26 offen offset:0 sc1
    s_waitcnt vmcnt(2)
    v_max3_u32 v11, v60, v61, v62
    v_max_u32 v11, v11, v63
    s_waitcnt vmcnt(1)
    v_max3_u32 v11, v11, v76, v77
    v_max3_u32 v11, v11, v78, v79
    s_waitcnt vmcnt(0)
    v_max3_u32 v11, v11, v92, v93
    v_max3_u32 v11, v11, v94, v95
    v_cmp_eq_u32 vcc, -1, v11
    s_cbranch_vccnz L_gr_70
L_gd_73:
    ds_write_b128 v9, v[60:63] offset:1024
    ds_write_b128 v9, v[76:79] offset:5120
    ds_write_b128 v9, v[92:95] offset:9216
    v_smfmac_f32_16x16x64_bf16 v[40:43], v[60:63], v[104:111], v39
    v_smfmac_f32_16x16x64_bf16 v[44:47], v[60:63], v[184:191], v39
    v_smfmac_f32_16x16x64_bf16 v[40:43], v[76:79], v[136:143], v39
    v_smfmac_f32_16x16x64_bf16 v[44:47], v[76:79], v[216:223], v39
    s_waitcnt lgkmcnt(0)
    s_barrier
    ds_read_b128 v[56:59], v9 offset:0
    ds_read_b128 v[64:67], v9 offset:2048
    ds_read_b128 v[68:71], v9 offset:3072
    ds_read_b128 v[72:75], v9 offset:4096
    ds_read_b128 v[80:83], v9 offset:6144
    ds_read_b128 v[84:87], v9 offset:7168
    ds_read_b128 v[88:91], v9 offset:8192
    v_smfmac_f32_16x16x64_bf16 v[40:43], v[92:95], v[168:175], v39
    v_smfmac_f32_16x16x64_bf16 v[44:47], v[92:95], v[248:255], v39
    s_waitcnt lgkmcnt(6)
    v_smfmac_f32_16x16x64_bf16 v[40:43], v[56:59], v[96:103], v39
    v_smfmac_f32_16x16x64_bf16 v[44:47], v[56:59], v[176:183], v39
    s_waitcnt lgkmcnt(5)
    v_smfmac_f32_16x16x64_bf16 v[40:43], v[64:67], v[112:119], v39
    v_smfmac_f32_16x16x64_bf16 v[44:47], v[64:67], v[192:199], v39
    s_waitcnt lgkmcnt(4)
    v_smfmac_f32_16x16x64_bf16 v[40:43], v[68:71], v[120:127], v39
    v_smfmac_f32_16x16x64_bf16 v[44:47], v[68:71], v[200:207], v39
    s_waitcnt lgkmcnt(3)
    v_smfmac_f32_16x16x64_bf16 v[40:43], v[72:75], v[128:135], v39
    v_smfmac_f32_16x16x64_bf16 v[44:47], v[72:75], v[208:215], v39
    s_waitcnt lgkmcnt(2)
    v_smfmac_f32_16x16x64_bf16 v[40:43], v[80:83], v[144:151], v39
    v_smfmac_f32_16x16x64_bf16 v[44:47], v[80:83], v[224:231], v39
    s_waitcnt lgkmcnt(1)
    v_smfmac_f32_16x16x64_bf16 v[40:43], v[84:87], v[152:159], v39
    v_smfmac_f32_16x16x64_bf16 v[44:47], v[84:87], v[232:239], v39
    s_waitcnt lgkmcnt(0)
    v_smfmac_f32_16x16x64_bf16 v[40:43], v[88:91], v[160:167], v39
    v_smfmac_f32_16x16x64_bf16 v[44:47], v[88:91], v[240:247], v39
    s_nop 5
    s_branch LV_Wjoin
LV_W2:
    buffer_load_dwordx4 v[64:67], v8, s[4:7], s24 offen offset:0 sc1
    buffer_load_dwordx4 v[80:83], v8, s[4:7], s25 offen offset:0 sc1
    s_waitcnt vmcnt(1)
    v_max3_u32 v11, v64, v65, v66
    v_max_u32 v11, v11, v67
    s_waitcnt vmcnt(0)
    v_max3_u32 v11, v11, v80, v81
    v_max3_u32 v11, v11, v82, v83
    v_cmp_eq_u32 vcc, -1, v11
    s_cbranch_vccnz L_gr_74
L_gd_77:
    ds_write_b128 v9, v[64:67] offset:2048
    ds_write_b128 v9, v[80:83] offset:6144
    v_smfmac_f32_16x16x64_bf16 v[40:43], v[64:67], v[112:119], v39
    v_smfmac_f32_16x16x64_bf16 v[44:47], v[64:67], v[192:199], v39
    s_waitcnt lgkmcnt(0)
    s_barrier
    ds_read_b128 v[56:59], v9 offset:0
    ds_read_b128 v[60:63], v9 offset:1024
    ds_read_b128 v[68:71], v9 offset:3072
    ds_read_b128 v[72:75], v9 offset:4096
    ds_read_b128 v[76:79], v9 offset:5120
    ds_read_b128 v[84:87], v9 offset:7168
    ds_read_b128 v[88:91], v9 offset:8192
    ds_read_b128 v[92:95], v9 offset:9216
    v_smfmac_f32_16x16x64_bf16 v[40:43], v[80:83], v[144:151], v39
    v_smfmac_f32_16x16x64_bf16 v[44:47], v[80:83], v[224:231], v39
    s_waitcnt lgkmcnt(7)
    v_smfmac_f32_16x16x64_bf16 v[40:43], v[56:59], v[96:103], v39
    v_smfmac_f32_16x16x64_bf16 v[44:47], v[56:59], v[176:183], v39
    s_waitcnt lgkmcnt(6)
    v_smfmac_f32_16x16x64_bf16 v[40:43], v[60:63], v[104:111], v39
    v_smfmac_f32_16x16x64_bf16 v[44:47], v[60:63], v[184:191], v39
    s_waitcnt lgkmcnt(5)
    v_smfmac_f32_16x16x64_bf16 v[40:43], v[68:71], v[120:127], v39
    v_smfmac_f32_16x16x64_bf16 v[44:47], v[68:71], v[200:207], v39
    s_waitcnt lgkmcnt(4)
    v_smfmac_f32_16x16x64_bf16 v[40:43], v[72:75], v[128:135], v39
    v_smfmac_f32_16x16x64_bf16 v[44:47], v[72:75], v[208:215], v39
    s_waitcnt lgkmcnt(3)
    v_smfmac_f32_16x16x64_bf16 v[40:43], v[76:79], v[136:143], v39
    v_smfmac_f32_16x16x64_bf16 v[44:47], v[76:79], v[216:223], v39
    s_waitcnt lgkmcnt(2)
    v_smfmac_f32_16x16x64_bf16 v[40:43], v[84:87], v[152:159], v39
    v_smfmac_f32_16x16x64_bf16 v[44:47], v[84:87], v[232:239], v39
    s_waitcnt lgkmcnt(1)
    v_smfmac_f32_16x16x64_bf16 v[40:43], v[88:91], v[160:167], v39
    v_smfmac_f32_16x16x64_bf16 v[44:47], v[88:91], v[240:247], v39
    s_waitcnt lgkmcnt(0)
    v_smfmac_f32_16x16x64_bf16 v[40:43], v[92:95], v[168:175], v39
    v_smfmac_f32_16x16x64_bf16 v[44:47], v[92:95], v[248:255], v39
    s_nop 5
    s_branch LV_Wjoin
LV_W3:
    buffer_load_dwordx4 v[68:71], v8, s[4:7], s24 offen offset:0 sc1
    buffer_load_dwordx4 v[84:87], v8, s[4:7], s25 offen offset:0 sc1
    s_waitcnt vmcnt(1)
    v_max3_u32 v11, v68, v69, v70
    v_max_u32 v11, v11, v71
    s_waitcnt vmcnt(0)
    v_max3_u32 v11, v11, v84, v85
    v_max3_u32 v11, v11, v86, v87
    v_cmp_eq_u32 vcc, -1, v11
    s_cbranch_vccnz L_gr_78
L_gd_81:
    ds_write_b128 v9, v[68:71] offset:3072
    ds_write_b128 v9, v[84:87] offset:7168
    v_smfmac_f32_16x16x64_bf16 v[40:43], v[68:71], v[120:127], v39
    v_smfmac_f32_16x16x64_bf16 v[44:47], v[68:71], v[200:207], v39
    s_waitcnt lgkmcnt(0)
    s_barrier
    ds_read_b128 v[56:59], v9 offset:0
    ds_read_b128 v[60:63], v9 offset:1024
    ds_read_b128 v[64:67], v9 offset:2048
    ds_read_b128 v[72:75], v9 offset:4096
    ds_read_b128 v[76:79], v9 offset:5120
    ds_read_b128 v[80:83], v9 offset:6144
    ds_read_b128 v[88:91], v9 offset:8192
    ds_read_b128 v[92:95], v9 offset:9216
    v_smfmac_f32_16x16x64_bf16 v[40:43], v[84:87], v[152:159], v39
    v_smfmac_f32_16x16x64_bf16 v[44:47], v[84:87], v[232:239], v39
    s_waitcnt lgkmcnt(7)
    v_smfmac_f32_16x16x64_bf16 v[40:43], v[56:59], v[96:103], v39
    v_smfmac_f32_16x16x64_bf16 v[44:47], v[56:59], v[176:183], v39
    s_waitcnt lgkmcnt(6)
    v_smfmac_f32_16x16x64_bf16 v[40:43], v[60:63], v[104:111], v39
    v_smfmac_f32_16x16x64_bf16 v[44:47], v[60:63], v[184:191], v39
    s_waitcnt lgkmcnt(5)
    v_smfmac_f32_16x16x64_bf16 v[40:43], v[64:67], v[112:119], v39
    v_smfmac_f32_16x16x64_bf16 v[44:47], v[64:67], v[192:199], v39
    s_waitcnt lgkmcnt(4)
    v_smfmac_f32_16x16x64_bf16 v[40:43], v[72:75], v[128:135], v39
    v_smfmac_f32_16x16x64_bf16 v[44:47], v[72:75], v[208:215], v39
    s_waitcnt lgkmcnt(3)
    v_smfmac_f32_16x16x64_bf16 v[40:43], v[76:79], v[136:143], v39
    v_smfmac_f32_16x16x64_bf16 v[44:47], v[76:79], v[216:223], v39
    s_waitcnt lgkmcnt(2)
    v_smfmac_f32_16x16x64_bf16 v[40:43], v[80:83], v[144:151], v39
    v_smfmac_f32_16x16x64_bf16 v[44:47], v[80:83], v[224:231], v39
    s_waitcnt lgkmcnt(1)
    v_smfmac_f32_16x16x64_bf16 v[40:43], v[88:91], v[160:167], v39
    v_smfmac_f32_16x16x64_bf16 v[44:47], v[88:91], v[240:247], v39
    s_waitcnt lgkmcnt(0)
    v_smfmac_f32_16x16x64_bf16 v[40:43], v[92:95], v[168:175], v39
    v_smfmac_f32_16x16x64_bf16 v[44:47], v[92:95], v[248:255], v39
    s_nop 6
LV_Wjoin:
    v_pk_add_f32 v[40:41], v[40:41], v[42:43]
    v_pk_add_f32 v[44:45], v[44:45], v[46:47]
    v_cvt_pk_bf16_f32 v40, v40, v41
    v_cvt_pk_bf16_f32 v41, v44, v45
    ds_write_b64 v6, v[40:41]
    ds_write_b32 v36, v7 offset:48
    s_waitcnt vmcnt(0)
    s_cmp_eq_u32 s20, 63
    s_cbranch_scc1 LV_Wend
LV_Wtok:
    s_add_u32 s21, s20, 1
    s_and_b32 s27, s21, 1
    s_mul_i32 s24, s27, 40960
    v_add_u32 v10, s24, v5
    s_setprio 0
    ds_read_b128 v[56:59], v10 offset:0
    ds_read_b128 v[60:63], v10 offset:20480
    ds_read_b128 v[64:67], v10 offset:1024
    ds_read_b128 v[68:71], v10 offset:21504
    ds_read_b128 v[72:75], v10 offset:2048
    ds_read_b128 v[76:79], v10 offset:22528
    ds_read_b128 v[80:83], v10 offset:3072
    ds_read_b128 v[84:87], v10 offset:23552
    ds_read_b128 v[88:91], v10 offset:4096
    ds_read_b128 v[92:95], v10 offset:24576
    s_waitcnt lgkmcnt(8)
    v_mfma_f32_16x16x32_bf16 v[40:43], v[56:59], v[96:99], 0
    v_mfma_f32_16x16x32_bf16 v[48:51], v[56:59], v[176:179], 0
    v_mfma_f32_16x16x32_bf16 v[44:47], v[60:63], v[96:99], 0
    v_mfma_f32_16x16x32_bf16 v[52:55], v[60:63], v[176:179], 0
    ds_read_b128 v[56:59], v10 offset:5120
    ds_read_b128 v[60:63], v10 offset:25600
    s_waitcnt lgkmcnt(8)
    v_mfma_f32_16x16x32_bf16 v[40:43], v[64:67], v[100:103], v[40:43]
    v_mfma_f32_16x16x32_bf16 v[48:51], v[64:67], v[180:183], v[48:51]
    v_mfma_f32_16x16x32_bf16 v[44:47], v[68:71], v[100:103], v[44:47]
    v_mfma_f32_16x16x32_bf16 v[52:55], v[68:71], v[180:183], v[52:55]
    ds_read_b128 v[64:67], v10 offset:6144
    ds_read_b128 v[68:71], v10 offset:26624
    s_waitcnt lgkmcnt(8)
    v_mfma_f32_16x16x32_bf16 v[40:43], v[72:75], v[104:107], v[40:43]
    v_mfma_f32_16x16x32_bf16 v[48:51], v[72:75], v[184:187], v[48:51]
    v_mfma_f32_16x16x32_bf16 v[44:47], v[76:79], v[104:107], v[44:47]
    v_mfma_f32_16x16x32_bf16 v[52:55], v[76:79], v[184:187], v[52:55]
    ds_read_b128 v[72:75], v10 offset:7168
    ds_read_b128 v[76:79], v10 offset:27648
    s_waitcnt lgkmcnt(8)
    v_mfma_f32_16x16x32_bf16 v[40:43], v[80:83], v[108:111], v[40:43]
    v_mfma_f32_16x16x32_bf16 v[48:51], v[80:83], v[188:191], v[48:51]
    v_mfma_f32_16x16x32_bf16 v[44:47], v[84:87], v[108:111], v[44:47]
    v_mfma_f32_16x16x32_bf16 v[52:55], v[84:87], v[188:191], v[52:55]
    ds_read_b128 v[80:83], v10 offset:8192
    ds_read_b128 v[84:87], v10 offset:28672
    s_waitcnt lgkmcnt(8)
    v_mfma_f32_16x16x32_bf16 v[40:43], v[88:91], v[112:115], v[40:43]
    v_mfma_f32_16x16x32_bf16 v[48:51], v[88:91], v[192:195], v[48:51]
    v_mfma_f32_16x16x32_bf16 v[44:47], v[92:95], v[112:115], v[44:47]
    v_mfma_f32_16x16x32_bf16 v[52:55], v[92:95], v[192:195], v[52:55]
    ds_read_b128 v[88:91], v10 offset:9216
    ds_read_b128 v[92:95], v10 offset:29696
    s_waitcnt lgkmcnt(8)
    v_mfma_f32_16x16x32_bf16 v[40:43], v[56:59], v[116:119], v[40:43]
    v_mfma_f32_16x16x32_bf16 v[48:51], v[56:59], v[196:199], v[48:51]
    v_mfma_f32_16x16x32_bf16 v[44:47], v[60:63], v[116:119], v[44:47]
    v_mfma_f32_16x16x32_bf16 v[52:55], v[60:63], v[196:199], v[52:55]
    ds_read_b128 v[56:59], v10 offset:10240
    ds_read_b128 v[60:63], v10 offset:30720
    s_waitcnt lgkmcnt(8)
    v_mfma_f32_16x16x32_bf16 v[40:43], v[64:67], v[120:123], v[40:43]
    v_mfma_f32_16x16x32_bf16 v[48:51], v[64:67], v[200:203], v[48:51]
    v_mfma_f32_16x16x32_bf16 v[44:47], v[68:71], v[120:123], v[44:47]
    v_mfma_f32_16x16x32_bf16 v[52:55], v[68:71], v[200:203], v[52:55]
    ds_read_b128 v[64:67], v10 offset:11264
    ds_read_b128 v[68:71], v10 offset:31744
    s_waitcnt lgkmcnt(8)
    v_mfma_f32_16x16x32_bf16 v[40:43], v[72:75], v[124:127], v[40:43]
    v_mfma_f32_16x16x32_bf16 v[48:51], v[72:75], v[204:207], v[48:51]
    v_mfma_f32_16x16x32_bf16 v[44:47], v[76:79], v[124:127], v[44:47]
    v_mfma_f32_16x16x32_bf16 v[52:55], v[76:79], v[204:207], v[52:55]
    s_cmp_ge_u32 s16, 2
    s_cbranch_scc1 LV_nopause
    s_mov_b32 s37, s38
    s_branch L_lws_84
L_lw_82:
    s_sleep 1
L_lws_84:
    ds_read_b32 v16, v38 offset:28
    s_sub_u32 s37, s37, 1
    s_cbranch_scc1 L_lwd_83
    s_waitcnt lgkmcnt(0)
    v_cmp_gt_u32 vcc, s21, v16
    s_cbranch_vccnz L_lw_82
L_lwd_83:
LV_nopause:
    ds_read_b128 v[72:75], v10 offset:12288
    ds_read_b128 v[76:79], v10 offset:32768
    s_waitcnt lgkmcnt(8)
    v_mfma_f32_16x16x32_bf16 v[40:43], v[80:83], v[128:131], v[40:43]
    v_mfma_f32_16x16x32_bf16 v[48:51], v[80:83], v[208:211], v[48:51]
    v_mfma_f32_16x16x32_bf16 v[44:47], v[84:87], v[128:131], v[44:47]
    v_mfma_f32_16x16x32_bf16 v[52:55], v[84:87], v[208:211], v[52:55]
    ds_read_b128 v[80:83], v10 offset:13312
    ds_read_b128 v[84:87], v10 offset:33792
    s_waitcnt lgkmcnt(8)
    v_mfma_f32_16x16x32_bf16 v[40:43], v[88:91], v[132:135], v[40:43]
    v_mfma_f32_16x16x32_bf16 v[48:51], v[88:91], v[212:215], v[48:51]
    v_mfma_f32_16x16x32_bf16 v[44:47], v[92:95], v[132:135], v[44:47]
    v_mfma_f32_16x16x32_bf16 v[52:55], v[92:95], v[212:215], v[52:55]
    ds_read_b128 v[88:91], v10 offset:14336
    ds_read_b128 v[92:95], v10 offset:34816
    s_waitcnt lgkmcnt(8)
    v_mfma_f32_16x16x32_bf16 v[40:43], v[56:59], v[136:139], v[40:43]
    v_mfma_f32_16x16x32_bf16 v[48:51], v[56:59], v[216:219], v[48:51]
    v_mfma_f32_16x16x32_bf16 v[44:47], v[60:63], v[136:139], v[44:47]
    v_mfma_f32_16x16x32_bf16 v[52:55], v[60:63], v[216:219], v[52:55]
    ds_read_b128 v[56:59], v10 offset:15360
    ds_read_b128 v[60:63], v10 offset:35840
    s_waitcnt lgkmcnt(8)
    v_mfma_f32_16x16x32_bf16 v[40:43], v[64:67], v[140:143], v[40:43]
    v_mfma_f32_16x16x32_bf16 v[48:51], v[64:67], v[220:223], v[48:51]
    v_mfma_f32_16x16x32_bf16 v[44:47], v[68:71], v[140:143], v[44:47]
    v_mfma_f32_16x16x32_bf16 v[52:55], v[68:71], v[220:223], v[52:55]
    ds_read_b128 v[64:67], v10 offset:16384
    ds_read_b128 v[68:71], v10 offset:36864
    s_waitcnt lgkmcnt(8)
    v_mfma_f32_16x16x32_bf16 v[40:43], v[72:75], v[144:147], v[40:43]
    v_mfma_f32_16x16x32_bf16 v[48:51], v[72:75], v[224:227], v[48:51]
    v_mfma_f32_16x16x32_bf16 v[44:47], v[76:79], v[144:147], v[44:47]
    v_mfma_f32_16x16x32_bf16 v[52:55], v[76:79], v[224:227], v[52:55]
    ds_read_b128 v[72:75], v10 offset:17408
    ds_read_b128 v[76:79], v10 offset:37888
    s_waitcnt lgkmcnt(8)
    v_mfma_f32_16x16x32_bf16 v[40:43], v[80:83], v[148:151], v[40:43]
    v_mfma_f32_16x16x32_bf16 v[48:51], v[80:83], v[228:231], v[48:51]
    v_mfma_f32_16x16x32_bf16 v[44:47], v[84:87], v[148:151], v[44:47]
    v_mfma_f32_16x16x32_bf16 v[52:55], v[84:87], v[228:231], v[52:55]
    ds_read_b128 v[80:83], v10 offset:18432
    ds_read_b128 v[84:87], v10 offset:38912
    s_waitcnt lgkmcnt(8)
    v_mfma_f32_16x16x32_bf16 v[40:43], v[88:91], v[152:155], v[40:43]
    v_mfma_f32_16x16x32_bf16 v[48:51], v[88:91], v[232:235], v[48:51]
    v_mfma_f32_16x16x32_bf16 v[44:47], v[92:95], v[152:155], v[44:47]
    v_mfma_f32_16x16x32_bf16 v[52:55], v[92:95], v[232:235], v[52:55]
    ds_read_b128 v[88:91], v10 offset:19456
    ds_read_b128 v[92:95], v10 offset:39936
    s_waitcnt lgkmcnt(8)
    v_mfma_f32_16x16x32_bf16 v[40:43], v[56:59], v[156:159], v[40:43]
    v_mfma_f32_16x16x32_bf16 v[48:51], v[56:59], v[236:239], v[48:51]
    v_mfma_f32_16x16x32_bf16 v[44:47], v[60:63], v[156:159], v[44:47]
    v_mfma_f32_16x16x32_bf16 v[52:55], v[60:63], v[236:239], v[52:55]
    s_waitcnt lgkmcnt(6)
    v_mfma_f32_16x16x32_bf16 v[40:43], v[64:67], v[160:163], v[40:43]
    v_mfma_f32_16x16x32_bf16 v[48:51], v[64:67], v[240:243], v[48:51]
    v_mfma_f32_16x16x32_bf16 v[44:47], v[68:71], v[160:163], v[44:47]
    v_mfma_f32_16x16x32_bf16 v[52:55], v[68:71], v[240:243], v[52:55]
    s_waitcnt lgkmcnt(4)
    v_mfma_f32_16x16x32_bf16 v[40:43], v[72:75], v[164:167], v[40:43]
    v_mfma_f32_16x16x32_bf16 v[48:51], v[72:75], v[244:247], v[48:51]
    v_mfma_f32_16x16x32_bf16 v[44:47], v[76:79], v[164:167], v[44:47]
    v_mfma_f32_16x16x32_bf16 v[52:55], v[76:79], v[244:247], v[52:55]
    s_waitcnt lgkmcnt(2)
    v_mfma_f32_16x16x32_bf16 v[40:43], v[80:83], v[168:171], v[40:43]
    v_mfma_f32_16x16x32_bf16 v[48:51], v[80:83], v[248:251], v[48:51]
    v_mfma_f32_16x16x32_bf16 v[44:47], v[84:87], v[168:171], v[44:47]
    v_mfma_f32_16x16x32_bf16 v[52:55], v[84:87], v[248:251], v[52:55]
    s_waitcnt lgkmcnt(0)
    v_mfma_f32_16x16x32_bf16 v[40:43], v[88:91], v[172:175], v[40:43]
    v_mfma_f32_16x16x32_bf16 v[48:51], v[88:91], v[252:255], v[48:51]
    v_mfma_f32_16x16x32_bf16 v[44:47], v[92:95], v[172:175], v[44:47]
    v_mfma_f32_16x16x32_bf16 v[52:55], v[92:95], v[252:255], v[52:55]
    s_nop 7
    s_and_b32 s21, s21, 3
    s_lshl_b32 s21, s21, 13
    v_add_u32 v6, s21, v14
    v_cvt_pk_bf16_f32 v40, v40, v41
    v_cvt_pk_bf16_f32 v41, v42, v43
    v_cvt_pk_bf16_f32 v42, v44, v45
    v_cvt_pk_bf16_f32 v43, v46, v47
    ds_write_b128 v6, v[40:43] offset:0
    v_cvt_pk_bf16_f32 v48, v48, v49
    v_cvt_pk_bf16_f32 v49, v50, v51
    v_cvt_pk_bf16_f32 v50, v52, v53
    v_cvt_pk_bf16_f32 v51, v54, v55
    ds_write_b128 v6, v[48:51] offset:1024
    s_waitcnt lgkmcnt(0)
    s_cmp_lt_i32 s37, 0
    s_cselect_b32 s38, 4, s38
    s_add_u32 s20, s20, 1
    s_branch LV_Wloop
LV_Wend:
    s_waitcnt vmcnt(0) lgkmcnt(0)
    s_branch LM_tail
LV_C01:
    s_setprio 3
    v_and_b32 v6, 1, v0
    v_lshlrev_b32 v6, 4, v6
    v_mov_b32 v7, 0x3f80
    v_lshlrev_b32 v6, v6, v7
    v_lshrrev_b32 v7, 1, v3
    v_cmp_eq_u32 vcc, 0, v7
    s_nop 1
    v_cndmask_b32 v16, 0, v6, vcc
    v_cmp_eq_u32 vcc, 1, v7
    s_nop 1
    v_cndmask_b32 v17, 0, v6, vcc
    v_cmp_eq_u32 vcc, 2, v7
    s_nop 1
    v_cndmask_b32 v18, 0, v6, vcc
    v_cmp_eq_u32 vcc, 3, v7
    s_nop 1
    v_cndmask_b32 v19, 0, v6, vcc
    v_and_b32 v6, 1, v1
    v_cmp_eq_u32 vcc, v6, v4
    s_nop 1
    v_cndmask_b32 v20, 0, v16, vcc
    v_cndmask_b32 v21, 0, v17, vcc
    v_cndmask_b32 v22, 0, v18, vcc
    v_cndmask_b32 v23, 0, v19, vcc
    v_cmp_gt_u32 vcc, 2, v1
    s_nop 1
    v_cndmask_b32 v24, 0, v20, vcc
    v_cndmask_b32 v25, 0, v21, vcc
    v_cndmask_b32 v26, 0, v22, vcc
    v_cndmask_b32 v27, 0, v23, vcc
    v_cmp_le_u32 vcc, 2, v1
    s_nop 1
    v_cndmask_b32 v28, 0, v20, vcc
    v_cndmask_b32 v29, 0, v21, vcc
    v_cndmask_b32 v30, 0, v22, vcc
    v_cndmask_b32 v31, 0, v23, vcc
    v_and_b32 v6, 1, v0
    v_lshlrev_b32 v6, 4, v6
    v_mov_b32 v7, 0x3f80
    v_lshlrev_b32 v6, v6, v7
    v_bfe_u32 v7, v0, 1, 3
    v_cmp_eq_u32 vcc, 0, v7
    s_nop 1
    v_cndmask_b32 v16, 0, v6, vcc
    v_cmp_eq_u32 vcc, 2, v7
    s_nop 1
    v_cndmask_b32 v17, 0, v6, vcc
    v_cmp_eq_u32 vcc, 4, v7
    s_nop 1
    v_cndmask_b32 v18, 0, v6, vcc
    v_cmp_eq_u32 vcc, 6, v7
    s_nop 1
    v_cndmask_b32 v19, 0, v6, vcc
    s_sub_u32 s41, s16, 4
    v_cmp_eq_u32 vcc, 3, v1
    v_mov_b32 v6, 0x40000000
    s_nop 0
    v_cndmask_b32 v8, v5, v6, vcc
    s_lshl_b32 s43, s17, 13
    s_lshl_b32 s21, s41, 12
    s_add_u32 s43, s43, s21
    s_add_u32 s43, s43, 1112064
    v_cmp_eq_u32 s[44:45], 1, v4
    v_cmp_eq_u32 s[64:65], 0, v4
    s_mov_b32 s66, 1037384597
    s_mov_b32 s67, 1037384597
    v_mov_b32 v88, 0x3f803f80
    v_mov_b32 v89, 0x3f803f80
    v_mov_b32 v90, 0x3f803f80
    v_mov_b32 v91, 0x3f803f80
    v_mov_b32 v65, 0
    v_mov_b32 v66, 0
    v_lshl_add_u32 v6, v1, 3, v3
    v_lshlrev_b32 v120, 4, v6
    v_lshl_add_u32 v120, v4, 3, v120
    v_lshrrev_b32 v6, 1, v1
    v_lshlrev_b32 v121, 4, v6
    v_bfe_u32 v6, v0, 1, 2
    v_lshl_add_u32 v121, v6, 2, v121
    v_lshl_add_u32 v121, v4, 1, v121
    v_and_b32 v6, 1, v0
    v_add_u32 v121, v121, v6
    v_lshlrev_b32 v121, 4, v121
    v_and_b32 v6, 1, v1
    v_lshl_add_u32 v121, v6, 3, v121
    v_add_u32 v122, 133120, v5
    v_mov_b32 v123, 147456
    s_lshr_b32 s21, s18, 1
    s_lshl_b32 s46, s21, 14
    s_and_b32 s21, s18, 1
    s_lshl_b32 s21, s21, 12
    s_add_u32 s46, s46, s21
    s_add_u32 s46, s46, 10485760
    s_lshl_b32 s47, s17, 9
    s_mul_i32 s48, s17, 10240
    s_lshl_b32 s21, s18, 9
    s_add_u32 s48, s48, s21
    s_add_u32 s48, s48, 1374208
    v_mov_b32 v124, -1
    v_mov_b32 v125, -1
    s_mul_i32 s21, s17, 81920
    s_add_u32 s21, s21, 409600
    s_mul_i32 s24, s18, 2560
    s_add_u32 s24, s24, s21
    v_lshlrev_b32 v6, 7, v0
    v_add_u32 v148, s24, v6
    s_mov_b64 s[68:69], 0xfff
    s_lshl_b32 s24, s18, 7
    s_add_u32 s24, s24, s21
    s_add_u32 s24, s24, 51200
    v_mul_u32_u24 v149, 2560, v0
    v_add_u32 v149, s24, v149
    v_mov_b32 v7, 0x40000000
    v_cmp_gt_u32 vcc, 12, v0
    s_mul_i32 s24, s17, 20
    s_add_u32 s24, s24, s18
    v_cndmask_b32 v149, v7, v149, vcc
    s_lshr_b32 s51, s24, 3
    s_lshl_b32 s51, s51, 14
    s_and_b32 s24, s24, 7
    s_lshl_b32 s24, s24, 10
    s_add_u32 s51, s51, s24
    s_add_u32 s51, s51, 81920
    v_mul_u32_u24 v6, 20, v3
    v_add_u32 v6, s18, v6
    v_lshrrev_b32 v150, 3, v6
    v_lshlrev_b32 v150, 14, v150
    v_and_b32 v6, 7, v6
    v_lshl_add_u32 v150, v6, 10, v150
    v_lshl_add_u32 v150, v4, 13, v150
    v_sub_u32 v6, s17, v3
    v_and_b32 v6, 7, v6
    v_lshl_add_u32 v150, v6, 7, v150
    v_add_u32 v150, 81920, v150
    v_cmp_gt_u32 vcc, 16, v0
    s_nop 1
    v_cndmask_b32 v150, v7, v150, vcc
    s_add_u32 s25, s51, 8192
    s_mov_b32 s28, -1
    s_mov_b32 s29, -1
    s_mov_b32 s26, 4
LV_cal:
    s_memtime s[52:53]
    s_waitcnt lgkmcnt(0)
    s_load_dword s21, s[4:5], s51 glc
    s_waitcnt lgkmcnt(0)
    s_memtime s[54:55]
    s_waitcnt lgkmcnt(0)
    s_load_dword s21, s[4:5], s25 glc
    s_waitcnt lgkmcnt(0)
    s_memtime s[56:57]
    s_waitcnt lgkmcnt(0)
    s_sub_u32 s56, s56, s54
    s_sub_u32 s54, s54, s52
    s_min_u32 s28, s28, s54
    s_min_u32 s29, s29, s56
    s_cmp_lg_u32 s26, 4
    s_cbranch_scc1 LV_cal2
    s_barrier
LV_cal2:
    s_sub_u32 s26, s26, 1
    s_cmp_lg_u32 s26, 0
    s_cbranch_scc1 LV_cal
    s_cmp_lt_u32 s29, s28
    s_cselect_b32 s50, 8192, 0
LV_nocal:
    v_mov_b32 v6, 147456
    ds_read_b32 v6, v6 offset:8
    s_waitcnt lgkmcnt(0)
    v_readfirstlane_b32 s19, v6
    s_add_u32 s51, s51, s50
    s_add_u32 s60, s4, s51
    s_addc_u32 s61, s5, 0
    s_mov_b64 s[52:53], 0
    s_mov_b64 s[54:55], 0
    s_mov_b64 s[56:57], 0
    s_mov_b64 s[58:59], 0
    s_mov_b32 s20, 0
    s_cmp_lg_u32 s41, 0
    s_cbranch_scc1 LV_Cloop1
LV_Cloop0:
    s_and_b32 s21, s20, 3
    s_mul_i32 s24, s21, 65536
    s_add_u32 s24, s24, s43
    s_lshl_b32 s25, s21, 13
    s_add_u32 s25, s25, 92160
    v_add_u32 v9, s25, v5
    s_lshl_b32 s25, s21, 11
    s_add_u32 s25, s25, 124928
    v_lshlrev_b32 v6, 3, v0
    v_add_u32 v10, s25, v6
    s_add_u32 s27, s20, 1
    v_mov_b32 v126, s27
    s_mul_i32 s32, s20, 163840
    s_add_u32 s32, s32, s46
    s_add_u32 s32, s32, s47
    s_add_u32 s33, s32, 8192
    s_waitcnt lgkmcnt(0)
    s_barrier
    ds_read_b128 v[68:71], v9 offset:0
    ds_read_b128 v[72:75], v9 offset:1024
    ds_read_b128 v[76:79], v9 offset:2048
    ds_read_b128 v[80:83], v9 offset:3072
    s_waitcnt vmcnt(0)
    s_sleep 6
    v_mov_b32 v11, 0
    s_mov_b64 exec, s[68:69]
    s_mov_b32 s37, s38
L_ns_85:
    buffer_load_dword v11, v148, s[4:7], 0 offen sc1
    s_sub_u32 s37, s37, 1
    s_cbranch_scc1 L_nsd_86
    s_waitcnt vmcnt(3)
    v_cmp_gt_u32 vcc, s27, v11
    s_cbranch_vccnz L_ns_85
L_nsd_86:
    s_mov_b64 exec, -1
    buffer_load_dwordx4 v[44:47], v8, s[4:7], s24 offen offset:3072 sc1
    buffer_load_dwordx4 v[32:35], v5, s[4:7], s24 offen offset:0 sc1
    buffer_load_dwordx4 v[36:39], v5, s[4:7], s24 offen offset:1024 sc1
    buffer_load_dwordx4 v[40:43], v5, s[4:7], s24 offen offset:2048 sc1
    ds_write_b32 v123, v126 offset:24
    ds_read_b128 v[116:119], v123 offset:48
    ds_read_b64 v[84:85], v10 offset:0
    ds_read_b64 v[86:87], v10 offset:512
    s_waitcnt lgkmcnt(0)
    v_min3_u32 v116, v116, v117, v118
    v_min_u32 v116, v116, v119
    v_cmp_gt_u32 vcc, s27, v116
    s_mov_b32 s39, vcc_lo
    s_waitcnt vmcnt(3)
    v_max3_u32 v12, v44, v45, v46
    v_max_u32 v12, v12, v47
    v_mfma_f32_16x16x32_bf16 v[56:59], v[16:19], v[44:47], 0
    s_waitcnt vmcnt(2)
    v_max3_u32 v12, v12, v32, v33
    v_max3_u32 v12, v12, v34, v35
    v_mfma_f32_16x16x32_bf16 v[48:51], v[20:23], v[32:35], 0
    s_waitcnt vmcnt(1)
    v_max3_u32 v12, v12, v36, v37
    v_max3_u32 v12, v12, v38, v39
    v_mfma_f32_16x16x32_bf16 v[52:55], v[20:23], v[36:39], 0
    s_waitcnt vmcnt(0)
    v_max3_u32 v12, v12, v40, v41
    v_max3_u32 v12, v12, v42, v43
    v_mfma_f32_16x16x32_bf16 v[48:51], v[24:27], v[40:43], v[48:51]
    v_mfma_f32_16x16x32_bf16 v[52:55], v[28:31], v[40:43], v[52:55]
    v_cmp_eq_u32 vcc, -1, v12
    s_cbranch_vccnz L_gr_87
L_gd_90:
    ds_write_b32 v123, v126 offset:64
    s_nop 3
    v_max3_f32 v14, v48, v49, v50
    v_max3_f32 v14, v14, v51, v52
    v_max3_f32 v14, v14, v53, v54
    v_max3_f32 v14, v14, v55, v56
    v_max_f32 v14, v14, v57
    v_mov_b32 v15, v14
    s_nop 1
    v_permlane32_swap_b32 v15, v14
    v_max_f32 v14, v14, v15
    v_mov_b32 v15, v14
    s_nop 1
    v_permlane16_swap_b32 v15, v14
    v_max_f32 v14, v14, v15
    v_mul_f32 v14, s66, v14
    v_pk_fma_f32 v[56:57], v[56:57], s[66:67], v[14:15] op_sel_hi:[1,1,0] neg_lo:[0,0,1] neg_hi:[0,0,1]
    v_pk_fma_f32 v[48:49], v[48:49], s[66:67], v[14:15] op_sel_hi:[1,1,0] neg_lo:[0,0,1] neg_hi:[0,0,1]
    v_exp_f32 v56, v56
    v_exp_f32 v57, v57
    v_pk_fma_f32 v[50:51], v[50:51], s[66:67], v[14:15] op_sel_hi:[1,1,0] neg_lo:[0,0,1] neg_hi:[0,0,1]
    v_cvt_pk_bf16_f32 v64, v56, v57
    v_cvt_pk_bf16_f32 v67, v56, v57
    v_pk_fma_f32 v[52:53], v[52:53], s[66:67], v[14:15] op_sel_hi:[1,1,0] neg_lo:[0,0,1] neg_hi:[0,0,1]
    v_pk_fma_f32 v[54:55], v[54:55], s[66:67], v[14:15] op_sel_hi:[1,1,0] neg_lo:[0,0,1] neg_hi:[0,0,1]
    v_mfma_f32_16x16x16_bf16 v[128:131], v[88:89], v[64:65], 0
    v_exp_f32 v48, v48
    v_exp_f32 v49, v49
    s_cmp_lg_u32 s39, 0
    s_cbranch_scc1 LV_ys0
LV_yb0:
    v_mfma_f32_16x16x16_bf16 v[92:95], v[84:85], v[64:65], 0
    v_exp_f32 v50, v50
    v_exp_f32 v51, v51
    v_mfma_f32_16x16x16_bf16 v[96:99], v[84:85], v[66:67], 0
    v_exp_f32 v52, v52
    v_exp_f32 v53, v53
    v_mfma_f32_16x16x16_bf16 v[100:103], v[86:87], v[64:65], 0
    v_exp_f32 v54, v54
    v_exp_f32 v55, v55
    v_mfma_f32_16x16x16_bf16 v[104:107], v[86:87], v[66:67], 0
    v_cvt_pk_bf16_f32 v60, v48, v49
    v_cvt_pk_bf16_f32 v61, v50, v51
    v_cvt_pk_bf16_f32 v62, v52, v53
    v_cvt_pk_bf16_f32 v63, v54, v55
    s_nop 1
    v_mfma_f32_16x16x32_bf16 v[128:131], v[88:91], v[60:63], v[128:131]
    v_mfma_f32_16x16x32_bf16 v[92:95], v[68:71], v[60:63], v[92:95]
    v_mfma_f32_16x16x32_bf16 v[96:99], v[72:75], v[60:63], v[96:99]
    v_mfma_f32_16x16x32_bf16 v[100:103], v[76:79], v[60:63], v[100:103]
    v_mfma_f32_16x16x32_bf16 v[104:107], v[80:83], v[60:63], v[104:107]
    s_nop 3
    v_rcp_f32 v128, v128
    s_mov_b64 exec, s[64:65]
    v_pk_mul_f32 v[108:109], v[92:93], v[128:129] op_sel_hi:[1,0]
    v_pk_mul_f32 v[110:111], v[94:95], v[128:129] op_sel_hi:[1,0]
    v_pk_mul_f32 v[112:113], v[96:97], v[128:129] op_sel_hi:[1,0]
    v_pk_mul_f32 v[114:115], v[98:99], v[128:129] op_sel_hi:[1,0]
    s_mov_b64 exec, s[44:45]
    v_pk_mul_f32 v[112:113], v[100:101], v[128:129] op_sel_hi:[1,0]
    v_pk_mul_f32 v[114:115], v[102:103], v[128:129] op_sel_hi:[1,0]
    v_pk_mul_f32 v[108:109], v[104:105], v[128:129] op_sel_hi:[1,0]
    v_pk_mul_f32 v[110:111], v[106:107], v[128:129] op_sel_hi:[1,0]
    s_mov_b64 exec, -1
    v_add_f32_dpp v108, v112, v108 row_ror:8 row_mask:0xf bank_mask:0xf
    v_add_f32_dpp v109, v113, v109 row_ror:8 row_mask:0xf bank_mask:0xf
    v_add_f32_dpp v110, v114, v110 row_ror:8 row_mask:0xf bank_mask:0xf
    v_add_f32_dpp v111, v115, v111 row_ror:8 row_mask:0xf bank_mask:0xf
    s_mov_b32 s37, s38
L_lw_94:
    ds_read_b32 v15, v123 offset:16
    ds_read_b128 v[116:119], v122
    s_sub_u32 s37, s37, 1
    s_cbranch_scc1 L_lwd_95
    s_waitcnt lgkmcnt(0)
    v_cmp_gt_u32 vcc, s27, v15
    s_cbranch_vccnz L_lw_94
L_lwd_95:
    v_pk_add_f32 v[108:109], v[108:109], v[116:117]
    v_pk_add_f32 v[110:111], v[110:111], v[118:119]
    v_cvt_pk_bf16_f32 v108, v108, v109
    v_cvt_pk_bf16_f32 v109, v110, v111
    v_min_u32 v108, -2, v108
    v_min_u32 v109, -2, v109
    buffer_store_dwordx2 v[108:109], v120, s[4:7], s32 offen sc1
    buffer_store_dwordx2 v[108:109], v120, s[4:7], s33 offen sc1
    ds_write_b32 v123, v126 offset:28
    s_cmp_lt_i32 s37, 0
    s_cselect_b32 s38, 4, s38
    s_add_u32 s20, s20, 1
    s_cmp_lt_u32 s20, 63
    s_cbranch_scc1 LV_Cloop0
    s_waitcnt vmcnt(0) lgkmcnt(0)
    s_endpgm
LV_Cloop1:
    s_and_b32 s21, s20, 3
    s_mul_i32 s24, s21, 65536
    s_add_u32 s24, s24, s43
    s_lshl_b32 s25, s21, 13
    s_add_u32 s25, s25, 96256
    v_add_u32 v9, s25, v5
    s_lshl_b32 s25, s21, 11
    s_add_u32 s25, s25, 125952
    v_lshlrev_b32 v6, 3, v0
    v_add_u32 v10, s25, v6
    s_add_u32 s27, s20, 1
    v_mov_b32 v126, s27
    s_mul_i32 s32, s20, 163840
    s_add_u32 s32, s32, s46
    s_lshr_b32 s21, s32, 8
    s_and_b32 s21, s21, 8192
    s_xor_b32 s21, s21, s50
    s_add_u32 s34, s32, s21
    s_and_b32 s21, s27, 3
    s_mul_i32 s35, s21, 81920
    s_add_u32 s35, s35, s48
    s_xor_b32 s21, s21, 2
    s_mul_i32 s36, s21, 81920
    s_add_u32 s36, s36, s48
    s_waitcnt lgkmcnt(0)
    s_barrier
    ds_read_b128 v[68:71], v9 offset:0
    ds_read_b128 v[72:75], v9 offset:1024
    ds_read_b128 v[76:79], v9 offset:2048
    ds_read_b128 v[80:83], v9 offset:3072
    s_waitcnt vmcnt(0)
    s_sleep 6
    v_mov_b32 v11, 0
    s_mov_b64 exec, s[68:69]
    s_mov_b32 s37, s38
L_ns_97:
    buffer_load_dword v11, v148, s[4:7], 0 offen sc1
    s_sub_u32 s37, s37, 1
    s_cbranch_scc1 L_nsd_98
    s_waitcnt vmcnt(3)
    v_cmp_gt_u32 vcc, s27, v11
    s_cbranch_vccnz L_ns_97
L_nsd_98:
    s_mov_b64 exec, -1
    buffer_load_dwordx4 v[44:47], v8, s[4:7], s24 offen offset:3072 sc1
    buffer_load_dwordx4 v[32:35], v5, s[4:7], s24 offen offset:0 sc1
    buffer_load_dwordx4 v[36:39], v5, s[4:7], s24 offen offset:1024 sc1
    buffer_load_dwordx4 v[40:43], v5, s[4:7], s24 offen offset:2048 sc1
    ds_read_b128 v[116:119], v123 offset:48
    ds_read_b64 v[84:85], v10 offset:0
    ds_read_b64 v[86:87], v10 offset:512
    s_waitcnt lgkmcnt(0)
    v_min3_u32 v116, v116, v117, v118
    v_min_u32 v116, v116, v119
    v_cmp_gt_u32 vcc, s27, v116
    s_mov_b32 s39, vcc_lo
    s_waitcnt vmcnt(3)
    v_max3_u32 v12, v44, v45, v46
    v_max_u32 v12, v12, v47
    v_mfma_f32_16x16x32_bf16 v[56:59], v[16:19], v[44:47], 0
    s_waitcnt vmcnt(2)
    v_max3_u32 v12, v12, v32, v33
    v_max3_u32 v12, v12, v34, v35
    v_mfma_f32_16x16x32_bf16 v[48:51], v[20:23], v[32:35], 0
    s_waitcnt vmcnt(1)
    v_max3_u32 v12, v12, v36, v37
    v_max3_u32 v12, v12, v38, v39
    v_mfma_f32_16x16x32_bf16 v[52:55], v[20:23], v[36:39], 0
    s_waitcnt vmcnt(0)
    v_max3_u32 v12, v12, v40, v41
    v_max3_u32 v12, v12, v42, v43
    v_mfma_f32_16x16x32_bf16 v[48:51], v[24:27], v[40:43], v[48:51]
    v_mfma_f32_16x16x32_bf16 v[52:55], v[28:31], v[40:43], v[52:55]
    v_cmp_eq_u32 vcc, -1, v12
    s_cbranch_vccnz L_gr_99
L_gd_102:
    s_nop 0
    s_nop 3
    v_max3_f32 v14, v48, v49, v50
    v_max3_f32 v14, v14, v51, v52
    v_max3_f32 v14, v14, v53, v54
    v_max3_f32 v14, v14, v55, v56
    v_max_f32 v14, v14, v57
    v_mov_b32 v15, v14
    s_nop 1
    v_permlane32_swap_b32 v15, v14
    v_max_f32 v14, v14, v15
    v_mov_b32 v15, v14
    s_nop 1
    v_permlane16_swap_b32 v15, v14
    v_max_f32 v14, v14, v15
    v_mul_f32 v14, s66, v14
    v_pk_fma_f32 v[56:57], v[56:57], s[66:67], v[14:15] op_sel_hi:[1,1,0] neg_lo:[0,0,1] neg_hi:[0,0,1]
    v_pk_fma_f32 v[48:49], v[48:49], s[66:67], v[14:15] op_sel_hi:[1,1,0] neg_lo:[0,0,1] neg_hi:[0,0,1]
    v_exp_f32 v56, v56
    v_exp_f32 v57, v57
    v_pk_fma_f32 v[50:51], v[50:51], s[66:67], v[14:15] op_sel_hi:[1,1,0] neg_lo:[0,0,1] neg_hi:[0,0,1]
    v_cvt_pk_bf16_f32 v64, v56, v57
    v_cvt_pk_bf16_f32 v67, v56, v57
    v_pk_fma_f32 v[52:53], v[52:53], s[66:67], v[14:15] op_sel_hi:[1,1,0] neg_lo:[0,0,1] neg_hi:[0,0,1]
    v_pk_fma_f32 v[54:55], v[54:55], s[66:67], v[14:15] op_sel_hi:[1,1,0] neg_lo:[0,0,1] neg_hi:[0,0,1]
    v_mfma_f32_16x16x16_bf16 v[128:131], v[88:89], v[64:65], 0
    v_exp_f32 v48, v48
    v_exp_f32 v49, v49
    s_cmp_lg_u32 s39, 0
    s_cbranch_scc1 LV_ys1
LV_yb1:
    v_mfma_f32_16x16x16_bf16 v[92:95], v[84:85], v[64:65], 0
    v_exp_f32 v50, v50
    v_exp_f32 v51, v51
    v_mfma_f32_16x16x16_bf16 v[96:99], v[84:85], v[66:67], 0
    v_exp_f32 v52, v52
    v_exp_f32 v53, v53
    v_mfma_f32_16x16x16_bf16 v[100:103], v[86:87], v[64:65], 0
    v_exp_f32 v54, v54
    v_exp_f32 v55, v55
    v_mfma_f32_16x16x16_bf16 v[104:107], v[86:87], v[66:67], 0
    buffer_store_dword v126, v150, s[4:7], 0 offen sc1
    v_cvt_pk_bf16_f32 v60, v48, v49
    v_cvt_pk_bf16_f32 v61, v50, v51
    v_cvt_pk_bf16_f32 v62, v52, v53
    v_cvt_pk_bf16_f32 v63, v54, v55
    s_nop 1
    v_mfma_f32_16x16x32_bf16 v[128:131], v[88:91], v[60:63], v[128:131]
    v_mfma_f32_16x16x32_bf16 v[92:95], v[68:71], v[60:63], v[92:95]
    v_mfma_f32_16x16x32_bf16 v[96:99], v[72:75], v[60:63], v[96:99]
    v_mfma_f32_16x16x32_bf16 v[100:103], v[76:79], v[60:63], v[100:103]
    v_mfma_f32_16x16x32_bf16 v[104:107], v[80:83], v[60:63], v[104:107]
    s_nop 3
    v_rcp_f32 v128, v128
    s_mov_b64 exec, s[64:65]
    v_pk_mul_f32 v[108:109], v[92:93], v[128:129] op_sel_hi:[1,0]
    v_pk_mul_f32 v[110:111], v[94:95], v[128:129] op_sel_hi:[1,0]
    v_pk_mul_f32 v[112:113], v[96:97], v[128:129] op_sel_hi:[1,0]
    v_pk_mul_f32 v[114:115], v[98:99], v[128:129] op_sel_hi:[1,0]
    s_mov_b64 exec, s[44:45]
    v_pk_mul_f32 v[112:113], v[100:101], v[128:129] op_sel_hi:[1,0]
    v_pk_mul_f32 v[114:115], v[102:103], v[128:129] op_sel_hi:[1,0]
    v_pk_mul_f32 v[108:109], v[104:105], v[128:129] op_sel_hi:[1,0]
    v_pk_mul_f32 v[110:111], v[106:107], v[128:129] op_sel_hi:[1,0]
    s_mov_b64 exec, -1
    v_add_f32_dpp v108, v112, v108 row_ror:8 row_mask:0xf bank_mask:0xf
    v_add_f32_dpp v109, v113, v109 row_ror:8 row_mask:0xf bank_mask:0xf
    v_add_f32_dpp v110, v114, v110 row_ror:8 row_mask:0xf bank_mask:0xf
    v_add_f32_dpp v111, v115, v111 row_ror:8 row_mask:0xf bank_mask:0xf
    ds_write_b128 v122, v[108:111]
    ds_write_b32 v123, v126 offset:16
    s_mov_b32 s37, s38
LV_np:
    s_load_dword s53, s[60:61], 128 glc
    s_load_dword s54, s[60:61], 256 glc
    s_load_dword s55, s[60:61], 384 glc
    s_load_dword s56, s[60:61], 512 glc
    s_load_dword s57, s[60:61], 640 glc
    s_load_dword s58, s[60:61], 768 glc
    s_load_dword s59, s[60:61], 896 glc
    s_sub_u32 s37, s37, 1
    s_cbranch_scc1 LV_npd
    s_min_u32 s25, s54, s55
    s_min_u32 s26, s56, s57
    s_min_u32 s28, s58, s59
    s_min_u32 s21, s53, s25
    s_min_u32 s26, s26, s28
    s_min_u32 s21, s21, s26
    s_cmp_ge_u32 s21, s27
    s_cbranch_scc1 LV_npd
    s_min_u32 s25, s54, s55
    s_min_u32 s26, s56, s57
    s_min_u32 s28, s58, s59
    s_min_u32 s21, s53, s25
    s_min_u32 s26, s26, s28
    s_min_u32 s21, s21, s26
    s_cmp_ge_u32 s21, s27
    s_cbranch_scc1 LV_npd
    s_min_u32 s25, s54, s55
    s_min_u32 s26, s56, s57
    s_min_u32 s28, s58, s59
    s_min_u32 s21, s53, s25
    s_min_u32 s26, s26, s28
    s_min_u32 s21, s21, s26
    s_cmp_ge_u32 s21, s27
    s_cbranch_scc1 LV_npd
    s_waitcnt lgkmcnt(7)
    s_min_u32 s25, s54, s55
    s_min_u32 s26, s56, s57
    s_min_u32 s28, s58, s59
    s_min_u32 s21, s53, s25
    s_min_u32 s26, s26, s28
    s_min_u32 s21, s21, s26
    s_cmp_ge_u32 s21, s27
    s_cbranch_scc0 LV_np
LV_npd:
    buffer_load_dwordx4 v[132:135], v5, s[4:7], s34 offen offset:0 sc1
    buffer_load_dwordx4 v[136:139], v5, s[4:7], s34 offen offset:1024 sc1
    buffer_load_dwordx4 v[140:143], v5, s[4:7], s34 offen offset:2048 sc1
    buffer_load_dwordx4 v[144:147], v5, s[4:7], s34 offen offset:3072 sc1
    ds_write_b32 v123, v126 offset:88
    s_nop 15
    s_nop 15
    s_nop 15
    s_nop 7
    s_cmp_lg_u32 s19, 0
    s_cbranch_scc1 L_slow_110
    buffer_store_dword v126, v149, s[4:7], 0 offen
L_back_111:
    s_waitcnt vmcnt(4)
    v_max3_u32 v12, v132, v133, v134
    v_max_u32 v12, v12, v135
    v_mfma_f32_16x16x32_bf16 v[48:51], v[20:23], v[132:135], 0
    s_waitcnt vmcnt(3)
    v_max3_u32 v12, v12, v136, v137
    v_max3_u32 v12, v12, v138, v139
    v_mfma_f32_16x16x32_bf16 v[48:51], v[20:23], v[136:139], v[48:51]
    s_waitcnt vmcnt(2)
    v_max3_u32 v12, v12, v140, v141
    v_max3_u32 v12, v12, v142, v143
    v_mfma_f32_16x16x32_bf16 v[48:51], v[20:23], v[140:143], v[48:51]
    s_waitcnt vmcnt(1)
    v_max3_u32 v12, v12, v144, v145
    v_max3_u32 v12, v12, v146, v147
    v_mfma_f32_16x16x32_bf16 v[48:51], v[20:23], v[144:147], v[48:51]
    v_cmp_eq_u32 vcc, -1, v12
    s_cbranch_vccnz L_gr_106
L_gd_109:
    s_nop 5
    v_cvt_pk_bf16_f32 v48, v48, v49
    v_cvt_pk_bf16_f32 v49, v50, v51
    v_min_u32 v48, -2, v48
    v_min_u32 v49, -2, v49
    s_cmp_lg_u32 s19, 0
    s_cbranch_scc1 L_slow_112
    buffer_store_dwordx2 v[48:49], v121, s[4:7], s35 offen
L_back_113:
    ds_write_b32 v123, v126 offset:20
    s_cmp_lg_u32 s19, 0
    s_cbranch_scc1 L_slow_114
    buffer_store_dwordx2 v[124:125], v121, s[4:7], s36 offen
L_back_115:
    s_cmp_lt_i32 s37, 0
    s_cselect_b32 s38, 4, s38
    s_add_u32 s20, s20, 1
    s_cmp_lt_u32 s20, 63
    s_cbranch_scc1 LV_Cloop1
    s_waitcnt vmcnt(0) lgkmcnt(0)
    s_endpgm
LV_C2:
    s_lshl_b32 s21, s17, 10
    s_add_u32 s21, s21, 1077248
    v_lshlrev_b32 v8, 7, v3
    v_add_u32 v8, s21, v8
    s_mul_i32 s43, s17, 12288
    s_add_u32 s43, s43, 1701888
    v_lshlrev_b32 v9, 2, v0
    v_lshlrev_b32 v10, 12, v4
    v_lshl_add_u32 v6, v3, 2, v1
    v_lshl_add_u32 v10, v6, 4, v10
    s_lshl_b32 s44, s18, 14
    s_lshl_b32 s21, s17, 9
    s_add_u32 s44, s44, s21
    s_add_u32 s44, s44, 20971520
    v_mov_b32 v7, 147456
    v_mov_b32 v49, 0
    v_mov_b32 v50, 0
    v_mov_b32 v53, 0
    v_mov_b32 v54, 0
    v_mov_b32 v57, 0
    v_mov_b32 v58, 0
    v_mov_b32 v61, 0
    v_mov_b32 v62, 0
    v_mov_b32 v65, 0
    v_mov_b32 v66, 0
    v_mov_b32 v69, 0
    v_mov_b32 v70, 0
    v_mov_b32 v73, 0
    v_mov_b32 v74, 0
    v_mov_b32 v77, 0
    v_mov_b32 v78, 0
    s_mov_b32 s28, 268435456
    s_mov_b32 s29, 268435456
    s_barrier
    s_mov_b32 s20, 0
LV_C2loop:
    s_add_u32 s27, s20, 1
    v_mov_b32 v15, s27
    s_cmp_lt_u32 s20, 2
    s_cbranch_scc0 LV_C2a
    s_cmp_gt_u32 s20, 63
    s_cbranch_scc1 LV_C2c
    s_barrier
    s_branch LV_C2c
LV_C2a:
    s_sub_u32 s26, s20, 2
    s_add_u32 s30, s26, 1
    s_and_b32 s21, s26, 3
    s_mul_i32 s24, s21, 98304
    s_add_u32 s24, s24, s43
    s_lshl_b32 s25, s21, 13
    s_add_u32 s25, s25, 92160
    v_add_u32 v11, s25, v5
    s_lshl_b32 s25, s21, 11
    s_add_u32 s25, s25, 124928
    v_lshlrev_b32 v6, 3, v0
    v_add_u32 v12, s25, v6
    s_min_u32 s31, s27, 64
    s_min_u32 s32, s27, 63
    s_mov_b32 s37, s38
    s_branch L_lws_118
L_lw_116:
    s_sleep 1
L_lws_118:
    ds_read_b128 v[136:139], v7 offset:48
    s_sub_u32 s37, s37, 1
    s_cbranch_scc1 L_lwd_117
    s_waitcnt lgkmcnt(0)
    v_min3_u32 v136, v136, v137, v138
    v_min_u32 v136, v136, v139
    v_cmp_gt_u32 vcc, s30, v136
    s_cbranch_vccnz L_lw_116
L_lwd_117:
    ds_read_b128 v[80:83], v11 offset:0
    ds_read_b128 v[84:87], v11 offset:1024
    ds_read_b128 v[88:91], v11 offset:2048
    ds_read_b128 v[92:95], v11 offset:3072
    ds_read_b128 v[96:99], v11 offset:4096
    ds_read_b128 v[100:103], v11 offset:5120
    ds_read_b128 v[104:107], v11 offset:6144
    ds_read_b128 v[108:111], v11 offset:7168
    ds_read_b64 v[112:113], v12 offset:0
    ds_read_b64 v[114:115], v12 offset:512
    ds_read_b64 v[116:117], v12 offset:1024
    ds_read_b64 v[118:119], v12 offset:1536
    s_waitcnt lgkmcnt(0)
    s_cmp_gt_u32 s20, 63
    s_cbranch_scc1 LV_C2nb
    s_barrier
LV_C2nb:
    s_mov_b32 s37, s38
L_f_119:
    buffer_load_dword v13, v8, s[4:7], 0 offen sc1
    s_waitcnt vmcnt(0)
    v_cmp_gt_u32 vcc, s30, v13
    s_cbranch_vccz L_fd_120
    s_sub_u32 s37, s37, 1
    s_cbranch_scc1 L_fd_120
    s_sleep 1
    s_branch L_f_119
L_fd_120:
    s_cmp_lt_i32 s37, 0
    s_cselect_b32 s38, 4, s38
    buffer_load_dwordx4 v[16:19], v5, s[4:7], s24 offen offset:0 sc1
    buffer_load_dword v48, v9, s[4:7], s24 offen offset:1024 sc1
    buffer_load_dwordx4 v[20:23], v5, s[4:7], s24 offen offset:1536 sc1
    buffer_load_dword v52, v9, s[4:7], s24 offen offset:2560 sc1
    s_add_u32 s24, s24, 3072
    buffer_load_dwordx4 v[24:27], v5, s[4:7], s24 offen offset:0 sc1
    buffer_load_dword v56, v9, s[4:7], s24 offen offset:1024 sc1
    buffer_load_dwordx4 v[28:31], v5, s[4:7], s24 offen offset:1536 sc1
    buffer_load_dword v60, v9, s[4:7], s24 offen offset:2560 sc1
    s_add_u32 s24, s24, 3072
    buffer_load_dwordx4 v[32:35], v5, s[4:7], s24 offen offset:0 sc1
    buffer_load_dword v64, v9, s[4:7], s24 offen offset:1024 sc1
    buffer_load_dwordx4 v[36:39], v5, s[4:7], s24 offen offset:1536 sc1
    buffer_load_dword v68, v9, s[4:7], s24 offen offset:2560 sc1
    s_add_u32 s24, s24, 3072
    buffer_load_dwordx4 v[40:43], v5, s[4:7], s24 offen offset:0 sc1
    buffer_load_dword v72, v9, s[4:7], s24 offen offset:1024 sc1
    buffer_load_dwordx4 v[44:47], v5, s[4:7], s24 offen offset:1536 sc1
    buffer_load_dword v76, v9, s[4:7], s24 offen offset:2560 sc1
    s_mov_b32 s37, s38
    s_branch L_lws_123
L_lw_121:
    s_sleep 1
L_lws_123:
    ds_read_b32 v13, v7 offset:64
    s_sub_u32 s37, s37, 1
    s_cbranch_scc1 L_lwd_122
    s_waitcnt lgkmcnt(0)
    v_cmp_gt_u32 vcc, s32, v13
    s_cbranch_vccnz L_lw_121
L_lwd_122:
    buffer_store_dwordx4 v[140:143], v10, s[4:7], s28 offen sc1
    buffer_store_dwordx4 v[144:147], v10, s[4:7], s29 offen sc1
    s_mov_b32 s28, 268435456
    s_mov_b32 s29, 268435456
    s_waitcnt vmcnt(2)
    s_mov_b32 s37, s38
    s_branch L_lws_126
L_lw_124:
    s_sleep 1
L_lws_126:
    ds_read_b32 v13, v7 offset:28
    s_sub_u32 s37, s37, 1
    s_cbranch_scc1 L_lwd_125
    s_waitcnt lgkmcnt(0)
    v_cmp_gt_u32 vcc, s32, v13
    s_cbranch_vccnz L_lw_124
L_lwd_125:
    v_mov_b32 v51, v48
    v_mov_b32 v55, v52
    v_mfma_f32_16x16x32_bf16 v[120:123], v[80:83], v[16:19], 0
    v_mfma_f32_16x16x32_bf16 v[124:127], v[84:87], v[16:19], 0
    v_mfma_f32_16x16x32_bf16 v[128:131], v[80:83], v[20:23], 0
    v_mfma_f32_16x16x32_bf16 v[132:135], v[84:87], v[20:23], 0
    v_mfma_f32_16x16x16_bf16 v[120:123], v[112:113], v[48:49], v[120:123]
    v_mfma_f32_16x16x16_bf16 v[124:127], v[112:113], v[50:51], v[124:127]
    v_mfma_f32_16x16x16_bf16 v[128:131], v[112:113], v[52:53], v[128:131]
    v_mfma_f32_16x16x16_bf16 v[132:135], v[112:113], v[54:55], v[132:135]
    v_mov_b32 v59, v56
    v_mov_b32 v63, v60
    v_mfma_f32_16x16x32_bf16 v[120:123], v[88:91], v[24:27], v[120:123]
    v_mfma_f32_16x16x32_bf16 v[124:127], v[92:95], v[24:27], v[124:127]
    v_mfma_f32_16x16x32_bf16 v[128:131], v[88:91], v[28:31], v[128:131]
    v_mfma_f32_16x16x32_bf16 v[132:135], v[92:95], v[28:31], v[132:135]
    v_mfma_f32_16x16x16_bf16 v[120:123], v[114:115], v[56:57], v[120:123]
    v_mfma_f32_16x16x16_bf16 v[124:127], v[114:115], v[58:59], v[124:127]
    v_mfma_f32_16x16x16_bf16 v[128:131], v[114:115], v[60:61], v[128:131]
    v_mfma_f32_16x16x16_bf16 v[132:135], v[114:115], v[62:63], v[132:135]
    v_mov_b32 v67, v64
    v_mov_b32 v71, v68
    v_mfma_f32_16x16x32_bf16 v[120:123], v[96:99], v[32:35], v[120:123]
    v_mfma_f32_16x16x32_bf16 v[124:127], v[100:103], v[32:35], v[124:127]
    v_mfma_f32_16x16x32_bf16 v[128:131], v[96:99], v[36:39], v[128:131]
    v_mfma_f32_16x16x32_bf16 v[132:135], v[100:103], v[36:39], v[132:135]
    v_mfma_f32_16x16x16_bf16 v[120:123], v[116:117], v[64:65], v[120:123]
    v_mfma_f32_16x16x16_bf16 v[124:127], v[116:117], v[66:67], v[124:127]
    v_mfma_f32_16x16x16_bf16 v[128:131], v[116:117], v[68:69], v[128:131]
    v_mfma_f32_16x16x16_bf16 v[132:135], v[116:117], v[70:71], v[132:135]
    v_mov_b32 v75, v72
    v_mov_b32 v79, v76
    v_mfma_f32_16x16x32_bf16 v[120:123], v[104:107], v[40:43], v[120:123]
    v_mfma_f32_16x16x32_bf16 v[124:127], v[108:111], v[40:43], v[124:127]
    v_mfma_f32_16x16x32_bf16 v[128:131], v[104:107], v[44:47], v[128:131]
    v_mfma_f32_16x16x32_bf16 v[132:135], v[108:111], v[44:47], v[132:135]
    v_mfma_f32_16x16x16_bf16 v[120:123], v[118:119], v[72:73], v[120:123]
    v_mfma_f32_16x16x16_bf16 v[124:127], v[118:119], v[74:75], v[124:127]
    v_mfma_f32_16x16x16_bf16 v[128:131], v[118:119], v[76:77], v[128:131]
    v_mfma_f32_16x16x16_bf16 v[132:135], v[118:119], v[78:79], v[132:135]
    s_and_b32 s21, s26, 7
    s_mul_i32 s28, s21, 327680
    s_add_u32 s28, s28, s44
    s_add_u32 s29, s28, 8192
    s_nop 3
    v_cvt_pk_bf16_f32 v140, v120, v121
    v_cvt_pk_bf16_f32 v141, v122, v123
    v_cvt_pk_bf16_f32 v142, v124, v125
    v_cvt_pk_bf16_f32 v143, v126, v127
    v_cvt_pk_bf16_f32 v144, v128, v129
    v_cvt_pk_bf16_f32 v145, v130, v131
    v_cvt_pk_bf16_f32 v146, v132, v133
    v_cvt_pk_bf16_f32 v147, v134, v135
    v_min_u32 v140, -2, v140
    v_min_u32 v141, -2, v141
    v_min_u32 v142, -2, v142
    v_min_u32 v143, -2, v143
    v_min_u32 v144, -2, v144
    v_min_u32 v145, -2, v145
    v_min_u32 v146, -2, v146
    v_min_u32 v147, -2, v147
    s_cmp_lt_u32 s20, 63
    s_cbranch_scc1 LV_C2c
    buffer_store_dwordx4 v[140:143], v10, s[4:7], s28 offen sc1
    buffer_store_dwordx4 v[144:147], v10, s[4:7], s29 offen sc1
    s_mov_b32 s28, 268435456
    s_mov_b32 s29, 268435456
LV_C2c:
    s_add_u32 s20, s20, 1
    s_cmp_lt_u32 s20, 66
    s_cbranch_scc1 LV_C2loop
    s_waitcnt vmcnt(0) lgkmcnt(0)
    s_endpgm
LV_C3:
    v_mov_b32 v7, 147456
    s_and_b32 s21, s18, 1
    s_mul_i32 s21, s21, 20480
    v_add_u32 v9, s21, v5
    s_sub_u32 s21, 20480, s21
    v_add_u32 v11, s21, v5
    s_barrier
    s_mov_b32 s20, 0
LV_C3loop:
    s_add_u32 s27, s20, 1
    v_mov_b32 v15, s27
    s_add_u32 s26, s20, 2
    s_mul_i32 s28, s26, 40960
    s_add_u32 s28, s28, 4194304
    s_and_b32 s29, s26, 1
    s_mul_i32 s29, s29, 40960
    s_add_u32 s29, s29, 0
    v_add_u32 v8, s29, v9
    v_add_u32 v10, s29, v11
    s_barrier
    buffer_load_dwordx4 v[32:35], v9, s[4:7], s28 offen offset:0
    buffer_load_dwordx4 v[36:39], v9, s[4:7], s28 offen offset:1024
    buffer_load_dwordx4 v[40:43], v9, s[4:7], s28 offen offset:2048
    buffer_load_dwordx4 v[44:47], v9, s[4:7], s28 offen offset:3072
    s_add_u32 s28, s28, 4096
    buffer_load_dwordx4 v[48:51], v9, s[4:7], s28 offen offset:0
    buffer_load_dwordx4 v[52:55], v9, s[4:7], s28 offen offset:1024
    buffer_load_dwordx4 v[56:59], v9, s[4:7], s28 offen offset:2048
    buffer_load_dwordx4 v[60:63], v9, s[4:7], s28 offen offset:3072
    s_add_u32 s28, s28, 4096
    buffer_load_dwordx4 v[64:67], v9, s[4:7], s28 offen offset:0
    buffer_load_dwordx4 v[68:71], v9, s[4:7], s28 offen offset:1024
    buffer_load_dwordx4 v[72:75], v9, s[4:7], s28 offen offset:2048
    buffer_load_dwordx4 v[76:79], v9, s[4:7], s28 offen offset:3072
    s_add_u32 s28, s28, 4096
    s_mov_b32 s37, s38
    s_branch L_lws_129
L_lw_127:
    s_sleep 1
L_lws_129:
    ds_read_b32 v16, v7 offset:24
    s_sub_u32 s37, s37, 1
    s_cbranch_scc1 L_lwd_128
    s_waitcnt lgkmcnt(0)
    v_cmp_gt_u32 vcc, s27, v16
    s_cbranch_vccnz L_lw_127
L_lwd_128:
    buffer_load_dwordx4 v[80:83], v9, s[4:7], s28 offen offset:0
    s_nop 2
    buffer_load_dwordx4 v[84:87], v9, s[4:7], s28 offen offset:1024
    s_nop 2
    buffer_load_dwordx4 v[88:91], v9, s[4:7], s28 offen offset:2048
    s_nop 2
    buffer_load_dwordx4 v[92:95], v9, s[4:7], s28 offen offset:3072
    s_add_u32 s28, s28, 4096
    s_nop 2
    buffer_load_dwordx4 v[96:99], v9, s[4:7], s28 offen offset:0
    s_nop 2
    buffer_load_dwordx4 v[100:103], v9, s[4:7], s28 offen offset:1024
    s_nop 2
    buffer_load_dwordx4 v[104:107], v9, s[4:7], s28 offen offset:2048
    s_nop 2
    buffer_load_dwordx4 v[108:111], v9, s[4:7], s28 offen offset:3072
    s_sub_u32 s28, s28, 16384
    s_nop 2
    buffer_load_dwordx4 v[112:115], v11, s[4:7], s28 offen offset:0
    s_nop 2
    buffer_load_dwordx4 v[116:119], v11, s[4:7], s28 offen offset:1024
    s_nop 2
    buffer_load_dwordx4 v[120:123], v11, s[4:7], s28 offen offset:2048
    s_nop 2
    buffer_load_dwordx4 v[124:127], v11, s[4:7], s28 offen offset:3072
    s_add_u32 s28, s28, 4096
    s_nop 2
    buffer_load_dwordx4 v[128:131], v11, s[4:7], s28 offen offset:0
    s_nop 2
    buffer_load_dwordx4 v[132:135], v11, s[4:7], s28 offen offset:1024
    s_nop 2
    buffer_load_dwordx4 v[136:139], v11, s[4:7], s28 offen offset:2048
    s_nop 2
    buffer_load_dwordx4 v[140:143], v11, s[4:7], s28 offen offset:3072
    s_add_u32 s28, s28, 4096
    s_nop 2
    s_mov_b32 s37, s38
    s_branch L_lws_132
L_lw_130:
    s_sleep 1
L_lws_132:
    ds_read_b32 v16, v7 offset:28
    s_sub_u32 s37, s37, 1
    s_cbranch_scc1 L_lwd_131
    s_waitcnt lgkmcnt(0)
    v_cmp_gt_u32 vcc, s27, v16
    s_cbranch_vccnz L_lw_130
L_lwd_131:
    buffer_load_dwordx4 v[144:147], v11, s[4:7], s28 offen offset:0
    buffer_load_dwordx4 v[148:151], v11, s[4:7], s28 offen offset:1024
    buffer_load_dwordx4 v[152:155], v11, s[4:7], s28 offen offset:2048
    buffer_load_dwordx4 v[156:159], v11, s[4:7], s28 offen offset:3072
    s_add_u32 s28, s28, 4096
    buffer_load_dwordx4 v[160:163], v11, s[4:7], s28 offen offset:0
    buffer_load_dwordx4 v[164:167], v11, s[4:7], s28 offen offset:1024
    buffer_load_dwordx4 v[168:171], v11, s[4:7], s28 offen offset:2048
    buffer_load_dwordx4 v[172:175], v11, s[4:7], s28 offen offset:3072
    s_add_u32 s28, s28, 4096
    buffer_load_dwordx4 v[176:179], v11, s[4:7], s28 offen offset:0
    buffer_load_dwordx4 v[180:183], v11, s[4:7], s28 offen offset:1024
    buffer_load_dwordx4 v[184:187], v11, s[4:7], s28 offen offset:2048
    buffer_load_dwordx4 v[188:191], v11, s[4:7], s28 offen offset:3072
    s_add_u32 s28, s28, 4096
    s_waitcnt vmcnt(12)
    ds_write_b128 v8, v[32:35] offset:0
    ds_write_b128 v8, v[36:39] offset:1024
    ds_write_b128 v8, v[40:43] offset:2048
    ds_write_b128 v8, v[44:47] offset:3072
    ds_write_b128 v8, v[48:51] offset:4096
    ds_write_b128 v8, v[52:55] offset:5120
    ds_write_b128 v8, v[56:59] offset:6144
    ds_write_b128 v8, v[60:63] offset:7168
    ds_write_b128 v8, v[64:67] offset:8192
    ds_write_b128 v8, v[68:71] offset:9216
    ds_write_b128 v8, v[72:75] offset:10240
    ds_write_b128 v8, v[76:79] offset:11264
    ds_write_b128 v8, v[80:83] offset:12288
    ds_write_b128 v8, v[84:87] offset:13312
    ds_write_b128 v8, v[88:91] offset:14336
    ds_write_b128 v8, v[92:95] offset:15360
    ds_write_b128 v8, v[96:99] offset:16384
    ds_write_b128 v8, v[100:103] offset:17408
    ds_write_b128 v8, v[104:107] offset:18432
    ds_write_b128 v8, v[108:111] offset:19456
    ds_write_b128 v10, v[112:115] offset:0
    ds_write_b128 v10, v[116:119] offset:1024
    ds_write_b128 v10, v[120:123] offset:2048
    ds_write_b128 v10, v[124:127] offset:3072
    ds_write_b128 v10, v[128:131] offset:4096
    ds_write_b128 v10, v[132:135] offset:5120
    ds_write_b128 v10, v[136:139] offset:6144
    ds_write_b128 v10, v[140:143] offset:7168
    s_waitcnt vmcnt(0)
    ds_write_b128 v10, v[144:147] offset:8192
    ds_write_b128 v10, v[148:151] offset:9216
    ds_write_b128 v10, v[152:155] offset:10240
    ds_write_b128 v10, v[156:159] offset:11264
    ds_write_b128 v10, v[160:163] offset:12288
    ds_write_b128 v10, v[164:167] offset:13312
    ds_write_b128 v10, v[168:171] offset:14336
    ds_write_b128 v10, v[172:175] offset:15360
    ds_write_b128 v10, v[176:179] offset:16384
    ds_write_b128 v10, v[180:183] offset:17408
    ds_write_b128 v10, v[184:187] offset:18432
    ds_write_b128 v10, v[188:191] offset:19456
LV_C3b:
    s_waitcnt lgkmcnt(0)
    s_cmp_lt_i32 s37, 0
    s_cselect_b32 s38, 4, s38
    s_add_u32 s20, s20, 1
    s_cmp_lt_u32 s20, 62
    s_cbranch_scc1 LV_C3loop
    s_waitcnt vmcnt(0) lgkmcnt(0)
LM_end:
    s_endpgm
LM_tail:
    v_lshrrev_b32 v1, 4, v0
    v_and_b32 v2, 15, v0
    v_and_b32 v3, 7, v0
    v_bfe_u32 v4, v0, 3, 1
    v_lshlrev_b32 v5, 4, v0
    v_mov_b32 v6, 147456
    ds_read_b32 v6, v6 offset:8
    s_waitcnt lgkmcnt(0)
    v_readfirstlane_b32 s19, v6
    s_load_dwordx2 s[8:9], s[0:1], 72
    s_mov_b32 s10, 3072
    s_mov_b32 s11, 0x20000
    s_waitcnt lgkmcnt(0)
    s_setprio 0
    s_lshr_b32 s40, s18, 3
    s_sub_u32 s40, 3, s40
    s_lshl_b32 s21, s17, 2
    s_add_u32 s40, s40, s21
    s_and_b32 s41, s18, 7
    s_lshl_b32 s21, s40, 2
    s_add_u32 s21, s21, s16
    s_mul_i32 s24, s21, 20480
    s_add_u32 s24, s24, 6815744
    s_add_u32 s25, s24, 4096
    s_add_u32 s26, s25, 4096
    s_add_u32 s27, s26, 4096
    s_add_u32 s28, s27, 4096
    s_lshl_b32 s42, s41, 2
    s_add_u32 s42, s42, s16
    s_mul_i32 s42, s42, 3
    s_mul_i32 s44, s42, 20480
    s_add_u32 s44, s44, 29884416
    s_add_u32 s45, s44, 20480
    s_add_u32 s46, s45, 20480
    s_mov_b32 s29, 7680
    s_add_u32 s30, s29, 4096
    s_lshl_b32 s47, s18, 2
    s_add_u32 s47, s47, s16
    s_mul_i32 s47, s47, 15360
    s_add_u32 s47, s47, 31850496
    s_add_u32 s43, s47, 7168
    buffer_load_dwordx4 v[96:99], v5, s[4:7], s29 offen offset:0 sc1
    buffer_load_dwordx4 v[100:103], v5, s[4:7], s29 offen offset:1024 sc1
    buffer_load_dwordx4 v[104:107], v5, s[4:7], s29 offen offset:2048 sc1
    buffer_load_dwordx4 v[108:111], v5, s[4:7], s29 offen offset:3072 sc1
    buffer_load_dwordx4 v[112:115], v5, s[4:7], s30 offen offset:0 sc1
    v_lshlrev_b32 v12, 3, v1
    s_lshl_b32 s31, s42, 5
    buffer_load_dwordx2 v[250:251], v12, s[8:11], s31 offen offset:0
    buffer_load_dwordx2 v[252:253], v12, s[8:11], s31 offen offset:32
    buffer_load_dwordx2 v[254:255], v12, s[8:11], s31 offen offset:64
    s_waitcnt vmcnt(0)
    v_add_u32 v13, 135168, v5
    v_cmp_le_u32 vcc, 32, v0
    v_mov_b32 v6, 1.0
    s_nop 0
    v_cndmask_b32 v6, 0, v6, vcc
    v_add_f32 v104, v6, v104
    v_add_f32 v105, v6, v105
    v_add_f32 v106, v6, v106
    v_add_f32 v107, v6, v107
    v_add_f32 v108, 1.0, v108
    v_add_f32 v109, 1.0, v109
    v_add_f32 v110, 1.0, v110
    v_add_f32 v111, 1.0, v111
    v_add_f32 v112, 1.0, v112
    v_add_f32 v113, 1.0, v113
    v_add_f32 v114, 1.0, v114
    v_add_f32 v115, 1.0, v115
    ds_write_b128 v13, v[96:99] offset:0
    ds_write_b128 v13, v[100:103] offset:1024
    ds_write_b128 v13, v[104:107] offset:2048
    ds_write_b128 v13, v[108:111] offset:3072
    ds_write_b128 v13, v[112:115] offset:4096
    v_mov_b32 v152, 0x3f803f80
    v_mov_b32 v153, 0x3f803f80
    v_mov_b32 v154, 0x3f803f80
    v_mov_b32 v155, 0x3f803f80
    buffer_load_dwordx4 v[176:179], v5, s[4:7], s44 offen offset:0
    s_sleep 1
    buffer_load_dwordx4 v[180:183], v5, s[4:7], s45 offen offset:0
    s_sleep 1
    buffer_load_dwordx4 v[184:187], v5, s[4:7], s46 offen offset:0
    s_sleep 1
    buffer_load_dwordx4 v[188:191], v5, s[4:7], s44 offen offset:1024
    s_sleep 1
    buffer_load_dwordx4 v[192:195], v5, s[4:7], s45 offen offset:1024
    s_sleep 1
    buffer_load_dwordx4 v[196:199], v5, s[4:7], s46 offen offset:1024
    s_sleep 1
    buffer_load_dwordx4 v[200:203], v5, s[4:7], s44 offen offset:2048
    s_sleep 1
    buffer_load_dwordx4 v[204:207], v5, s[4:7], s45 offen offset:2048
    s_sleep 1
    buffer_load_dwordx4 v[208:211], v5, s[4:7], s46 offen offset:2048
    s_sleep 1
    buffer_load_dwordx4 v[212:215], v5, s[4:7], s44 offen offset:3072
    s_add_u32 s44, s44, 4096
    s_sleep 1
    buffer_load_dwordx4 v[216:219], v5, s[4:7], s45 offen offset:3072
    s_add_u32 s45, s45, 4096
    s_sleep 1
    buffer_load_dwordx4 v[220:223], v5, s[4:7], s46 offen offset:3072
    s_add_u32 s46, s46, 4096
    s_sleep 1
    buffer_load_dwordx4 v[224:227], v5, s[4:7], s44 offen offset:0
    s_sleep 1
    buffer_load_dwordx4 v[228:231], v5, s[4:7], s45 offen offset:0
    s_sleep 1
    buffer_load_dwordx4 v[232:235], v5, s[4:7], s46 offen offset:0
    s_sleep 1
    buffer_load_dwordx4 v[236:239], v5, s[4:7], s44 offen offset:1024
    s_sleep 1
    buffer_load_dwordx4 v[240:243], v5, s[4:7], s45 offen offset:1024
    s_sleep 1
    buffer_load_dwordx4 v[244:247], v5, s[4:7], s46 offen offset:1024
    s_sleep 1
    v_mul_u32_u24 v6, 13, v0
    v_lshrrev_b32 v6, 8, v6
    v_mul_u32_u24 v7, 20, v6
    v_sub_u32 v7, v0, v7
    s_mul_i32 s21, s16, 5440
    v_mul_u32_u24 v8, 272, v7
    v_lshl_add_u32 v8, v6, 4, v8
    v_add_u32 v8, s21, v8
    s_mul_i32 s21, s41, 20
    v_add_u32 v7, s21, v7
    v_lshlrev_b32 v11, 3, v7
    v_mul_u32_u24 v9, 1280, v6
    v_add_u32 v9, v9, v11
    v_lshrrev_b32 v12, 1, v7
    v_lshlrev_b32 v10, 8, v12
    v_lshl_add_u32 v10, v6, 4, v10
    v_and_b32 v12, 1, v7
    v_lshl_add_u32 v10, v12, 3, v10
    v_lshlrev_b32 v15, 7, v0
    s_waitcnt lgkmcnt(0)
    s_barrier
    buffer_load_dwordx4 v[16:19], v5, s[4:7], s24 offen offset:0 sc1
    buffer_load_dwordx4 v[20:23], v5, s[4:7], s24 offen offset:1024 sc1
    buffer_load_dwordx4 v[24:27], v5, s[4:7], s24 offen offset:2048 sc1
    buffer_load_dwordx4 v[28:31], v5, s[4:7], s24 offen offset:3072 sc1
    buffer_load_dwordx4 v[32:35], v5, s[4:7], s25 offen offset:0 sc1
    buffer_load_dwordx4 v[36:39], v5, s[4:7], s25 offen offset:1024 sc1
    buffer_load_dwordx4 v[40:43], v5, s[4:7], s25 offen offset:2048 sc1
    buffer_load_dwordx4 v[44:47], v5, s[4:7], s25 offen offset:3072 sc1
    buffer_load_dwordx4 v[48:51], v5, s[4:7], s26 offen offset:0 sc1
    buffer_load_dwordx4 v[52:55], v5, s[4:7], s26 offen offset:1024 sc1
    buffer_load_dwordx4 v[56:59], v5, s[4:7], s26 offen offset:2048 sc1
    buffer_load_dwordx4 v[60:63], v5, s[4:7], s26 offen offset:3072 sc1
    buffer_load_dwordx4 v[64:67], v5, s[4:7], s27 offen offset:0 sc1
    buffer_load_dwordx4 v[68:71], v5, s[4:7], s27 offen offset:1024 sc1
    buffer_load_dwordx4 v[72:75], v5, s[4:7], s27 offen offset:2048 sc1
    buffer_load_dwordx4 v[76:79], v5, s[4:7], s27 offen offset:3072 sc1
    buffer_load_dwordx4 v[80:83], v5, s[4:7], s28 offen offset:0 sc1
    buffer_load_dwordx4 v[84:87], v5, s[4:7], s28 offen offset:1024 sc1
    buffer_load_dwordx4 v[88:91], v5, s[4:7], s28 offen offset:2048 sc1
    buffer_load_dwordx4 v[92:95], v5, s[4:7], s28 offen offset:3072 sc1
    buffer_load_dword v248, v15, s[4:7], s47 offen
    buffer_load_dword v249, v15, s[4:7], s43 offen
    s_waitcnt vmcnt(21)
    v_max3_u32 v12, v16, v17, v18
    v_max_u32 v12, v12, v19
    v_mfma_f32_16x16x32_bf16 v[144:147], v[152:155], v[16:19], 0
    v_mfma_f32_16x16x32_bf16 v[148:151], v[16:19], v[16:19], 0
    s_waitcnt vmcnt(20)
    v_max3_u32 v12, v12, v20, v21
    v_max3_u32 v12, v12, v22, v23
    v_mfma_f32_16x16x32_bf16 v[144:147], v[152:155], v[20:23], v[144:147]
    v_mfma_f32_16x16x32_bf16 v[148:151], v[20:23], v[20:23], v[148:151]
    s_waitcnt vmcnt(19)
    v_max3_u32 v12, v12, v24, v25
    v_max3_u32 v12, v12, v26, v27
    v_mfma_f32_16x16x32_bf16 v[144:147], v[152:155], v[24:27], v[144:147]
    v_mfma_f32_16x16x32_bf16 v[148:151], v[24:27], v[24:27], v[148:151]
    s_waitcnt vmcnt(18)
    v_max3_u32 v12, v12, v28, v29
    v_max3_u32 v12, v12, v30, v31
    v_mfma_f32_16x16x32_bf16 v[144:147], v[152:155], v[28:31], v[144:147]
    v_mfma_f32_16x16x32_bf16 v[148:151], v[28:31], v[28:31], v[148:151]
    s_waitcnt vmcnt(17)
    v_max3_u32 v12, v12, v32, v33
    v_max3_u32 v12, v12, v34, v35
    v_mfma_f32_16x16x32_bf16 v[144:147], v[152:155], v[32:35], v[144:147]
    v_mfma_f32_16x16x32_bf16 v[148:151], v[32:35], v[32:35], v[148:151]
    s_waitcnt vmcnt(16)
    v_max3_u32 v12, v12, v36, v37
    v_max3_u32 v12, v12, v38, v39
    v_mfma_f32_16x16x32_bf16 v[144:147], v[152:155], v[36:39], v[144:147]
    v_mfma_f32_16x16x32_bf16 v[148:151], v[36:39], v[36:39], v[148:151]
    s_waitcnt vmcnt(15)
    v_max3_u32 v12, v12, v40, v41
    v_max3_u32 v12, v12, v42, v43
    v_mfma_f32_16x16x32_bf16 v[144:147], v[152:155], v[40:43], v[144:147]
    v_mfma_f32_16x16x32_bf16 v[148:151], v[40:43], v[40:43], v[148:151]
    s_waitcnt vmcnt(14)
    v_max3_u32 v12, v12, v44, v45
    v_max3_u32 v12, v12, v46, v47
    v_mfma_f32_16x16x32_bf16 v[144:147], v[152:155], v[44:47], v[144:147]
    v_mfma_f32_16x16x32_bf16 v[148:151], v[44:47], v[44:47], v[148:151]
    s_waitcnt vmcnt(13)
    v_max3_u32 v12, v12, v48, v49
    v_max3_u32 v12, v12, v50, v51
    v_mfma_f32_16x16x32_bf16 v[144:147], v[152:155], v[48:51], v[144:147]
    v_mfma_f32_16x16x32_bf16 v[148:151], v[48:51], v[48:51], v[148:151]
    s_waitcnt vmcnt(12)
    v_max3_u32 v12, v12, v52, v53
    v_max3_u32 v12, v12, v54, v55
    v_mfma_f32_16x16x32_bf16 v[144:147], v[152:155], v[52:55], v[144:147]
    v_mfma_f32_16x16x32_bf16 v[148:151], v[52:55], v[52:55], v[148:151]
    s_waitcnt vmcnt(11)
    v_max3_u32 v12, v12, v56, v57
    v_max3_u32 v12, v12, v58, v59
    v_mfma_f32_16x16x32_bf16 v[144:147], v[152:155], v[56:59], v[144:147]
    v_mfma_f32_16x16x32_bf16 v[148:151], v[56:59], v[56:59], v[148:151]
    s_waitcnt vmcnt(10)
    v_max3_u32 v12, v12, v60, v61
    v_max3_u32 v12, v12, v62, v63
    v_mfma_f32_16x16x32_bf16 v[144:147], v[152:155], v[60:63], v[144:147]
    v_mfma_f32_16x16x32_bf16 v[148:151], v[60:63], v[60:63], v[148:151]
    s_waitcnt vmcnt(9)
    v_max3_u32 v12, v12, v64, v65
    v_max3_u32 v12, v12, v66, v67
    v_mfma_f32_16x16x32_bf16 v[144:147], v[152:155], v[64:67], v[144:147]
    v_mfma_f32_16x16x32_bf16 v[148:151], v[64:67], v[64:67], v[148:151]
    s_waitcnt vmcnt(8)
    v_max3_u32 v12, v12, v68, v69
    v_max3_u32 v12, v12, v70, v71
    v_mfma_f32_16x16x32_bf16 v[144:147], v[152:155], v[68:71], v[144:147]
    v_mfma_f32_16x16x32_bf16 v[148:151], v[68:71], v[68:71], v[148:151]
    s_waitcnt vmcnt(7)
    v_max3_u32 v12, v12, v72, v73
    v_max3_u32 v12, v12, v74, v75
    v_mfma_f32_16x16x32_bf16 v[144:147], v[152:155], v[72:75], v[144:147]
    v_mfma_f32_16x16x32_bf16 v[148:151], v[72:75], v[72:75], v[148:151]
    s_waitcnt vmcnt(6)
    v_max3_u32 v12, v12, v76, v77
    v_max3_u32 v12, v12, v78, v79
    v_mfma_f32_16x16x32_bf16 v[144:147], v[152:155], v[76:79], v[144:147]
    v_mfma_f32_16x16x32_bf16 v[148:151], v[76:79], v[76:79], v[148:151]
    s_waitcnt vmcnt(5)
    v_max3_u32 v12, v12, v80, v81
    v_max3_u32 v12, v12, v82, v83
    v_mfma_f32_16x16x32_bf16 v[144:147], v[152:155], v[80:83], v[144:147]
    v_mfma_f32_16x16x32_bf16 v[148:151], v[80:83], v[80:83], v[148:151]
    s_waitcnt vmcnt(4)
    v_max3_u32 v12, v12, v84, v85
    v_max3_u32 v12, v12, v86, v87
    v_mfma_f32_16x16x32_bf16 v[144:147], v[152:155], v[84:87], v[144:147]
    v_mfma_f32_16x16x32_bf16 v[148:151], v[84:87], v[84:87], v[148:151]
    s_waitcnt vmcnt(3)
    v_max3_u32 v12, v12, v88, v89
    v_max3_u32 v12, v12, v90, v91
    v_mfma_f32_16x16x32_bf16 v[144:147], v[152:155], v[88:91], v[144:147]
    v_mfma_f32_16x16x32_bf16 v[148:151], v[88:91], v[88:91], v[148:151]
    s_waitcnt vmcnt(2)
    v_max3_u32 v12, v12, v92, v93
    v_max3_u32 v12, v12, v94, v95
    v_mfma_f32_16x16x32_bf16 v[144:147], v[152:155], v[92:95], v[144:147]
    v_mfma_f32_16x16x32_bf16 v[148:151], v[92:95], v[92:95], v[148:151]
    v_cmp_eq_u32 vcc, -1, v12
    s_cbranch_vccnz L_gr_133
L_gd_136:
    v_lshlrev_b32 v14, 5, v1
    v_add_u32 v14, 135168, v14
    v_lshlrev_b32 v6, 2, v1
    v_sub_u32 v6, v2, v6
    v_mov_b32 v156, 0
    ds_read_b128 v[96:99], v14 offset:0
    ds_read_b128 v[100:103], v14 offset:16
    ds_read_b128 v[104:107], v14 offset:2560
    ds_read_b128 v[108:111], v14 offset:2576
    ds_read_b128 v[112:115], v14 offset:128
    ds_read_b128 v[116:119], v14 offset:144
    ds_read_b128 v[120:123], v14 offset:2688
    ds_read_b128 v[124:127], v14 offset:2704
    v_cmp_eq_u32 vcc, 0, v6
    s_nop 1
    v_cndmask_b32 v156, v156, v148, vcc
    v_cmp_eq_u32 vcc, 1, v6
    s_nop 1
    v_cndmask_b32 v156, v156, v149, vcc
    v_cmp_eq_u32 vcc, 2, v6
    s_nop 1
    v_cndmask_b32 v156, v156, v150, vcc
    v_cmp_eq_u32 vcc, 3, v6
    s_nop 1
    v_cndmask_b32 v156, v156, v151, vcc
    v_mov_b32 v157, v156
    s_nop 1
    v_permlane32_swap_b32 v157, v156
    v_add_f32 v156, v156, v157
    v_mov_b32 v157, v156
    s_nop 1
    v_permlane16_swap_b32 v157, v156
    v_add_f32 v156, v156, v157
    v_mul_f32 v144, 0x3acccccd, v144
    v_mul_f32 v156, 0x3acccccd, v156
    v_fma_f32 v156, -v144, v144, v156
    v_max_f32 v156, 0, v156
    v_add_f32 v156, 0x3727c5ac, v156
    v_rsq_f32 v146, v156
    s_mul_i32 s31, s16, 20480
    v_add_u32 v13, s31, v5
    v_mul_f32 v144, v144, v146
    v_lshlrev_b32 v152, 16, v16
    v_and_b32 v153, 0xffff0000, v16
    v_lshlrev_b32 v154, 16, v17
    v_and_b32 v155, 0xffff0000, v17
    v_lshlrev_b32 v156, 16, v18
    v_and_b32 v157, 0xffff0000, v18
    v_lshlrev_b32 v158, 16, v19
    v_and_b32 v159, 0xffff0000, v19
    buffer_load_dwordx4 v[16:19], v5, s[4:7], s44 offen offset:2048
    v_pk_fma_f32 v[152:153], v[152:153], v[146:147], v[144:145] op_sel_hi:[1,0,0] neg_lo:[0,0,1] neg_hi:[0,0,1]
    v_pk_fma_f32 v[154:155], v[154:155], v[146:147], v[144:145] op_sel_hi:[1,0,0] neg_lo:[0,0,1] neg_hi:[0,0,1]
    v_pk_fma_f32 v[156:157], v[156:157], v[146:147], v[144:145] op_sel_hi:[1,0,0] neg_lo:[0,0,1] neg_hi:[0,0,1]
    v_pk_fma_f32 v[158:159], v[158:159], v[146:147], v[144:145] op_sel_hi:[1,0,0] neg_lo:[0,0,1] neg_hi:[0,0,1]
    s_waitcnt lgkmcnt(4)
    v_pk_fma_f32 v[152:153], v[152:153], v[104:105], v[96:97]
    v_pk_fma_f32 v[154:155], v[154:155], v[106:107], v[98:99]
    v_pk_fma_f32 v[156:157], v[156:157], v[108:109], v[100:101]
    v_pk_fma_f32 v[158:159], v[158:159], v[110:111], v[102:103]
    v_cvt_pk_bf16_f32 v160, v152, v153
    v_cvt_pk_bf16_f32 v161, v154, v155
    v_cvt_pk_bf16_f32 v162, v156, v157
    v_cvt_pk_bf16_f32 v163, v158, v159
    ds_read_b128 v[128:131], v14 offset:256
    ds_read_b128 v[132:135], v14 offset:272
    ds_read_b128 v[136:139], v14 offset:2816
    ds_read_b128 v[140:143], v14 offset:2832
    ds_write_b128 v13, v[160:163] offset:0
    v_lshlrev_b32 v152, 16, v20
    v_and_b32 v153, 0xffff0000, v20
    v_lshlrev_b32 v154, 16, v21
    v_and_b32 v155, 0xffff0000, v21
    v_lshlrev_b32 v156, 16, v22
    v_and_b32 v157, 0xffff0000, v22
    v_lshlrev_b32 v158, 16, v23
    v_and_b32 v159, 0xffff0000, v23
    buffer_load_dwordx4 v[20:23], v5, s[4:7], s45 offen offset:2048
    v_pk_fma_f32 v[152:153], v[152:153], v[146:147], v[144:145] op_sel_hi:[1,0,0] neg_lo:[0,0,1] neg_hi:[0,0,1]
    v_pk_fma_f32 v[154:155], v[154:155], v[146:147], v[144:145] op_sel_hi:[1,0,0] neg_lo:[0,0,1] neg_hi:[0,0,1]
    v_pk_fma_f32 v[156:157], v[156:157], v[146:147], v[144:145] op_sel_hi:[1,0,0] neg_lo:[0,0,1] neg_hi:[0,0,1]
    v_pk_fma_f32 v[158:159], v[158:159], v[146:147], v[144:145] op_sel_hi:[1,0,0] neg_lo:[0,0,1] neg_hi:[0,0,1]
    s_waitcnt lgkmcnt(5)
    v_pk_fma_f32 v[152:153], v[152:153], v[120:121], v[112:113]
    v_pk_fma_f32 v[154:155], v[154:155], v[122:123], v[114:115]
    v_pk_fma_f32 v[156:157], v[156:157], v[124:125], v[116:117]
    v_pk_fma_f32 v[158:159], v[158:159], v[126:127], v[118:119]
    v_cvt_pk_bf16_f32 v164, v152, v153
    v_cvt_pk_bf16_f32 v165, v154, v155
    v_cvt_pk_bf16_f32 v166, v156, v157
    v_cvt_pk_bf16_f32 v167, v158, v159
    ds_read_b128 v[96:99], v14 offset:384
    ds_read_b128 v[100:103], v14 offset:400
    ds_read_b128 v[104:107], v14 offset:2944
    ds_read_b128 v[108:111], v14 offset:2960
    ds_write_b128 v13, v[164:167] offset:1024
    v_lshlrev_b32 v152, 16, v24
    v_and_b32 v153, 0xffff0000, v24
    v_lshlrev_b32 v154, 16, v25
    v_and_b32 v155, 0xffff0000, v25
    v_lshlrev_b32 v156, 16, v26
    v_and_b32 v157, 0xffff0000, v26
    v_lshlrev_b32 v158, 16, v27
    v_and_b32 v159, 0xffff0000, v27
    buffer_load_dwordx4 v[24:27], v5, s[4:7], s46 offen offset:2048
    v_pk_fma_f32 v[152:153], v[152:153], v[146:147], v[144:145] op_sel_hi:[1,0,0] neg_lo:[0,0,1] neg_hi:[0,0,1]
    v_pk_fma_f32 v[154:155], v[154:155], v[146:147], v[144:145] op_sel_hi:[1,0,0] neg_lo:[0,0,1] neg_hi:[0,0,1]
    v_pk_fma_f32 v[156:157], v[156:157], v[146:147], v[144:145] op_sel_hi:[1,0,0] neg_lo:[0,0,1] neg_hi:[0,0,1]
    v_pk_fma_f32 v[158:159], v[158:159], v[146:147], v[144:145] op_sel_hi:[1,0,0] neg_lo:[0,0,1] neg_hi:[0,0,1]
    s_waitcnt lgkmcnt(5)
    v_pk_fma_f32 v[152:153], v[152:153], v[136:137], v[128:129]
    v_pk_fma_f32 v[154:155], v[154:155], v[138:139], v[130:131]
    v_pk_fma_f32 v[156:157], v[156:157], v[140:141], v[132:133]
    v_pk_fma_f32 v[158:159], v[158:159], v[142:143], v[134:135]
    v_cvt_pk_bf16_f32 v160, v152, v153
    v_cvt_pk_bf16_f32 v161, v154, v155
    v_cvt_pk_bf16_f32 v162, v156, v157
    v_cvt_pk_bf16_f32 v163, v158, v159
    ds_read_b128 v[112:115], v14 offset:512
    ds_read_b128 v[116:119], v14 offset:528
    ds_read_b128 v[120:123], v14 offset:3072
    ds_read_b128 v[124:127], v14 offset:3088
    ds_write_b128 v13, v[160:163] offset:2048
    v_lshlrev_b32 v152, 16, v28
    v_and_b32 v153, 0xffff0000, v28
    v_lshlrev_b32 v154, 16, v29
    v_and_b32 v155, 0xffff0000, v29
    v_lshlrev_b32 v156, 16, v30
    v_and_b32 v157, 0xffff0000, v30
    v_lshlrev_b32 v158, 16, v31
    v_and_b32 v159, 0xffff0000, v31
    buffer_load_dwordx4 v[28:31], v5, s[4:7], s44 offen offset:3072
    s_add_u32 s44, s44, 4096
    v_pk_fma_f32 v[152:153], v[152:153], v[146:147], v[144:145] op_sel_hi:[1,0,0] neg_lo:[0,0,1] neg_hi:[0,0,1]
    v_pk_fma_f32 v[154:155], v[154:155], v[146:147], v[144:145] op_sel_hi:[1,0,0] neg_lo:[0,0,1] neg_hi:[0,0,1]
    v_pk_fma_f32 v[156:157], v[156:157], v[146:147], v[144:145] op_sel_hi:[1,0,0] neg_lo:[0,0,1] neg_hi:[0,0,1]
    v_pk_fma_f32 v[158:159], v[158:159], v[146:147], v[144:145] op_sel_hi:[1,0,0] neg_lo:[0,0,1] neg_hi:[0,0,1]
    s_waitcnt lgkmcnt(5)
    v_pk_fma_f32 v[152:153], v[152:153], v[104:105], v[96:97]
    v_pk_fma_f32 v[154:155], v[154:155], v[106:107], v[98:99]
    v_pk_fma_f32 v[156:157], v[156:157], v[108:109], v[100:101]
    v_pk_fma_f32 v[158:159], v[158:159], v[110:111], v[102:103]
    v_cvt_pk_bf16_f32 v164, v152, v153
    v_cvt_pk_bf16_f32 v165, v154, v155
    v_cvt_pk_bf16_f32 v166, v156, v157
    v_cvt_pk_bf16_f32 v167, v158, v159
    ds_read_b128 v[128:131], v14 offset:640
    ds_read_b128 v[132:135], v14 offset:656
    ds_read_b128 v[136:139], v14 offset:3200
    ds_read_b128 v[140:143], v14 offset:3216
    ds_write_b128 v13, v[164:167] offset:3072
    v_lshlrev_b32 v152, 16, v32
    v_and_b32 v153, 0xffff0000, v32
    v_lshlrev_b32 v154, 16, v33
    v_and_b32 v155, 0xffff0000, v33
    v_lshlrev_b32 v156, 16, v34
    v_and_b32 v157, 0xffff0000, v34
    v_lshlrev_b32 v158, 16, v35
    v_and_b32 v159, 0xffff0000, v35
    buffer_load_dwordx4 v[32:35], v5, s[4:7], s45 offen offset:3072
    s_add_u32 s45, s45, 4096
    v_pk_fma_f32 v[152:153], v[152:153], v[146:147], v[144:145] op_sel_hi:[1,0,0] neg_lo:[0,0,1] neg_hi:[0,0,1]
    v_pk_fma_f32 v[154:155], v[154:155], v[146:147], v[144:145] op_sel_hi:[1,0,0] neg_lo:[0,0,1] neg_hi:[0,0,1]
    v_pk_fma_f32 v[156:157], v[156:157], v[146:147], v[144:145] op_sel_hi:[1,0,0] neg_lo:[0,0,1] neg_hi:[0,0,1]
    v_pk_fma_f32 v[158:159], v[158:159], v[146:147], v[144:145] op_sel_hi:[1,0,0] neg_lo:[0,0,1] neg_hi:[0,0,1]
    s_waitcnt lgkmcnt(5)
    v_pk_fma_f32 v[152:153], v[152:153], v[120:121], v[112:113]
    v_pk_fma_f32 v[154:155], v[154:155], v[122:123], v[114:115]
    v_pk_fma_f32 v[156:157], v[156:157], v[124:125], v[116:117]
    v_pk_fma_f32 v[158:159], v[158:159], v[126:127], v[118:119]
    v_cvt_pk_bf16_f32 v160, v152, v153
    v_cvt_pk_bf16_f32 v161, v154, v155
    v_cvt_pk_bf16_f32 v162, v156, v157
    v_cvt_pk_bf16_f32 v163, v158, v159
    ds_read_b128 v[96:99], v14 offset:768
    ds_read_b128 v[100:103], v14 offset:784
    ds_read_b128 v[104:107], v14 offset:3328
    ds_read_b128 v[108:111], v14 offset:3344
    ds_write_b128 v13, v[160:163] offset:4096
    v_lshlrev_b32 v152, 16, v36
    v_and_b32 v153, 0xffff0000, v36
    v_lshlrev_b32 v154, 16, v37
    v_and_b32 v155, 0xffff0000, v37
    v_lshlrev_b32 v156, 16, v38
    v_and_b32 v157, 0xffff0000, v38
    v_lshlrev_b32 v158, 16, v39
    v_and_b32 v159, 0xffff0000, v39
    buffer_load_dwordx4 v[36:39], v5, s[4:7], s46 offen offset:3072
    s_add_u32 s46, s46, 4096
    v_pk_fma_f32 v[152:153], v[152:153], v[146:147], v[144:145] op_sel_hi:[1,0,0] neg_lo:[0,0,1] neg_hi:[0,0,1]
    v_pk_fma_f32 v[154:155], v[154:155], v[146:147], v[144:145] op_sel_hi:[1,0,0] neg_lo:[0,0,1] neg_hi:[0,0,1]
    v_pk_fma_f32 v[156:157], v[156:157], v[146:147], v[144:145] op_sel_hi:[1,0,0] neg_lo:[0,0,1] neg_hi:[0,0,1]
    v_pk_fma_f32 v[158:159], v[158:159], v[146:147], v[144:145] op_sel_hi:[1,0,0] neg_lo:[0,0,1] neg_hi:[0,0,1]
    s_waitcnt lgkmcnt(5)
    v_pk_fma_f32 v[152:153], v[152:153], v[136:137], v[128:129]
    v_pk_fma_f32 v[154:155], v[154:155], v[138:139], v[130:131]
    v_pk_fma_f32 v[156:157], v[156:157], v[140:141], v[132:133]
    v_pk_fma_f32 v[158:159], v[158:159], v[142:143], v[134:135]
    v_cvt_pk_bf16_f32 v164, v152, v153
    v_cvt_pk_bf16_f32 v165, v154, v155
    v_cvt_pk_bf16_f32 v166, v156, v157
    v_cvt_pk_bf16_f32 v167, v158, v159
    ds_read_b128 v[112:115], v14 offset:896
    ds_read_b128 v[116:119], v14 offset:912
    ds_read_b128 v[120:123], v14 offset:3456
    ds_read_b128 v[124:127], v14 offset:3472
    ds_write_b128 v13, v[164:167] offset:5120
    v_lshlrev_b32 v152, 16, v40
    v_and_b32 v153, 0xffff0000, v40
    v_lshlrev_b32 v154, 16, v41
    v_and_b32 v155, 0xffff0000, v41
    v_lshlrev_b32 v156, 16, v42
    v_and_b32 v157, 0xffff0000, v42
    v_lshlrev_b32 v158, 16, v43
    v_and_b32 v159, 0xffff0000, v43
    buffer_load_dwordx4 v[40:43], v5, s[4:7], s44 offen offset:0
    v_pk_fma_f32 v[152:153], v[152:153], v[146:147], v[144:145] op_sel_hi:[1,0,0] neg_lo:[0,0,1] neg_hi:[0,0,1]
    v_pk_fma_f32 v[154:155], v[154:155], v[146:147], v[144:145] op_sel_hi:[1,0,0] neg_lo:[0,0,1] neg_hi:[0,0,1]
    v_pk_fma_f32 v[156:157], v[156:157], v[146:147], v[144:145] op_sel_hi:[1,0,0] neg_lo:[0,0,1] neg_hi:[0,0,1]
    v_pk_fma_f32 v[158:159], v[158:159], v[146:147], v[144:145] op_sel_hi:[1,0,0] neg_lo:[0,0,1] neg_hi:[0,0,1]
    s_waitcnt lgkmcnt(5)
    v_pk_fma_f32 v[152:153], v[152:153], v[104:105], v[96:97]
    v_pk_fma_f32 v[154:155], v[154:155], v[106:107], v[98:99]
    v_pk_fma_f32 v[156:157], v[156:157], v[108:109], v[100:101]
    v_pk_fma_f32 v[158:159], v[158:159], v[110:111], v[102:103]
    v_cvt_pk_bf16_f32 v160, v152, v153
    v_cvt_pk_bf16_f32 v161, v154, v155
    v_cvt_pk_bf16_f32 v162, v156, v157
    v_cvt_pk_bf16_f32 v163, v158, v159
    ds_read_b128 v[128:131], v14 offset:1024
    ds_read_b128 v[132:135], v14 offset:1040
    ds_read_b128 v[136:139], v14 offset:3584
    ds_read_b128 v[140:143], v14 offset:3600
    ds_write_b128 v13, v[160:163] offset:6144
    v_lshlrev_b32 v152, 16, v44
    v_and_b32 v153, 0xffff0000, v44
    v_lshlrev_b32 v154, 16, v45
    v_and_b32 v155, 0xffff0000, v45
    v_lshlrev_b32 v156, 16, v46
    v_and_b32 v157, 0xffff0000, v46
    v_lshlrev_b32 v158, 16, v47
    v_and_b32 v159, 0xffff0000, v47
    buffer_load_dwordx4 v[44:47], v5, s[4:7], s45 offen offset:0
    v_pk_fma_f32 v[152:153], v[152:153], v[146:147], v[144:145] op_sel_hi:[1,0,0] neg_lo:[0,0,1] neg_hi:[0,0,1]
    v_pk_fma_f32 v[154:155], v[154:155], v[146:147], v[144:145] op_sel_hi:[1,0,0] neg_lo:[0,0,1] neg_hi:[0,0,1]
    v_pk_fma_f32 v[156:157], v[156:157], v[146:147], v[144:145] op_sel_hi:[1,0,0] neg_lo:[0,0,1] neg_hi:[0,0,1]
    v_pk_fma_f32 v[158:159], v[158:159], v[146:147], v[144:145] op_sel_hi:[1,0,0] neg_lo:[0,0,1] neg_hi:[0,0,1]
    s_waitcnt lgkmcnt(5)
    v_pk_fma_f32 v[152:153], v[152:153], v[120:121], v[112:113]
    v_pk_fma_f32 v[154:155], v[154:155], v[122:123], v[114:115]
    v_pk_fma_f32 v[156:157], v[156:157], v[124:125], v[116:117]
    v_pk_fma_f32 v[158:159], v[158:159], v[126:127], v[118:119]
    v_cvt_pk_bf16_f32 v164, v152, v153
    v_cvt_pk_bf16_f32 v165, v154, v155
    v_cvt_pk_bf16_f32 v166, v156, v157
    v_cvt_pk_bf16_f32 v167, v158, v159
    ds_read_b128 v[96:99], v14 offset:1152
    ds_read_b128 v[100:103], v14 offset:1168
    ds_read_b128 v[104:107], v14 offset:3712
    ds_read_b128 v[108:111], v14 offset:3728
    ds_write_b128 v13, v[164:167] offset:7168
    v_lshlrev_b32 v152, 16, v48
    v_and_b32 v153, 0xffff0000, v48
    v_lshlrev_b32 v154, 16, v49
    v_and_b32 v155, 0xffff0000, v49
    v_lshlrev_b32 v156, 16, v50
    v_and_b32 v157, 0xffff0000, v50
    v_lshlrev_b32 v158, 16, v51
    v_and_b32 v159, 0xffff0000, v51
    buffer_load_dwordx4 v[48:51], v5, s[4:7], s46 offen offset:0
    v_pk_fma_f32 v[152:153], v[152:153], v[146:147], v[144:145] op_sel_hi:[1,0,0] neg_lo:[0,0,1] neg_hi:[0,0,1]
    v_pk_fma_f32 v[154:155], v[154:155], v[146:147], v[144:145] op_sel_hi:[1,0,0] neg_lo:[0,0,1] neg_hi:[0,0,1]
    v_pk_fma_f32 v[156:157], v[156:157], v[146:147], v[144:145] op_sel_hi:[1,0,0] neg_lo:[0,0,1] neg_hi:[0,0,1]
    v_pk_fma_f32 v[158:159], v[158:159], v[146:147], v[144:145] op_sel_hi:[1,0,0] neg_lo:[0,0,1] neg_hi:[0,0,1]
    s_waitcnt lgkmcnt(5)
    v_pk_fma_f32 v[152:153], v[152:153], v[136:137], v[128:129]
    v_pk_fma_f32 v[154:155], v[154:155], v[138:139], v[130:131]
    v_pk_fma_f32 v[156:157], v[156:157], v[140:141], v[132:133]
    v_pk_fma_f32 v[158:159], v[158:159], v[142:143], v[134:135]
    v_cvt_pk_bf16_f32 v160, v152, v153
    v_cvt_pk_bf16_f32 v161, v154, v155
    v_cvt_pk_bf16_f32 v162, v156, v157
    v_cvt_pk_bf16_f32 v163, v158, v159
    ds_read_b128 v[112:115], v14 offset:1280
    ds_read_b128 v[116:119], v14 offset:1296
    ds_read_b128 v[120:123], v14 offset:3840
    ds_read_b128 v[124:127], v14 offset:3856
    ds_write_b128 v13, v[160:163] offset:8192
    v_lshlrev_b32 v152, 16, v52
    v_and_b32 v153, 0xffff0000, v52
    v_lshlrev_b32 v154, 16, v53
    v_and_b32 v155, 0xffff0000, v53
    v_lshlrev_b32 v156, 16, v54
    v_and_b32 v157, 0xffff0000, v54
    v_lshlrev_b32 v158, 16, v55
    v_and_b32 v159, 0xffff0000, v55
    buffer_load_dwordx4 v[52:55], v5, s[4:7], s44 offen offset:1024
    v_pk_fma_f32 v[152:153], v[152:153], v[146:147], v[144:145] op_sel_hi:[1,0,0] neg_lo:[0,0,1] neg_hi:[0,0,1]
    v_pk_fma_f32 v[154:155], v[154:155], v[146:147], v[144:145] op_sel_hi:[1,0,0] neg_lo:[0,0,1] neg_hi:[0,0,1]
    v_pk_fma_f32 v[156:157], v[156:157], v[146:147], v[144:145] op_sel_hi:[1,0,0] neg_lo:[0,0,1] neg_hi:[0,0,1]
    v_pk_fma_f32 v[158:159], v[158:159], v[146:147], v[144:145] op_sel_hi:[1,0,0] neg_lo:[0,0,1] neg_hi:[0,0,1]
    s_waitcnt lgkmcnt(5)
    v_pk_fma_f32 v[152:153], v[152:153], v[104:105], v[96:97]
    v_pk_fma_f32 v[154:155], v[154:155], v[106:107], v[98:99]
    v_pk_fma_f32 v[156:157], v[156:157], v[108:109], v[100:101]
    v_pk_fma_f32 v[158:159], v[158:159], v[110:111], v[102:103]
    v_cvt_pk_bf16_f32 v164, v152, v153
    v_cvt_pk_bf16_f32 v165, v154, v155
    v_cvt_pk_bf16_f32 v166, v156, v157
    v_cvt_pk_bf16_f32 v167, v158, v159
    ds_read_b128 v[128:131], v14 offset:1408
    ds_read_b128 v[132:135], v14 offset:1424
    ds_read_b128 v[136:139], v14 offset:3968
    ds_read_b128 v[140:143], v14 offset:3984
    ds_write_b128 v13, v[164:167] offset:9216
    v_lshlrev_b32 v152, 16, v56
    v_and_b32 v153, 0xffff0000, v56
    v_lshlrev_b32 v154, 16, v57
    v_and_b32 v155, 0xffff0000, v57
    v_lshlrev_b32 v156, 16, v58
    v_and_b32 v157, 0xffff0000, v58
    v_lshlrev_b32 v158, 16, v59
    v_and_b32 v159, 0xffff0000, v59
    buffer_load_dwordx4 v[56:59], v5, s[4:7], s45 offen offset:1024
    v_pk_fma_f32 v[152:153], v[152:153], v[146:147], v[144:145] op_sel_hi:[1,0,0] neg_lo:[0,0,1] neg_hi:[0,0,1]
    v_pk_fma_f32 v[154:155], v[154:155], v[146:147], v[144:145] op_sel_hi:[1,0,0] neg_lo:[0,0,1] neg_hi:[0,0,1]
    v_pk_fma_f32 v[156:157], v[156:157], v[146:147], v[144:145] op_sel_hi:[1,0,0] neg_lo:[0,0,1] neg_hi:[0,0,1]
    v_pk_fma_f32 v[158:159], v[158:159], v[146:147], v[144:145] op_sel_hi:[1,0,0] neg_lo:[0,0,1] neg_hi:[0,0,1]
    s_waitcnt lgkmcnt(5)
    v_pk_fma_f32 v[152:153], v[152:153], v[120:121], v[112:113]
    v_pk_fma_f32 v[154:155], v[154:155], v[122:123], v[114:115]
    v_pk_fma_f32 v[156:157], v[156:157], v[124:125], v[116:117]
    v_pk_fma_f32 v[158:159], v[158:159], v[126:127], v[118:119]
    v_cvt_pk_bf16_f32 v160, v152, v153
    v_cvt_pk_bf16_f32 v161, v154, v155
    v_cvt_pk_bf16_f32 v162, v156, v157
    v_cvt_pk_bf16_f32 v163, v158, v159
    ds_read_b128 v[96:99], v14 offset:1536
    ds_read_b128 v[100:103], v14 offset:1552
    ds_read_b128 v[104:107], v14 offset:4096
    ds_read_b128 v[108:111], v14 offset:4112
    ds_write_b128 v13, v[160:163] offset:10240
    v_lshlrev_b32 v152, 16, v60
    v_and_b32 v153, 0xffff0000, v60
    v_lshlrev_b32 v154, 16, v61
    v_and_b32 v155, 0xffff0000, v61
    v_lshlrev_b32 v156, 16, v62
    v_and_b32 v157, 0xffff0000, v62
    v_lshlrev_b32 v158, 16, v63
    v_and_b32 v159, 0xffff0000, v63
    buffer_load_dwordx4 v[60:63], v5, s[4:7], s46 offen offset:1024
    v_pk_fma_f32 v[152:153], v[152:153], v[146:147], v[144:145] op_sel_hi:[1,0,0] neg_lo:[0,0,1] neg_hi:[0,0,1]
    v_pk_fma_f32 v[154:155], v[154:155], v[146:147], v[144:145] op_sel_hi:[1,0,0] neg_lo:[0,0,1] neg_hi:[0,0,1]
    v_pk_fma_f32 v[156:157], v[156:157], v[146:147], v[144:145] op_sel_hi:[1,0,0] neg_lo:[0,0,1] neg_hi:[0,0,1]
    v_pk_fma_f32 v[158:159], v[158:159], v[146:147], v[144:145] op_sel_hi:[1,0,0] neg_lo:[0,0,1] neg_hi:[0,0,1]
    s_waitcnt lgkmcnt(5)
    v_pk_fma_f32 v[152:153], v[152:153], v[136:137], v[128:129]
    v_pk_fma_f32 v[154:155], v[154:155], v[138:139], v[130:131]
    v_pk_fma_f32 v[156:157], v[156:157], v[140:141], v[132:133]
    v_pk_fma_f32 v[158:159], v[158:159], v[142:143], v[134:135]
    v_cvt_pk_bf16_f32 v164, v152, v153
    v_cvt_pk_bf16_f32 v165, v154, v155
    v_cvt_pk_bf16_f32 v166, v156, v157
    v_cvt_pk_bf16_f32 v167, v158, v159
    ds_read_b128 v[112:115], v14 offset:1664
    ds_read_b128 v[116:119], v14 offset:1680
    ds_read_b128 v[120:123], v14 offset:4224
    ds_read_b128 v[124:127], v14 offset:4240
    ds_write_b128 v13, v[164:167] offset:11264
    v_lshlrev_b32 v152, 16, v64
    v_and_b32 v153, 0xffff0000, v64
    v_lshlrev_b32 v154, 16, v65
    v_and_b32 v155, 0xffff0000, v65
    v_lshlrev_b32 v156, 16, v66
    v_and_b32 v157, 0xffff0000, v66
    v_lshlrev_b32 v158, 16, v67
    v_and_b32 v159, 0xffff0000, v67
    buffer_load_dwordx4 v[64:67], v5, s[4:7], s44 offen offset:2048
    v_pk_fma_f32 v[152:153], v[152:153], v[146:147], v[144:145] op_sel_hi:[1,0,0] neg_lo:[0,0,1] neg_hi:[0,0,1]
    v_pk_fma_f32 v[154:155], v[154:155], v[146:147], v[144:145] op_sel_hi:[1,0,0] neg_lo:[0,0,1] neg_hi:[0,0,1]
    v_pk_fma_f32 v[156:157], v[156:157], v[146:147], v[144:145] op_sel_hi:[1,0,0] neg_lo:[0,0,1] neg_hi:[0,0,1]
    v_pk_fma_f32 v[158:159], v[158:159], v[146:147], v[144:145] op_sel_hi:[1,0,0] neg_lo:[0,0,1] neg_hi:[0,0,1]
    s_waitcnt lgkmcnt(5)
    v_pk_fma_f32 v[152:153], v[152:153], v[104:105], v[96:97]
    v_pk_fma_f32 v[154:155], v[154:155], v[106:107], v[98:99]
    v_pk_fma_f32 v[156:157], v[156:157], v[108:109], v[100:101]
    v_pk_fma_f32 v[158:159], v[158:159], v[110:111], v[102:103]
    v_cvt_pk_bf16_f32 v160, v152, v153
    v_cvt_pk_bf16_f32 v161, v154, v155
    v_cvt_pk_bf16_f32 v162, v156, v157
    v_cvt_pk_bf16_f32 v163, v158, v159
    ds_read_b128 v[128:131], v14 offset:1792
    ds_read_b128 v[132:135], v14 offset:1808
    ds_read_b128 v[136:139], v14 offset:4352
    ds_read_b128 v[140:143], v14 offset:4368
    ds_write_b128 v13, v[160:163] offset:12288
    v_lshlrev_b32 v152, 16, v68
    v_and_b32 v153, 0xffff0000, v68
    v_lshlrev_b32 v154, 16, v69
    v_and_b32 v155, 0xffff0000, v69
    v_lshlrev_b32 v156, 16, v70
    v_and_b32 v157, 0xffff0000, v70
    v_lshlrev_b32 v158, 16, v71
    v_and_b32 v159, 0xffff0000, v71
    buffer_load_dwordx4 v[68:71], v5, s[4:7], s45 offen offset:2048
    v_pk_fma_f32 v[152:153], v[152:153], v[146:147], v[144:145] op_sel_hi:[1,0,0] neg_lo:[0,0,1] neg_hi:[0,0,1]
    v_pk_fma_f32 v[154:155], v[154:155], v[146:147], v[144:145] op_sel_hi:[1,0,0] neg_lo:[0,0,1] neg_hi:[0,0,1]
    v_pk_fma_f32 v[156:157], v[156:157], v[146:147], v[144:145] op_sel_hi:[1,0,0] neg_lo:[0,0,1] neg_hi:[0,0,1]
    v_pk_fma_f32 v[158:159], v[158:159], v[146:147], v[144:145] op_sel_hi:[1,0,0] neg_lo:[0,0,1] neg_hi:[0,0,1]
    s_waitcnt lgkmcnt(5)
    v_pk_fma_f32 v[152:153], v[152:153], v[120:121], v[112:113]
    v_pk_fma_f32 v[154:155], v[154:155], v[122:123], v[114:115]
    v_pk_fma_f32 v[156:157], v[156:157], v[124:125], v[116:117]
    v_pk_fma_f32 v[158:159], v[158:159], v[126:127], v[118:119]
    v_cvt_pk_bf16_f32 v164, v152, v153
    v_cvt_pk_bf16_f32 v165, v154, v155
    v_cvt_pk_bf16_f32 v166, v156, v157
    v_cvt_pk_bf16_f32 v167, v158, v159
    ds_read_b128 v[96:99], v14 offset:1920
    ds_read_b128 v[100:103], v14 offset:1936
    ds_read_b128 v[104:107], v14 offset:4480
    ds_read_b128 v[108:111], v14 offset:4496
    ds_write_b128 v13, v[164:167] offset:13312
    v_lshlrev_b32 v152, 16, v72
    v_and_b32 v153, 0xffff0000, v72
    v_lshlrev_b32 v154, 16, v73
    v_and_b32 v155, 0xffff0000, v73
    v_lshlrev_b32 v156, 16, v74
    v_and_b32 v157, 0xffff0000, v74
    v_lshlrev_b32 v158, 16, v75
    v_and_b32 v159, 0xffff0000, v75
    buffer_load_dwordx4 v[72:75], v5, s[4:7], s46 offen offset:2048
    v_pk_fma_f32 v[152:153], v[152:153], v[146:147], v[144:145] op_sel_hi:[1,0,0] neg_lo:[0,0,1] neg_hi:[0,0,1]
    v_pk_fma_f32 v[154:155], v[154:155], v[146:147], v[144:145] op_sel_hi:[1,0,0] neg_lo:[0,0,1] neg_hi:[0,0,1]
    v_pk_fma_f32 v[156:157], v[156:157], v[146:147], v[144:145] op_sel_hi:[1,0,0] neg_lo:[0,0,1] neg_hi:[0,0,1]
    v_pk_fma_f32 v[158:159], v[158:159], v[146:147], v[144:145] op_sel_hi:[1,0,0] neg_lo:[0,0,1] neg_hi:[0,0,1]
    s_waitcnt lgkmcnt(5)
    v_pk_fma_f32 v[152:153], v[152:153], v[136:137], v[128:129]
    v_pk_fma_f32 v[154:155], v[154:155], v[138:139], v[130:131]
    v_pk_fma_f32 v[156:157], v[156:157], v[140:141], v[132:133]
    v_pk_fma_f32 v[158:159], v[158:159], v[142:143], v[134:135]
    v_cvt_pk_bf16_f32 v160, v152, v153
    v_cvt_pk_bf16_f32 v161, v154, v155
    v_cvt_pk_bf16_f32 v162, v156, v157
    v_cvt_pk_bf16_f32 v163, v158, v159
    ds_read_b128 v[112:115], v14 offset:2048
    ds_read_b128 v[116:119], v14 offset:2064
    ds_read_b128 v[120:123], v14 offset:4608
    ds_read_b128 v[124:127], v14 offset:4624
    ds_write_b128 v13, v[160:163] offset:14336
    v_lshlrev_b32 v152, 16, v76
    v_and_b32 v153, 0xffff0000, v76
    v_lshlrev_b32 v154, 16, v77
    v_and_b32 v155, 0xffff0000, v77
    v_lshlrev_b32 v156, 16, v78
    v_and_b32 v157, 0xffff0000, v78
    v_lshlrev_b32 v158, 16, v79
    v_and_b32 v159, 0xffff0000, v79
    buffer_load_dwordx4 v[76:79], v5, s[4:7], s44 offen offset:3072
    s_add_u32 s44, s44, 4096
    v_pk_fma_f32 v[152:153], v[152:153], v[146:147], v[144:145] op_sel_hi:[1,0,0] neg_lo:[0,0,1] neg_hi:[0,0,1]
    v_pk_fma_f32 v[154:155], v[154:155], v[146:147], v[144:145] op_sel_hi:[1,0,0] neg_lo:[0,0,1] neg_hi:[0,0,1]
    v_pk_fma_f32 v[156:157], v[156:157], v[146:147], v[144:145] op_sel_hi:[1,0,0] neg_lo:[0,0,1] neg_hi:[0,0,1]
    v_pk_fma_f32 v[158:159], v[158:159], v[146:147], v[144:145] op_sel_hi:[1,0,0] neg_lo:[0,0,1] neg_hi:[0,0,1]
    s_waitcnt lgkmcnt(5)
    v_pk_fma_f32 v[152:153], v[152:153], v[104:105], v[96:97]
    v_pk_fma_f32 v[154:155], v[154:155], v[106:107], v[98:99]
    v_pk_fma_f32 v[156:157], v[156:157], v[108:109], v[100:101]
    v_pk_fma_f32 v[158:159], v[158:159], v[110:111], v[102:103]
    v_cvt_pk_bf16_f32 v164, v152, v153
    v_cvt_pk_bf16_f32 v165, v154, v155
    v_cvt_pk_bf16_f32 v166, v156, v157
    v_cvt_pk_bf16_f32 v167, v158, v159
    ds_read_b128 v[128:131], v14 offset:2176
    ds_read_b128 v[132:135], v14 offset:2192
    ds_read_b128 v[136:139], v14 offset:4736
    ds_read_b128 v[140:143], v14 offset:4752
    ds_write_b128 v13, v[164:167] offset:15360
    v_lshlrev_b32 v152, 16, v80
    v_and_b32 v153, 0xffff0000, v80
    v_lshlrev_b32 v154, 16, v81
    v_and_b32 v155, 0xffff0000, v81
    v_lshlrev_b32 v156, 16, v82
    v_and_b32 v157, 0xffff0000, v82
    v_lshlrev_b32 v158, 16, v83
    v_and_b32 v159, 0xffff0000, v83
    buffer_load_dwordx4 v[80:83], v5, s[4:7], s45 offen offset:3072
    s_add_u32 s45, s45, 4096
    v_pk_fma_f32 v[152:153], v[152:153], v[146:147], v[144:145] op_sel_hi:[1,0,0] neg_lo:[0,0,1] neg_hi:[0,0,1]
    v_pk_fma_f32 v[154:155], v[154:155], v[146:147], v[144:145] op_sel_hi:[1,0,0] neg_lo:[0,0,1] neg_hi:[0,0,1]
    v_pk_fma_f32 v[156:157], v[156:157], v[146:147], v[144:145] op_sel_hi:[1,0,0] neg_lo:[0,0,1] neg_hi:[0,0,1]
    v_pk_fma_f32 v[158:159], v[158:159], v[146:147], v[144:145] op_sel_hi:[1,0,0] neg_lo:[0,0,1] neg_hi:[0,0,1]
    s_waitcnt lgkmcnt(5)
    v_pk_fma_f32 v[152:153], v[152:153], v[120:121], v[112:113]
    v_pk_fma_f32 v[154:155], v[154:155], v[122:123], v[114:115]
    v_pk_fma_f32 v[156:157], v[156:157], v[124:125], v[116:117]
    v_pk_fma_f32 v[158:159], v[158:159], v[126:127], v[118:119]
    v_cvt_pk_bf16_f32 v160, v152, v153
    v_cvt_pk_bf16_f32 v161, v154, v155
    v_cvt_pk_bf16_f32 v162, v156, v157
    v_cvt_pk_bf16_f32 v163, v158, v159
    ds_read_b128 v[96:99], v14 offset:2304
    ds_read_b128 v[100:103], v14 offset:2320
    ds_read_b128 v[104:107], v14 offset:4864
    ds_read_b128 v[108:111], v14 offset:4880
    ds_write_b128 v13, v[160:163] offset:16384
    v_lshlrev_b32 v152, 16, v84
    v_and_b32 v153, 0xffff0000, v84
    v_lshlrev_b32 v154, 16, v85
    v_and_b32 v155, 0xffff0000, v85
    v_lshlrev_b32 v156, 16, v86
    v_and_b32 v157, 0xffff0000, v86
    v_lshlrev_b32 v158, 16, v87
    v_and_b32 v159, 0xffff0000, v87
    buffer_load_dwordx4 v[84:87], v5, s[4:7], s46 offen offset:3072
    s_add_u32 s46, s46, 4096
    v_pk_fma_f32 v[152:153], v[152:153], v[146:147], v[144:145] op_sel_hi:[1,0,0] neg_lo:[0,0,1] neg_hi:[0,0,1]
    v_pk_fma_f32 v[154:155], v[154:155], v[146:147], v[144:145] op_sel_hi:[1,0,0] neg_lo:[0,0,1] neg_hi:[0,0,1]
    v_pk_fma_f32 v[156:157], v[156:157], v[146:147], v[144:145] op_sel_hi:[1,0,0] neg_lo:[0,0,1] neg_hi:[0,0,1]
    v_pk_fma_f32 v[158:159], v[158:159], v[146:147], v[144:145] op_sel_hi:[1,0,0] neg_lo:[0,0,1] neg_hi:[0,0,1]
    s_waitcnt lgkmcnt(5)
    v_pk_fma_f32 v[152:153], v[152:153], v[136:137], v[128:129]
    v_pk_fma_f32 v[154:155], v[154:155], v[138:139], v[130:131]
    v_pk_fma_f32 v[156:157], v[156:157], v[140:141], v[132:133]
    v_pk_fma_f32 v[158:159], v[158:159], v[142:143], v[134:135]
    v_cvt_pk_bf16_f32 v164, v152, v153
    v_cvt_pk_bf16_f32 v165, v154, v155
    v_cvt_pk_bf16_f32 v166, v156, v157
    v_cvt_pk_bf16_f32 v167, v158, v159
    ds_read_b128 v[112:115], v14 offset:2432
    ds_read_b128 v[116:119], v14 offset:2448
    ds_read_b128 v[120:123], v14 offset:4992
    ds_read_b128 v[124:127], v14 offset:5008
    ds_write_b128 v13, v[164:167] offset:17408
    v_lshlrev_b32 v152, 16, v88
    v_and_b32 v153, 0xffff0000, v88
    v_lshlrev_b32 v154, 16, v89
    v_and_b32 v155, 0xffff0000, v89
    v_lshlrev_b32 v156, 16, v90
    v_and_b32 v157, 0xffff0000, v90
    v_lshlrev_b32 v158, 16, v91
    v_and_b32 v159, 0xffff0000, v91
    v_pk_fma_f32 v[152:153], v[152:153], v[146:147], v[144:145] op_sel_hi:[1,0,0] neg_lo:[0,0,1] neg_hi:[0,0,1]
    v_pk_fma_f32 v[154:155], v[154:155], v[146:147], v[144:145] op_sel_hi:[1,0,0] neg_lo:[0,0,1] neg_hi:[0,0,1]
    v_pk_fma_f32 v[156:157], v[156:157], v[146:147], v[144:145] op_sel_hi:[1,0,0] neg_lo:[0,0,1] neg_hi:[0,0,1]
    v_pk_fma_f32 v[158:159], v[158:159], v[146:147], v[144:145] op_sel_hi:[1,0,0] neg_lo:[0,0,1] neg_hi:[0,0,1]
    s_waitcnt lgkmcnt(5)
    v_pk_fma_f32 v[152:153], v[152:153], v[104:105], v[96:97]
    v_pk_fma_f32 v[154:155], v[154:155], v[106:107], v[98:99]
    v_pk_fma_f32 v[156:157], v[156:157], v[108:109], v[100:101]
    v_pk_fma_f32 v[158:159], v[158:159], v[110:111], v[102:103]
    v_cvt_pk_bf16_f32 v160, v152, v153
    v_cvt_pk_bf16_f32 v161, v154, v155
    v_cvt_pk_bf16_f32 v162, v156, v157
    v_cvt_pk_bf16_f32 v163, v158, v159
    ds_write_b128 v13, v[160:163] offset:18432
    v_lshlrev_b32 v152, 16, v92
    v_and_b32 v153, 0xffff0000, v92
    v_lshlrev_b32 v154, 16, v93
    v_and_b32 v155, 0xffff0000, v93
    v_lshlrev_b32 v156, 16, v94
    v_and_b32 v157, 0xffff0000, v94
    v_lshlrev_b32 v158, 16, v95
    v_and_b32 v159, 0xffff0000, v95
    v_pk_fma_f32 v[152:153], v[152:153], v[146:147], v[144:145] op_sel_hi:[1,0,0] neg_lo:[0,0,1] neg_hi:[0,0,1]
    v_pk_fma_f32 v[154:155], v[154:155], v[146:147], v[144:145] op_sel_hi:[1,0,0] neg_lo:[0,0,1] neg_hi:[0,0,1]
    v_pk_fma_f32 v[156:157], v[156:157], v[146:147], v[144:145] op_sel_hi:[1,0,0] neg_lo:[0,0,1] neg_hi:[0,0,1]
    v_pk_fma_f32 v[158:159], v[158:159], v[146:147], v[144:145] op_sel_hi:[1,0,0] neg_lo:[0,0,1] neg_hi:[0,0,1]
    s_waitcnt lgkmcnt(1)
    v_pk_fma_f32 v[152:153], v[152:153], v[120:121], v[112:113]
    v_pk_fma_f32 v[154:155], v[154:155], v[122:123], v[114:115]
    v_pk_fma_f32 v[156:157], v[156:157], v[124:125], v[116:117]
    v_pk_fma_f32 v[158:159], v[158:159], v[126:127], v[118:119]
    v_cvt_pk_bf16_f32 v164, v152, v153
    v_cvt_pk_bf16_f32 v165, v154, v155
    v_cvt_pk_bf16_f32 v166, v156, v157
    v_cvt_pk_bf16_f32 v167, v158, v159
    ds_write_b128 v13, v[164:167] offset:19456
    s_waitcnt lgkmcnt(0)
    s_barrier
    v_add_u32 v14, 40960, v5
    s_mul_i32 s21, s16, 12288
    s_mul_i32 s48, s40, 196608
    s_add_u32 s48, s48, 23592960
    s_add_u32 s52, s48, s21
    s_mul_i32 s56, s41, 245760
    s_add_u32 s56, s56, s21
    s_add_u32 s56, s56, 31850496
    s_add_u32 s53, s52, 49152
    s_add_u32 s54, s53, 49152
    s_add_u32 s55, s54, 49152
    s_add_u32 s57, s56, 49152
    s_add_u32 s58, s57, 49152
    s_add_u32 s59, s58, 49152
    s_add_u32 s60, s59, 49152
    ds_read_b128 v[144:147], v5 offset:0
    ds_read_b128 v[148:151], v5 offset:20480
    ds_read_b128 v[152:155], v14 offset:0
    ds_read_b128 v[156:159], v14 offset:20480
    ds_read_b128 v[160:163], v5 offset:1024
    ds_read_b128 v[164:167], v5 offset:21504
    ds_read_b128 v[168:171], v14 offset:1024
    ds_read_b128 v[172:175], v14 offset:21504
    s_waitcnt vmcnt(33) lgkmcnt(4)
    v_mfma_f32_16x16x32_bf16 v[96:99], v[176:179], v[144:147], 0
    v_mfma_f32_16x16x32_bf16 v[100:103], v[176:179], v[148:151], 0
    v_mfma_f32_16x16x32_bf16 v[104:107], v[176:179], v[152:155], 0
    v_mfma_f32_16x16x32_bf16 v[108:111], v[176:179], v[156:159], 0
    v_mfma_f32_16x16x32_bf16 v[112:115], v[180:183], v[144:147], 0
    v_mfma_f32_16x16x32_bf16 v[116:119], v[180:183], v[148:151], 0
    v_mfma_f32_16x16x32_bf16 v[120:123], v[180:183], v[152:155], 0
    v_mfma_f32_16x16x32_bf16 v[124:127], v[180:183], v[156:159], 0
    v_mfma_f32_16x16x32_bf16 v[128:131], v[184:187], v[144:147], 0
    v_mfma_f32_16x16x32_bf16 v[132:135], v[184:187], v[148:151], 0
    v_mfma_f32_16x16x32_bf16 v[136:139], v[184:187], v[152:155], 0
    v_mfma_f32_16x16x32_bf16 v[140:143], v[184:187], v[156:159], 0
    ds_read_b128 v[144:147], v5 offset:2048
    ds_read_b128 v[148:151], v5 offset:22528
    ds_read_b128 v[152:155], v14 offset:2048
    ds_read_b128 v[156:159], v14 offset:22528
    s_waitcnt vmcnt(30) lgkmcnt(4)
    v_mfma_f32_16x16x32_bf16 v[96:99], v[188:191], v[160:163], v[96:99]
    v_mfma_f32_16x16x32_bf16 v[100:103], v[188:191], v[164:167], v[100:103]
    buffer_load_dwordx4 v[176:179], v5, s[4:7], s44 offen offset:0
    v_mfma_f32_16x16x32_bf16 v[104:107], v[188:191], v[168:171], v[104:107]
    v_mfma_f32_16x16x32_bf16 v[108:111], v[188:191], v[172:175], v[108:111]
    v_mfma_f32_16x16x32_bf16 v[112:115], v[192:195], v[160:163], v[112:115]
    v_mfma_f32_16x16x32_bf16 v[116:119], v[192:195], v[164:167], v[116:119]
    buffer_load_dwordx4 v[180:183], v5, s[4:7], s45 offen offset:0
    v_mfma_f32_16x16x32_bf16 v[120:123], v[192:195], v[168:171], v[120:123]
    v_mfma_f32_16x16x32_bf16 v[124:127], v[192:195], v[172:175], v[124:127]
    v_mfma_f32_16x16x32_bf16 v[128:131], v[196:199], v[160:163], v[128:131]
    v_mfma_f32_16x16x32_bf16 v[132:135], v[196:199], v[164:167], v[132:135]
    buffer_load_dwordx4 v[184:187], v5, s[4:7], s46 offen offset:0
    v_mfma_f32_16x16x32_bf16 v[136:139], v[196:199], v[168:171], v[136:139]
    v_mfma_f32_16x16x32_bf16 v[140:143], v[196:199], v[172:175], v[140:143]
    ds_read_b128 v[160:163], v5 offset:3072
    ds_read_b128 v[164:167], v5 offset:23552
    ds_read_b128 v[168:171], v14 offset:3072
    ds_read_b128 v[172:175], v14 offset:23552
    s_waitcnt vmcnt(30) lgkmcnt(4)
    v_mfma_f32_16x16x32_bf16 v[96:99], v[200:203], v[144:147], v[96:99]
    v_mfma_f32_16x16x32_bf16 v[100:103], v[200:203], v[148:151], v[100:103]
    buffer_load_dwordx4 v[188:191], v5, s[4:7], s44 offen offset:1024
    v_mfma_f32_16x16x32_bf16 v[104:107], v[200:203], v[152:155], v[104:107]
    v_mfma_f32_16x16x32_bf16 v[108:111], v[200:203], v[156:159], v[108:111]
    v_mfma_f32_16x16x32_bf16 v[112:115], v[204:207], v[144:147], v[112:115]
    v_mfma_f32_16x16x32_bf16 v[116:119], v[204:207], v[148:151], v[116:119]
    buffer_load_dwordx4 v[192:195], v5, s[4:7], s45 offen offset:1024
    v_mfma_f32_16x16x32_bf16 v[120:123], v[204:207], v[152:155], v[120:123]
    v_mfma_f32_16x16x32_bf16 v[124:127], v[204:207], v[156:159], v[124:127]
    v_mfma_f32_16x16x32_bf16 v[128:131], v[208:211], v[144:147], v[128:131]
    v_mfma_f32_16x16x32_bf16 v[132:135], v[208:211], v[148:151], v[132:135]
    buffer_load_dwordx4 v[196:199], v5, s[4:7], s46 offen offset:1024
    v_mfma_f32_16x16x32_bf16 v[136:139], v[208:211], v[152:155], v[136:139]
    v_mfma_f32_16x16x32_bf16 v[140:143], v[208:211], v[156:159], v[140:143]
    ds_read_b128 v[144:147], v5 offset:4096
    ds_read_b128 v[148:151], v5 offset:24576
    ds_read_b128 v[152:155], v14 offset:4096
    ds_read_b128 v[156:159], v14 offset:24576
    s_waitcnt vmcnt(30) lgkmcnt(4)
    v_mfma_f32_16x16x32_bf16 v[96:99], v[212:215], v[160:163], v[96:99]
    v_mfma_f32_16x16x32_bf16 v[100:103], v[212:215], v[164:167], v[100:103]
    buffer_load_dwordx4 v[200:203], v5, s[4:7], s44 offen offset:2048
    v_mfma_f32_16x16x32_bf16 v[104:107], v[212:215], v[168:171], v[104:107]
    v_mfma_f32_16x16x32_bf16 v[108:111], v[212:215], v[172:175], v[108:111]
    v_mfma_f32_16x16x32_bf16 v[112:115], v[216:219], v[160:163], v[112:115]
    v_mfma_f32_16x16x32_bf16 v[116:119], v[216:219], v[164:167], v[116:119]
    buffer_load_dwordx4 v[204:207], v5, s[4:7], s45 offen offset:2048
    v_mfma_f32_16x16x32_bf16 v[120:123], v[216:219], v[168:171], v[120:123]
    v_mfma_f32_16x16x32_bf16 v[124:127], v[216:219], v[172:175], v[124:127]
    v_mfma_f32_16x16x32_bf16 v[128:131], v[220:223], v[160:163], v[128:131]
    v_mfma_f32_16x16x32_bf16 v[132:135], v[220:223], v[164:167], v[132:135]
    buffer_load_dwordx4 v[208:211], v5, s[4:7], s46 offen offset:2048
    v_mfma_f32_16x16x32_bf16 v[136:139], v[220:223], v[168:171], v[136:139]
    v_mfma_f32_16x16x32_bf16 v[140:143], v[220:223], v[172:175], v[140:143]
    ds_read_b128 v[160:163], v5 offset:5120
    ds_read_b128 v[164:167], v5 offset:25600
    ds_read_b128 v[168:171], v14 offset:5120
    ds_read_b128 v[172:175], v14 offset:25600
    s_waitcnt vmcnt(30) lgkmcnt(4)
    v_mfma_f32_16x16x32_bf16 v[96:99], v[224:227], v[144:147], v[96:99]
    v_mfma_f32_16x16x32_bf16 v[100:103], v[224:227], v[148:151], v[100:103]
    buffer_load_dwordx4 v[212:215], v5, s[4:7], s44 offen offset:3072
    s_add_u32 s44, s44, 4096
    v_mfma_f32_16x16x32_bf16 v[104:107], v[224:227], v[152:155], v[104:107]
    v_mfma_f32_16x16x32_bf16 v[108:111], v[224:227], v[156:159], v[108:111]
    v_mfma_f32_16x16x32_bf16 v[112:115], v[228:231], v[144:147], v[112:115]
    v_mfma_f32_16x16x32_bf16 v[116:119], v[228:231], v[148:151], v[116:119]
    buffer_load_dwordx4 v[216:219], v5, s[4:7], s45 offen offset:3072
    s_add_u32 s45, s45, 4096
    v_mfma_f32_16x16x32_bf16 v[120:123], v[228:231], v[152:155], v[120:123]
    v_mfma_f32_16x16x32_bf16 v[124:127], v[228:231], v[156:159], v[124:127]
    v_mfma_f32_16x16x32_bf16 v[128:131], v[232:235], v[144:147], v[128:131]
    v_mfma_f32_16x16x32_bf16 v[132:135], v[232:235], v[148:151], v[132:135]
    buffer_load_dwordx4 v[220:223], v5, s[4:7], s46 offen offset:3072
    s_add_u32 s46, s46, 4096
    v_mfma_f32_16x16x32_bf16 v[136:139], v[232:235], v[152:155], v[136:139]
    v_mfma_f32_16x16x32_bf16 v[140:143], v[232:235], v[156:159], v[140:143]
    ds_read_b128 v[144:147], v5 offset:6144
    ds_read_b128 v[148:151], v5 offset:26624
    ds_read_b128 v[152:155], v14 offset:6144
    ds_read_b128 v[156:159], v14 offset:26624
    s_waitcnt vmcnt(30) lgkmcnt(4)
    v_mfma_f32_16x16x32_bf16 v[96:99], v[236:239], v[160:163], v[96:99]
    v_mfma_f32_16x16x32_bf16 v[100:103], v[236:239], v[164:167], v[100:103]
    buffer_load_dwordx4 v[224:227], v5, s[4:7], s44 offen offset:0
    v_mfma_f32_16x16x32_bf16 v[104:107], v[236:239], v[168:171], v[104:107]
    v_mfma_f32_16x16x32_bf16 v[108:111], v[236:239], v[172:175], v[108:111]
    v_mfma_f32_16x16x32_bf16 v[112:115], v[240:243], v[160:163], v[112:115]
    v_mfma_f32_16x16x32_bf16 v[116:119], v[240:243], v[164:167], v[116:119]
    buffer_load_dwordx4 v[228:231], v5, s[4:7], s45 offen offset:0
    v_mfma_f32_16x16x32_bf16 v[120:123], v[240:243], v[168:171], v[120:123]
    v_mfma_f32_16x16x32_bf16 v[124:127], v[240:243], v[172:175], v[124:127]
    v_mfma_f32_16x16x32_bf16 v[128:131], v[244:247], v[160:163], v[128:131]
    v_mfma_f32_16x16x32_bf16 v[132:135], v[244:247], v[164:167], v[132:135]
    buffer_load_dwordx4 v[232:235], v5, s[4:7], s46 offen offset:0
    v_mfma_f32_16x16x32_bf16 v[136:139], v[244:247], v[168:171], v[136:139]
    v_mfma_f32_16x16x32_bf16 v[140:143], v[244:247], v[172:175], v[140:143]
    ds_read_b128 v[160:163], v5 offset:7168
    ds_read_b128 v[164:167], v5 offset:27648
    ds_read_b128 v[168:171], v14 offset:7168
    ds_read_b128 v[172:175], v14 offset:27648
    s_waitcnt vmcnt(30) lgkmcnt(4)
    v_mfma_f32_16x16x32_bf16 v[96:99], v[16:19], v[144:147], v[96:99]
    v_mfma_f32_16x16x32_bf16 v[100:103], v[16:19], v[148:151], v[100:103]
    buffer_load_dwordx4 v[236:239], v5, s[4:7], s44 offen offset:1024
    v_mfma_f32_16x16x32_bf16 v[104:107], v[16:19], v[152:155], v[104:107]
    v_mfma_f32_16x16x32_bf16 v[108:111], v[16:19], v[156:159], v[108:111]
    v_mfma_f32_16x16x32_bf16 v[112:115], v[20:23], v[144:147], v[112:115]
    v_mfma_f32_16x16x32_bf16 v[116:119], v[20:23], v[148:151], v[116:119]
    buffer_load_dwordx4 v[240:243], v5, s[4:7], s45 offen offset:1024
    v_mfma_f32_16x16x32_bf16 v[120:123], v[20:23], v[152:155], v[120:123]
    v_mfma_f32_16x16x32_bf16 v[124:127], v[20:23], v[156:159], v[124:127]
    v_mfma_f32_16x16x32_bf16 v[128:131], v[24:27], v[144:147], v[128:131]
    v_mfma_f32_16x16x32_bf16 v[132:135], v[24:27], v[148:151], v[132:135]
    buffer_load_dwordx4 v[244:247], v5, s[4:7], s46 offen offset:1024
    v_mfma_f32_16x16x32_bf16 v[136:139], v[24:27], v[152:155], v[136:139]
    v_mfma_f32_16x16x32_bf16 v[140:143], v[24:27], v[156:159], v[140:143]
    ds_read_b128 v[144:147], v5 offset:8192
    ds_read_b128 v[148:151], v5 offset:28672
    ds_read_b128 v[152:155], v14 offset:8192
    ds_read_b128 v[156:159], v14 offset:28672
    s_waitcnt vmcnt(30) lgkmcnt(4)
    v_mfma_f32_16x16x32_bf16 v[96:99], v[28:31], v[160:163], v[96:99]
    v_mfma_f32_16x16x32_bf16 v[100:103], v[28:31], v[164:167], v[100:103]
    buffer_load_dwordx4 v[16:19], v5, s[4:7], s44 offen offset:2048
    v_mfma_f32_16x16x32_bf16 v[104:107], v[28:31], v[168:171], v[104:107]
    v_mfma_f32_16x16x32_bf16 v[108:111], v[28:31], v[172:175], v[108:111]
    v_mfma_f32_16x16x32_bf16 v[112:115], v[32:35], v[160:163], v[112:115]
    v_mfma_f32_16x16x32_bf16 v[116:119], v[32:35], v[164:167], v[116:119]
    buffer_load_dwordx4 v[20:23], v5, s[4:7], s45 offen offset:2048
    v_mfma_f32_16x16x32_bf16 v[120:123], v[32:35], v[168:171], v[120:123]
    v_mfma_f32_16x16x32_bf16 v[124:127], v[32:35], v[172:175], v[124:127]
    v_mfma_f32_16x16x32_bf16 v[128:131], v[36:39], v[160:163], v[128:131]
    v_mfma_f32_16x16x32_bf16 v[132:135], v[36:39], v[164:167], v[132:135]
    buffer_load_dwordx4 v[24:27], v5, s[4:7], s46 offen offset:2048
    v_mfma_f32_16x16x32_bf16 v[136:139], v[36:39], v[168:171], v[136:139]
    v_mfma_f32_16x16x32_bf16 v[140:143], v[36:39], v[172:175], v[140:143]
    ds_read_b128 v[160:163], v5 offset:9216
    ds_read_b128 v[164:167], v5 offset:29696
    ds_read_b128 v[168:171], v14 offset:9216
    ds_read_b128 v[172:175], v14 offset:29696
    s_waitcnt vmcnt(30) lgkmcnt(4)
    v_mfma_f32_16x16x32_bf16 v[96:99], v[40:43], v[144:147], v[96:99]
    v_mfma_f32_16x16x32_bf16 v[100:103], v[40:43], v[148:151], v[100:103]
    buffer_load_dwordx4 v[28:31], v5, s[4:7], s44 offen offset:3072
    s_add_u32 s44, s44, 4096
    v_mfma_f32_16x16x32_bf16 v[104:107], v[40:43], v[152:155], v[104:107]
    v_mfma_f32_16x16x32_bf16 v[108:111], v[40:43], v[156:159], v[108:111]
    v_mfma_f32_16x16x32_bf16 v[112:115], v[44:47], v[144:147], v[112:115]
    v_mfma_f32_16x16x32_bf16 v[116:119], v[44:47], v[148:151], v[116:119]
    buffer_load_dwordx4 v[32:35], v5, s[4:7], s45 offen offset:3072
    s_add_u32 s45, s45, 4096
    v_mfma_f32_16x16x32_bf16 v[120:123], v[44:47], v[152:155], v[120:123]
    v_mfma_f32_16x16x32_bf16 v[124:127], v[44:47], v[156:159], v[124:127]
    v_mfma_f32_16x16x32_bf16 v[128:131], v[48:51], v[144:147], v[128:131]
    v_mfma_f32_16x16x32_bf16 v[132:135], v[48:51], v[148:151], v[132:135]
    buffer_load_dwordx4 v[36:39], v5, s[4:7], s46 offen offset:3072
    s_add_u32 s46, s46, 4096
    v_mfma_f32_16x16x32_bf16 v[136:139], v[48:51], v[152:155], v[136:139]
    v_mfma_f32_16x16x32_bf16 v[140:143], v[48:51], v[156:159], v[140:143]
    ds_read_b128 v[144:147], v5 offset:10240
    ds_read_b128 v[148:151], v5 offset:30720
    ds_read_b128 v[152:155], v14 offset:10240
    ds_read_b128 v[156:159], v14 offset:30720
    s_waitcnt vmcnt(30) lgkmcnt(4)
    v_mfma_f32_16x16x32_bf16 v[96:99], v[52:55], v[160:163], v[96:99]
    v_mfma_f32_16x16x32_bf16 v[100:103], v[52:55], v[164:167], v[100:103]
    v_mfma_f32_16x16x32_bf16 v[104:107], v[52:55], v[168:171], v[104:107]
    v_mfma_f32_16x16x32_bf16 v[108:111], v[52:55], v[172:175], v[108:111]
    v_mfma_f32_16x16x32_bf16 v[112:115], v[56:59], v[160:163], v[112:115]
    v_mfma_f32_16x16x32_bf16 v[116:119], v[56:59], v[164:167], v[116:119]
    v_mfma_f32_16x16x32_bf16 v[120:123], v[56:59], v[168:171], v[120:123]
    v_mfma_f32_16x16x32_bf16 v[124:127], v[56:59], v[172:175], v[124:127]
    v_mfma_f32_16x16x32_bf16 v[128:131], v[60:63], v[160:163], v[128:131]
    v_mfma_f32_16x16x32_bf16 v[132:135], v[60:63], v[164:167], v[132:135]
    v_mfma_f32_16x16x32_bf16 v[136:139], v[60:63], v[168:171], v[136:139]
    v_mfma_f32_16x16x32_bf16 v[140:143], v[60:63], v[172:175], v[140:143]
    ds_read_b128 v[160:163], v5 offset:11264
    ds_read_b128 v[164:167], v5 offset:31744
    ds_read_b128 v[168:171], v14 offset:11264
    ds_read_b128 v[172:175], v14 offset:31744
    s_waitcnt vmcnt(27) lgkmcnt(4)
    v_mfma_f32_16x16x32_bf16 v[96:99], v[64:67], v[144:147], v[96:99]
    v_mfma_f32_16x16x32_bf16 v[100:103], v[64:67], v[148:151], v[100:103]
    v_mfma_f32_16x16x32_bf16 v[104:107], v[64:67], v[152:155], v[104:107]
    v_mfma_f32_16x16x32_bf16 v[108:111], v[64:67], v[156:159], v[108:111]
    v_mfma_f32_16x16x32_bf16 v[112:115], v[68:71], v[144:147], v[112:115]
    v_mfma_f32_16x16x32_bf16 v[116:119], v[68:71], v[148:151], v[116:119]
    v_mfma_f32_16x16x32_bf16 v[120:123], v[68:71], v[152:155], v[120:123]
    v_mfma_f32_16x16x32_bf16 v[124:127], v[68:71], v[156:159], v[124:127]
    v_mfma_f32_16x16x32_bf16 v[128:131], v[72:75], v[144:147], v[128:131]
    v_mfma_f32_16x16x32_bf16 v[132:135], v[72:75], v[148:151], v[132:135]
    v_mfma_f32_16x16x32_bf16 v[136:139], v[72:75], v[152:155], v[136:139]
    v_mfma_f32_16x16x32_bf16 v[140:143], v[72:75], v[156:159], v[140:143]
    ds_read_b128 v[144:147], v5 offset:12288
    ds_read_b128 v[148:151], v5 offset:32768
    ds_read_b128 v[152:155], v14 offset:12288
    ds_read_b128 v[156:159], v14 offset:32768
    s_waitcnt vmcnt(24) lgkmcnt(4)
    v_mfma_f32_16x16x32_bf16 v[96:99], v[76:79], v[160:163], v[96:99]
    v_mfma_f32_16x16x32_bf16 v[100:103], v[76:79], v[164:167], v[100:103]
    v_mfma_f32_16x16x32_bf16 v[104:107], v[76:79], v[168:171], v[104:107]
    v_mfma_f32_16x16x32_bf16 v[108:111], v[76:79], v[172:175], v[108:111]
    v_mfma_f32_16x16x32_bf16 v[112:115], v[80:83], v[160:163], v[112:115]
    v_mfma_f32_16x16x32_bf16 v[116:119], v[80:83], v[164:167], v[116:119]
    v_mfma_f32_16x16x32_bf16 v[120:123], v[80:83], v[168:171], v[120:123]
    v_mfma_f32_16x16x32_bf16 v[124:127], v[80:83], v[172:175], v[124:127]
    v_mfma_f32_16x16x32_bf16 v[128:131], v[84:87], v[160:163], v[128:131]
    v_mfma_f32_16x16x32_bf16 v[132:135], v[84:87], v[164:167], v[132:135]
    v_mfma_f32_16x16x32_bf16 v[136:139], v[84:87], v[168:171], v[136:139]
    v_mfma_f32_16x16x32_bf16 v[140:143], v[84:87], v[172:175], v[140:143]
    ds_read_b128 v[160:163], v5 offset:13312
    ds_read_b128 v[164:167], v5 offset:33792
    ds_read_b128 v[168:171], v14 offset:13312
    ds_read_b128 v[172:175], v14 offset:33792
    s_waitcnt vmcnt(21) lgkmcnt(4)
    v_mfma_f32_16x16x32_bf16 v[96:99], v[176:179], v[144:147], v[96:99]
    v_mfma_f32_16x16x32_bf16 v[100:103], v[176:179], v[148:151], v[100:103]
    v_mfma_f32_16x16x32_bf16 v[104:107], v[176:179], v[152:155], v[104:107]
    v_mfma_f32_16x16x32_bf16 v[108:111], v[176:179], v[156:159], v[108:111]
    v_mfma_f32_16x16x32_bf16 v[112:115], v[180:183], v[144:147], v[112:115]
    v_mfma_f32_16x16x32_bf16 v[116:119], v[180:183], v[148:151], v[116:119]
    v_mfma_f32_16x16x32_bf16 v[120:123], v[180:183], v[152:155], v[120:123]
    v_mfma_f32_16x16x32_bf16 v[124:127], v[180:183], v[156:159], v[124:127]
    v_mfma_f32_16x16x32_bf16 v[128:131], v[184:187], v[144:147], v[128:131]
    v_mfma_f32_16x16x32_bf16 v[132:135], v[184:187], v[148:151], v[132:135]
    v_mfma_f32_16x16x32_bf16 v[136:139], v[184:187], v[152:155], v[136:139]
    v_mfma_f32_16x16x32_bf16 v[140:143], v[184:187], v[156:159], v[140:143]
    ds_read_b128 v[144:147], v5 offset:14336
    ds_read_b128 v[148:151], v5 offset:34816
    ds_read_b128 v[152:155], v14 offset:14336
    ds_read_b128 v[156:159], v14 offset:34816
    s_waitcnt vmcnt(18) lgkmcnt(4)
    v_mfma_f32_16x16x32_bf16 v[96:99], v[188:191], v[160:163], v[96:99]
    v_mfma_f32_16x16x32_bf16 v[100:103], v[188:191], v[164:167], v[100:103]
    v_mfma_f32_16x16x32_bf16 v[104:107], v[188:191], v[168:171], v[104:107]
    v_mfma_f32_16x16x32_bf16 v[108:111], v[188:191], v[172:175], v[108:111]
    v_mfma_f32_16x16x32_bf16 v[112:115], v[192:195], v[160:163], v[112:115]
    v_mfma_f32_16x16x32_bf16 v[116:119], v[192:195], v[164:167], v[116:119]
    v_mfma_f32_16x16x32_bf16 v[120:123], v[192:195], v[168:171], v[120:123]
    v_mfma_f32_16x16x32_bf16 v[124:127], v[192:195], v[172:175], v[124:127]
    v_mfma_f32_16x16x32_bf16 v[128:131], v[196:199], v[160:163], v[128:131]
    v_mfma_f32_16x16x32_bf16 v[132:135], v[196:199], v[164:167], v[132:135]
    v_mfma_f32_16x16x32_bf16 v[136:139], v[196:199], v[168:171], v[136:139]
    v_mfma_f32_16x16x32_bf16 v[140:143], v[196:199], v[172:175], v[140:143]
    ds_read_b128 v[160:163], v5 offset:15360
    ds_read_b128 v[164:167], v5 offset:35840
    ds_read_b128 v[168:171], v14 offset:15360
    ds_read_b128 v[172:175], v14 offset:35840
    s_waitcnt vmcnt(15) lgkmcnt(4)
    v_mfma_f32_16x16x32_bf16 v[96:99], v[200:203], v[144:147], v[96:99]
    v_mfma_f32_16x16x32_bf16 v[100:103], v[200:203], v[148:151], v[100:103]
    v_mfma_f32_16x16x32_bf16 v[104:107], v[200:203], v[152:155], v[104:107]
    v_mfma_f32_16x16x32_bf16 v[108:111], v[200:203], v[156:159], v[108:111]
    v_mfma_f32_16x16x32_bf16 v[112:115], v[204:207], v[144:147], v[112:115]
    v_mfma_f32_16x16x32_bf16 v[116:119], v[204:207], v[148:151], v[116:119]
    v_mfma_f32_16x16x32_bf16 v[120:123], v[204:207], v[152:155], v[120:123]
    v_mfma_f32_16x16x32_bf16 v[124:127], v[204:207], v[156:159], v[124:127]
    v_mfma_f32_16x16x32_bf16 v[128:131], v[208:211], v[144:147], v[128:131]
    v_mfma_f32_16x16x32_bf16 v[132:135], v[208:211], v[148:151], v[132:135]
    v_mfma_f32_16x16x32_bf16 v[136:139], v[208:211], v[152:155], v[136:139]
    v_mfma_f32_16x16x32_bf16 v[140:143], v[208:211], v[156:159], v[140:143]
    ds_read_b128 v[144:147], v5 offset:16384
    ds_read_b128 v[148:151], v5 offset:36864
    ds_read_b128 v[152:155], v14 offset:16384
    ds_read_b128 v[156:159], v14 offset:36864
    s_waitcnt vmcnt(12) lgkmcnt(4)
    v_mfma_f32_16x16x32_bf16 v[96:99], v[212:215], v[160:163], v[96:99]
    v_mfma_f32_16x16x32_bf16 v[100:103], v[212:215], v[164:167], v[100:103]
    v_mfma_f32_16x16x32_bf16 v[104:107], v[212:215], v[168:171], v[104:107]
    v_mfma_f32_16x16x32_bf16 v[108:111], v[212:215], v[172:175], v[108:111]
    v_mfma_f32_16x16x32_bf16 v[112:115], v[216:219], v[160:163], v[112:115]
    v_mfma_f32_16x16x32_bf16 v[116:119], v[216:219], v[164:167], v[116:119]
    v_mfma_f32_16x16x32_bf16 v[120:123], v[216:219], v[168:171], v[120:123]
    v_mfma_f32_16x16x32_bf16 v[124:127], v[216:219], v[172:175], v[124:127]
    v_mfma_f32_16x16x32_bf16 v[128:131], v[220:223], v[160:163], v[128:131]
    v_mfma_f32_16x16x32_bf16 v[132:135], v[220:223], v[164:167], v[132:135]
    v_mfma_f32_16x16x32_bf16 v[136:139], v[220:223], v[168:171], v[136:139]
    v_mfma_f32_16x16x32_bf16 v[140:143], v[220:223], v[172:175], v[140:143]
    ds_read_b128 v[160:163], v5 offset:17408
    ds_read_b128 v[164:167], v5 offset:37888
    ds_read_b128 v[168:171], v14 offset:17408
    ds_read_b128 v[172:175], v14 offset:37888
    s_waitcnt vmcnt(9) lgkmcnt(4)
    v_mfma_f32_16x16x32_bf16 v[96:99], v[224:227], v[144:147], v[96:99]
    v_mfma_f32_16x16x32_bf16 v[100:103], v[224:227], v[148:151], v[100:103]
    v_mfma_f32_16x16x32_bf16 v[104:107], v[224:227], v[152:155], v[104:107]
    v_mfma_f32_16x16x32_bf16 v[108:111], v[224:227], v[156:159], v[108:111]
    v_mfma_f32_16x16x32_bf16 v[112:115], v[228:231], v[144:147], v[112:115]
    v_mfma_f32_16x16x32_bf16 v[116:119], v[228:231], v[148:151], v[116:119]
    v_mfma_f32_16x16x32_bf16 v[120:123], v[228:231], v[152:155], v[120:123]
    v_mfma_f32_16x16x32_bf16 v[124:127], v[228:231], v[156:159], v[124:127]
    v_mfma_f32_16x16x32_bf16 v[128:131], v[232:235], v[144:147], v[128:131]
    v_mfma_f32_16x16x32_bf16 v[132:135], v[232:235], v[148:151], v[132:135]
    v_mfma_f32_16x16x32_bf16 v[136:139], v[232:235], v[152:155], v[136:139]
    v_mfma_f32_16x16x32_bf16 v[140:143], v[232:235], v[156:159], v[140:143]
    ds_read_b128 v[144:147], v5 offset:18432
    ds_read_b128 v[148:151], v5 offset:38912
    ds_read_b128 v[152:155], v14 offset:18432
    ds_read_b128 v[156:159], v14 offset:38912
    s_waitcnt vmcnt(6) lgkmcnt(4)
    v_mfma_f32_16x16x32_bf16 v[96:99], v[236:239], v[160:163], v[96:99]
    v_mfma_f32_16x16x32_bf16 v[100:103], v[236:239], v[164:167], v[100:103]
    v_mfma_f32_16x16x32_bf16 v[104:107], v[236:239], v[168:171], v[104:107]
    v_mfma_f32_16x16x32_bf16 v[108:111], v[236:239], v[172:175], v[108:111]
    v_mfma_f32_16x16x32_bf16 v[112:115], v[240:243], v[160:163], v[112:115]
    v_mfma_f32_16x16x32_bf16 v[116:119], v[240:243], v[164:167], v[116:119]
    v_mfma_f32_16x16x32_bf16 v[120:123], v[240:243], v[168:171], v[120:123]
    v_mfma_f32_16x16x32_bf16 v[124:127], v[240:243], v[172:175], v[124:127]
    v_mfma_f32_16x16x32_bf16 v[128:131], v[244:247], v[160:163], v[128:131]
    v_mfma_f32_16x16x32_bf16 v[132:135], v[244:247], v[164:167], v[132:135]
    v_mfma_f32_16x16x32_bf16 v[136:139], v[244:247], v[168:171], v[136:139]
    v_mfma_f32_16x16x32_bf16 v[140:143], v[244:247], v[172:175], v[140:143]
    ds_read_b128 v[160:163], v5 offset:19456
    ds_read_b128 v[164:167], v5 offset:39936
    ds_read_b128 v[168:171], v14 offset:19456
    ds_read_b128 v[172:175], v14 offset:39936
    s_waitcnt vmcnt(3) lgkmcnt(4)
    v_mfma_f32_16x16x32_bf16 v[96:99], v[16:19], v[144:147], v[96:99]
    v_mfma_f32_16x16x32_bf16 v[100:103], v[16:19], v[148:151], v[100:103]
    v_mfma_f32_16x16x32_bf16 v[104:107], v[16:19], v[152:155], v[104:107]
    v_mfma_f32_16x16x32_bf16 v[108:111], v[16:19], v[156:159], v[108:111]
    v_mfma_f32_16x16x32_bf16 v[112:115], v[20:23], v[144:147], v[112:115]
    v_mfma_f32_16x16x32_bf16 v[116:119], v[20:23], v[148:151], v[116:119]
    v_mfma_f32_16x16x32_bf16 v[120:123], v[20:23], v[152:155], v[120:123]
    v_mfma_f32_16x16x32_bf16 v[124:127], v[20:23], v[156:159], v[124:127]
    v_mfma_f32_16x16x32_bf16 v[128:131], v[24:27], v[144:147], v[128:131]
    v_mfma_f32_16x16x32_bf16 v[132:135], v[24:27], v[148:151], v[132:135]
    v_mfma_f32_16x16x32_bf16 v[136:139], v[24:27], v[152:155], v[136:139]
    v_mfma_f32_16x16x32_bf16 v[140:143], v[24:27], v[156:159], v[140:143]
    s_waitcnt vmcnt(0) lgkmcnt(0)
    v_mfma_f32_16x16x32_bf16 v[96:99], v[28:31], v[160:163], v[96:99]
    v_mfma_f32_16x16x32_bf16 v[100:103], v[28:31], v[164:167], v[100:103]
    v_mfma_f32_16x16x32_bf16 v[104:107], v[28:31], v[168:171], v[104:107]
    v_mfma_f32_16x16x32_bf16 v[108:111], v[28:31], v[172:175], v[108:111]
    v_mfma_f32_16x16x32_bf16 v[112:115], v[32:35], v[160:163], v[112:115]
    v_mfma_f32_16x16x32_bf16 v[116:119], v[32:35], v[164:167], v[116:119]
    v_mfma_f32_16x16x32_bf16 v[120:123], v[32:35], v[168:171], v[120:123]
    v_mfma_f32_16x16x32_bf16 v[124:127], v[32:35], v[172:175], v[124:127]
    v_mfma_f32_16x16x32_bf16 v[128:131], v[36:39], v[160:163], v[128:131]
    v_mfma_f32_16x16x32_bf16 v[132:135], v[36:39], v[164:167], v[132:135]
    v_mfma_f32_16x16x32_bf16 v[136:139], v[36:39], v[168:171], v[136:139]
    v_mfma_f32_16x16x32_bf16 v[140:143], v[36:39], v[172:175], v[140:143]
    s_mov_b32 s32, 0xbdd2d3e8
    s_mov_b32 s33, s32
    v_mov_b32 v160, 0xc0135761
    v_lshlrev_b32 v164, 16, v250
    v_and_b32 v165, 0xffff0000, v250
    v_lshlrev_b32 v166, 16, v251
    v_and_b32 v167, 0xffff0000, v251
    s_add_u32 s34, s42, 0
    s_lshr_b32 s35, s34, 1
    s_lshl_b32 s35, s35, 10
    s_and_b32 s34, s34, 1
    s_lshl_b32 s34, s34, 3
    s_add_u32 s35, s35, s34
    s_add_u32 s24, s35, s48
    s_add_u32 s25, s24, 49152
    s_add_u32 s26, s25, 49152
    s_add_u32 s27, s26, 49152
    v_pk_add_f32 v[96:97], v[96:97], v[164:165]
    v_pk_add_f32 v[98:99], v[98:99], v[166:167]
    v_pk_add_f32 v[100:101], v[100:101], v[164:165]
    v_pk_add_f32 v[102:103], v[102:103], v[166:167]
    v_pk_add_f32 v[104:105], v[104:105], v[164:165]
    v_pk_add_f32 v[106:107], v[106:107], v[166:167]
    v_pk_add_f32 v[108:109], v[108:109], v[164:165]
    v_pk_add_f32 v[110:111], v[110:111], v[166:167]
    buffer_load_dwordx4 v[16:19], v5, s[4:7], s56 offen offset:0
    v_pk_mul_f32 v[144:145], v[96:97], v[96:97]
    v_pk_mul_f32 v[146:147], v[98:99], v[98:99]
    v_pk_mul_f32 v[148:149], v[100:101], v[100:101]
    v_pk_mul_f32 v[150:151], v[102:103], v[102:103]
    v_pk_mul_f32 v[152:153], v[104:105], v[104:105]
    v_pk_mul_f32 v[154:155], v[106:107], v[106:107]
    v_pk_mul_f32 v[156:157], v[108:109], v[108:109]
    v_pk_mul_f32 v[158:159], v[110:111], v[110:111]
    v_pk_fma_f32 v[144:145], v[144:145], s[32:33], v[160:161] op_sel_hi:[1,1,0]
    v_pk_fma_f32 v[146:147], v[146:147], s[32:33], v[160:161] op_sel_hi:[1,1,0]
    v_pk_fma_f32 v[148:149], v[148:149], s[32:33], v[160:161] op_sel_hi:[1,1,0]
    v_pk_fma_f32 v[150:151], v[150:151], s[32:33], v[160:161] op_sel_hi:[1,1,0]
    v_pk_fma_f32 v[152:153], v[152:153], s[32:33], v[160:161] op_sel_hi:[1,1,0]
    v_pk_fma_f32 v[154:155], v[154:155], s[32:33], v[160:161] op_sel_hi:[1,1,0]
    v_pk_fma_f32 v[156:157], v[156:157], s[32:33], v[160:161] op_sel_hi:[1,1,0]
    v_pk_fma_f32 v[158:159], v[158:159], s[32:33], v[160:161] op_sel_hi:[1,1,0]
    buffer_load_dwordx4 v[20:23], v5, s[4:7], s57 offen offset:0
    v_pk_mul_f32 v[144:145], v[144:145], v[96:97]
    v_pk_mul_f32 v[146:147], v[146:147], v[98:99]
    v_pk_mul_f32 v[148:149], v[148:149], v[100:101]
    v_pk_mul_f32 v[150:151], v[150:151], v[102:103]
    v_pk_mul_f32 v[152:153], v[152:153], v[104:105]
    v_pk_mul_f32 v[154:155], v[154:155], v[106:107]
    v_pk_mul_f32 v[156:157], v[156:157], v[108:109]
    v_pk_mul_f32 v[158:159], v[158:159], v[110:111]
    v_exp_f32 v144, v144
    v_exp_f32 v145, v145
    v_exp_f32 v146, v146
    v_exp_f32 v147, v147
    buffer_load_dwordx4 v[24:27], v5, s[4:7], s58 offen offset:0
    v_exp_f32 v148, v148
    v_exp_f32 v149, v149
    v_exp_f32 v150, v150
    v_exp_f32 v151, v151
    v_exp_f32 v152, v152
    v_exp_f32 v153, v153
    v_exp_f32 v154, v154
    v_exp_f32 v155, v155
    buffer_load_dwordx4 v[28:31], v5, s[4:7], s59 offen offset:0
    v_exp_f32 v156, v156
    v_exp_f32 v157, v157
    v_exp_f32 v158, v158
    v_exp_f32 v159, v159
    v_pk_add_f32 v[144:145], v[144:145], 1.0 op_sel_hi:[1,0]
    v_pk_add_f32 v[146:147], v[146:147], 1.0 op_sel_hi:[1,0]
    v_pk_add_f32 v[148:149], v[148:149], 1.0 op_sel_hi:[1,0]
    v_pk_add_f32 v[150:151], v[150:151], 1.0 op_sel_hi:[1,0]
    v_pk_add_f32 v[152:153], v[152:153], 1.0 op_sel_hi:[1,0]
    v_pk_add_f32 v[154:155], v[154:155], 1.0 op_sel_hi:[1,0]
    v_pk_add_f32 v[156:157], v[156:157], 1.0 op_sel_hi:[1,0]
    v_pk_add_f32 v[158:159], v[158:159], 1.0 op_sel_hi:[1,0]
    v_rcp_f32 v144, v144
    v_rcp_f32 v145, v145
    v_rcp_f32 v146, v146
    v_rcp_f32 v147, v147
    buffer_load_dwordx4 v[32:35], v5, s[4:7], s60 offen offset:0
    v_rcp_f32 v148, v148
    v_rcp_f32 v149, v149
    v_rcp_f32 v150, v150
    v_rcp_f32 v151, v151
    v_rcp_f32 v152, v152
    v_rcp_f32 v153, v153
    v_rcp_f32 v154, v154
    v_rcp_f32 v155, v155
    buffer_load_dwordx4 v[36:39], v5, s[4:7], s56 offen offset:1024
    v_rcp_f32 v156, v156
    v_rcp_f32 v157, v157
    v_rcp_f32 v158, v158
    v_rcp_f32 v159, v159
    v_pk_mul_f32 v[96:97], v[96:97], v[144:145]
    v_pk_mul_f32 v[98:99], v[98:99], v[146:147]
    v_pk_mul_f32 v[100:101], v[100:101], v[148:149]
    v_pk_mul_f32 v[102:103], v[102:103], v[150:151]
    v_pk_mul_f32 v[104:105], v[104:105], v[152:153]
    v_pk_mul_f32 v[106:107], v[106:107], v[154:155]
    v_pk_mul_f32 v[108:109], v[108:109], v[156:157]
    v_pk_mul_f32 v[110:111], v[110:111], v[158:159]
    buffer_load_dwordx4 v[40:43], v5, s[4:7], s57 offen offset:1024
    v_cvt_pk_bf16_f32 v96, v96, v97
    v_cvt_pk_bf16_f32 v97, v98, v99
    v_cvt_pk_bf16_f32 v100, v100, v101
    v_cvt_pk_bf16_f32 v101, v102, v103
    v_cvt_pk_bf16_f32 v104, v104, v105
    v_cvt_pk_bf16_f32 v105, v106, v107
    v_cvt_pk_bf16_f32 v108, v108, v109
    v_cvt_pk_bf16_f32 v109, v110, v111
    s_cmp_lg_u32 s19, 0
    s_cbranch_scc1 L_slow_137
    buffer_store_dwordx2 v[96:97], v5, s[4:7], s24 offen
    buffer_store_dwordx2 v[100:101], v5, s[4:7], s25 offen
    buffer_store_dwordx2 v[104:105], v5, s[4:7], s26 offen
    buffer_store_dwordx2 v[108:109], v5, s[4:7], s27 offen
L_back_138:
    v_lshlrev_b32 v164, 16, v252
    v_and_b32 v165, 0xffff0000, v252
    v_lshlrev_b32 v166, 16, v253
    v_and_b32 v167, 0xffff0000, v253
    s_add_u32 s34, s42, 1
    s_lshr_b32 s35, s34, 1
    s_lshl_b32 s35, s35, 10
    s_and_b32 s34, s34, 1
    s_lshl_b32 s34, s34, 3
    s_add_u32 s35, s35, s34
    s_add_u32 s24, s35, s48
    s_add_u32 s25, s24, 49152
    s_add_u32 s26, s25, 49152
    s_add_u32 s27, s26, 49152
    v_pk_add_f32 v[112:113], v[112:113], v[164:165]
    v_pk_add_f32 v[114:115], v[114:115], v[166:167]
    v_pk_add_f32 v[116:117], v[116:117], v[164:165]
    v_pk_add_f32 v[118:119], v[118:119], v[166:167]
    v_pk_add_f32 v[120:121], v[120:121], v[164:165]
    v_pk_add_f32 v[122:123], v[122:123], v[166:167]
    v_pk_add_f32 v[124:125], v[124:125], v[164:165]
    v_pk_add_f32 v[126:127], v[126:127], v[166:167]
    buffer_load_dwordx4 v[44:47], v5, s[4:7], s58 offen offset:1024
    v_pk_mul_f32 v[144:145], v[112:113], v[112:113]
    v_pk_mul_f32 v[146:147], v[114:115], v[114:115]
    v_pk_mul_f32 v[148:149], v[116:117], v[116:117]
    v_pk_mul_f32 v[150:151], v[118:119], v[118:119]
    v_pk_mul_f32 v[152:153], v[120:121], v[120:121]
    v_pk_mul_f32 v[154:155], v[122:123], v[122:123]
    v_pk_mul_f32 v[156:157], v[124:125], v[124:125]
    v_pk_mul_f32 v[158:159], v[126:127], v[126:127]
    v_pk_fma_f32 v[144:145], v[144:145], s[32:33], v[160:161] op_sel_hi:[1,1,0]
    v_pk_fma_f32 v[146:147], v[146:147], s[32:33], v[160:161] op_sel_hi:[1,1,0]
    v_pk_fma_f32 v[148:149], v[148:149], s[32:33], v[160:161] op_sel_hi:[1,1,0]
    v_pk_fma_f32 v[150:151], v[150:151], s[32:33], v[160:161] op_sel_hi:[1,1,0]
    v_pk_fma_f32 v[152:153], v[152:153], s[32:33], v[160:161] op_sel_hi:[1,1,0]
    v_pk_fma_f32 v[154:155], v[154:155], s[32:33], v[160:161] op_sel_hi:[1,1,0]
    v_pk_fma_f32 v[156:157], v[156:157], s[32:33], v[160:161] op_sel_hi:[1,1,0]
    v_pk_fma_f32 v[158:159], v[158:159], s[32:33], v[160:161] op_sel_hi:[1,1,0]
    buffer_load_dwordx4 v[48:51], v5, s[4:7], s59 offen offset:1024
    v_pk_mul_f32 v[144:145], v[144:145], v[112:113]
    v_pk_mul_f32 v[146:147], v[146:147], v[114:115]
    v_pk_mul_f32 v[148:149], v[148:149], v[116:117]
    v_pk_mul_f32 v[150:151], v[150:151], v[118:119]
    v_pk_mul_f32 v[152:153], v[152:153], v[120:121]
    v_pk_mul_f32 v[154:155], v[154:155], v[122:123]
    v_pk_mul_f32 v[156:157], v[156:157], v[124:125]
    v_pk_mul_f32 v[158:159], v[158:159], v[126:127]
    v_exp_f32 v144, v144
    v_exp_f32 v145, v145
    v_exp_f32 v146, v146
    v_exp_f32 v147, v147
    buffer_load_dwordx4 v[52:55], v5, s[4:7], s60 offen offset:1024
    v_exp_f32 v148, v148
    v_exp_f32 v149, v149
    v_exp_f32 v150, v150
    v_exp_f32 v151, v151
    v_exp_f32 v152, v152
    v_exp_f32 v153, v153
    v_exp_f32 v154, v154
    v_exp_f32 v155, v155
    buffer_load_dwordx4 v[56:59], v5, s[4:7], s56 offen offset:2048
    v_exp_f32 v156, v156
    v_exp_f32 v157, v157
    v_exp_f32 v158, v158
    v_exp_f32 v159, v159
    v_pk_add_f32 v[144:145], v[144:145], 1.0 op_sel_hi:[1,0]
    v_pk_add_f32 v[146:147], v[146:147], 1.0 op_sel_hi:[1,0]
    v_pk_add_f32 v[148:149], v[148:149], 1.0 op_sel_hi:[1,0]
    v_pk_add_f32 v[150:151], v[150:151], 1.0 op_sel_hi:[1,0]
    v_pk_add_f32 v[152:153], v[152:153], 1.0 op_sel_hi:[1,0]
    v_pk_add_f32 v[154:155], v[154:155], 1.0 op_sel_hi:[1,0]
    v_pk_add_f32 v[156:157], v[156:157], 1.0 op_sel_hi:[1,0]
    v_pk_add_f32 v[158:159], v[158:159], 1.0 op_sel_hi:[1,0]
    v_rcp_f32 v144, v144
    v_rcp_f32 v145, v145
    v_rcp_f32 v146, v146
    v_rcp_f32 v147, v147
    buffer_load_dwordx4 v[60:63], v5, s[4:7], s57 offen offset:2048
    v_rcp_f32 v148, v148
    v_rcp_f32 v149, v149
    v_rcp_f32 v150, v150
    v_rcp_f32 v151, v151
    v_rcp_f32 v152, v152
    v_rcp_f32 v153, v153
    v_rcp_f32 v154, v154
    v_rcp_f32 v155, v155
    buffer_load_dwordx4 v[64:67], v5, s[4:7], s58 offen offset:2048
    v_rcp_f32 v156, v156
    v_rcp_f32 v157, v157
    v_rcp_f32 v158, v158
    v_rcp_f32 v159, v159
    v_pk_mul_f32 v[112:113], v[112:113], v[144:145]
    v_pk_mul_f32 v[114:115], v[114:115], v[146:147]
    v_pk_mul_f32 v[116:117], v[116:117], v[148:149]
    v_pk_mul_f32 v[118:119], v[118:119], v[150:151]
    v_pk_mul_f32 v[120:121], v[120:121], v[152:153]
    v_pk_mul_f32 v[122:123], v[122:123], v[154:155]
    v_pk_mul_f32 v[124:125], v[124:125], v[156:157]
    v_pk_mul_f32 v[126:127], v[126:127], v[158:159]
    buffer_load_dwordx4 v[68:71], v5, s[4:7], s59 offen offset:2048
    v_cvt_pk_bf16_f32 v112, v112, v113
    v_cvt_pk_bf16_f32 v113, v114, v115
    v_cvt_pk_bf16_f32 v116, v116, v117
    v_cvt_pk_bf16_f32 v117, v118, v119
    v_cvt_pk_bf16_f32 v120, v120, v121
    v_cvt_pk_bf16_f32 v121, v122, v123
    v_cvt_pk_bf16_f32 v124, v124, v125
    v_cvt_pk_bf16_f32 v125, v126, v127
    s_cmp_lg_u32 s19, 0
    s_cbranch_scc1 L_slow_139
    buffer_store_dwordx2 v[112:113], v5, s[4:7], s24 offen
    buffer_store_dwordx2 v[116:117], v5, s[4:7], s25 offen
    buffer_store_dwordx2 v[120:121], v5, s[4:7], s26 offen
    buffer_store_dwordx2 v[124:125], v5, s[4:7], s27 offen
L_back_140:
    v_lshlrev_b32 v164, 16, v254
    v_and_b32 v165, 0xffff0000, v254
    v_lshlrev_b32 v166, 16, v255
    v_and_b32 v167, 0xffff0000, v255
    s_add_u32 s34, s42, 2
    s_lshr_b32 s35, s34, 1
    s_lshl_b32 s35, s35, 10
    s_and_b32 s34, s34, 1
    s_lshl_b32 s34, s34, 3
    s_add_u32 s35, s35, s34
    s_add_u32 s24, s35, s48
    s_add_u32 s25, s24, 49152
    s_add_u32 s26, s25, 49152
    s_add_u32 s27, s26, 49152
    v_pk_add_f32 v[128:129], v[128:129], v[164:165]
    v_pk_add_f32 v[130:131], v[130:131], v[166:167]
    v_pk_add_f32 v[132:133], v[132:133], v[164:165]
    v_pk_add_f32 v[134:135], v[134:135], v[166:167]
    v_pk_add_f32 v[136:137], v[136:137], v[164:165]
    v_pk_add_f32 v[138:139], v[138:139], v[166:167]
    v_pk_add_f32 v[140:141], v[140:141], v[164:165]
    v_pk_add_f32 v[142:143], v[142:143], v[166:167]
    buffer_load_dwordx4 v[72:75], v5, s[4:7], s60 offen offset:2048
    v_pk_mul_f32 v[144:145], v[128:129], v[128:129]
    v_pk_mul_f32 v[146:147], v[130:131], v[130:131]
    v_pk_mul_f32 v[148:149], v[132:133], v[132:133]
    v_pk_mul_f32 v[150:151], v[134:135], v[134:135]
    v_pk_mul_f32 v[152:153], v[136:137], v[136:137]
    v_pk_mul_f32 v[154:155], v[138:139], v[138:139]
    v_pk_mul_f32 v[156:157], v[140:141], v[140:141]
    v_pk_mul_f32 v[158:159], v[142:143], v[142:143]
    v_pk_fma_f32 v[144:145], v[144:145], s[32:33], v[160:161] op_sel_hi:[1,1,0]
    v_pk_fma_f32 v[146:147], v[146:147], s[32:33], v[160:161] op_sel_hi:[1,1,0]
    v_pk_fma_f32 v[148:149], v[148:149], s[32:33], v[160:161] op_sel_hi:[1,1,0]
    v_pk_fma_f32 v[150:151], v[150:151], s[32:33], v[160:161] op_sel_hi:[1,1,0]
    v_pk_fma_f32 v[152:153], v[152:153], s[32:33], v[160:161] op_sel_hi:[1,1,0]
    v_pk_fma_f32 v[154:155], v[154:155], s[32:33], v[160:161] op_sel_hi:[1,1,0]
    v_pk_fma_f32 v[156:157], v[156:157], s[32:33], v[160:161] op_sel_hi:[1,1,0]
    v_pk_fma_f32 v[158:159], v[158:159], s[32:33], v[160:161] op_sel_hi:[1,1,0]
    buffer_load_dwordx4 v[76:79], v5, s[4:7], s56 offen offset:3072
    s_add_u32 s56, s56, 4096
    v_pk_mul_f32 v[144:145], v[144:145], v[128:129]
    v_pk_mul_f32 v[146:147], v[146:147], v[130:131]
    v_pk_mul_f32 v[148:149], v[148:149], v[132:133]
    v_pk_mul_f32 v[150:151], v[150:151], v[134:135]
    v_pk_mul_f32 v[152:153], v[152:153], v[136:137]
    v_pk_mul_f32 v[154:155], v[154:155], v[138:139]
    v_pk_mul_f32 v[156:157], v[156:157], v[140:141]
    v_pk_mul_f32 v[158:159], v[158:159], v[142:143]
    v_exp_f32 v144, v144
    v_exp_f32 v145, v145
    v_exp_f32 v146, v146
    v_exp_f32 v147, v147
    buffer_load_dwordx4 v[80:83], v5, s[4:7], s57 offen offset:3072
    s_add_u32 s57, s57, 4096
    v_exp_f32 v148, v148
    v_exp_f32 v149, v149
    v_exp_f32 v150, v150
    v_exp_f32 v151, v151
    v_exp_f32 v152, v152
    v_exp_f32 v153, v153
    v_exp_f32 v154, v154
    v_exp_f32 v155, v155
    buffer_load_dwordx4 v[84:87], v5, s[4:7], s58 offen offset:3072
    s_add_u32 s58, s58, 4096
    v_exp_f32 v156, v156
    v_exp_f32 v157, v157
    v_exp_f32 v158, v158
    v_exp_f32 v159, v159
    v_pk_add_f32 v[144:145], v[144:145], 1.0 op_sel_hi:[1,0]
    v_pk_add_f32 v[146:147], v[146:147], 1.0 op_sel_hi:[1,0]
    v_pk_add_f32 v[148:149], v[148:149], 1.0 op_sel_hi:[1,0]
    v_pk_add_f32 v[150:151], v[150:151], 1.0 op_sel_hi:[1,0]
    v_pk_add_f32 v[152:153], v[152:153], 1.0 op_sel_hi:[1,0]
    v_pk_add_f32 v[154:155], v[154:155], 1.0 op_sel_hi:[1,0]
    v_pk_add_f32 v[156:157], v[156:157], 1.0 op_sel_hi:[1,0]
    v_pk_add_f32 v[158:159], v[158:159], 1.0 op_sel_hi:[1,0]
    v_rcp_f32 v144, v144
    v_rcp_f32 v145, v145
    v_rcp_f32 v146, v146
    v_rcp_f32 v147, v147
    buffer_load_dwordx4 v[88:91], v5, s[4:7], s59 offen offset:3072
    s_add_u32 s59, s59, 4096
    v_rcp_f32 v148, v148
    v_rcp_f32 v149, v149
    v_rcp_f32 v150, v150
    v_rcp_f32 v151, v151
    v_rcp_f32 v152, v152
    v_rcp_f32 v153, v153
    v_rcp_f32 v154, v154
    v_rcp_f32 v155, v155
    buffer_load_dwordx4 v[92:95], v5, s[4:7], s60 offen offset:3072
    s_add_u32 s60, s60, 4096
    v_rcp_f32 v156, v156
    v_rcp_f32 v157, v157
    v_rcp_f32 v158, v158
    v_rcp_f32 v159, v159
    v_pk_mul_f32 v[128:129], v[128:129], v[144:145]
    v_pk_mul_f32 v[130:131], v[130:131], v[146:147]
    v_pk_mul_f32 v[132:133], v[132:133], v[148:149]
    v_pk_mul_f32 v[134:135], v[134:135], v[150:151]
    v_pk_mul_f32 v[136:137], v[136:137], v[152:153]
    v_pk_mul_f32 v[138:139], v[138:139], v[154:155]
    v_pk_mul_f32 v[140:141], v[140:141], v[156:157]
    v_pk_mul_f32 v[142:143], v[142:143], v[158:159]
    v_cvt_pk_bf16_f32 v128, v128, v129
    v_cvt_pk_bf16_f32 v129, v130, v131
    v_cvt_pk_bf16_f32 v132, v132, v133
    v_cvt_pk_bf16_f32 v133, v134, v135
    v_cvt_pk_bf16_f32 v136, v136, v137
    v_cvt_pk_bf16_f32 v137, v138, v139
    v_cvt_pk_bf16_f32 v140, v140, v141
    v_cvt_pk_bf16_f32 v141, v142, v143
    s_cmp_lg_u32 s19, 0
    s_cbranch_scc1 L_slow_141
    buffer_store_dwordx2 v[128:129], v5, s[4:7], s24 offen
    buffer_store_dwordx2 v[132:133], v5, s[4:7], s25 offen
    buffer_store_dwordx2 v[136:137], v5, s[4:7], s26 offen
    buffer_store_dwordx2 v[140:141], v5, s[4:7], s27 offen
L_back_142:
    s_lshl_b32 s21, s40, 9
    s_add_u32 s21, s21, 1085440
    s_lshr_b32 s24, s41, 1
    s_lshl_b32 s24, s24, 7
    s_add_u32 s24, s24, s21
    s_and_b32 s25, s41, 1
    s_lshl_b32 s25, s25, 2
    s_add_u32 s25, s25, s16
    s_lshl_b32 s25, s25, 2
    s_add_u32 s24, s24, s25
    s_lshl_b32 s25, s16, 7
    s_add_u32 s21, s21, s25
    v_lshlrev_b32 v12, 2, v3
    v_add_u32 v12, s21, v12
    v_mov_b32 v6, 0
    v_mov_b32 v7, 1
    s_mov_b32 s26, 1
    s_waitcnt vmcnt(0)
    s_mov_b64 exec, 1
    s_cmp_lg_u32 s19, 0
    s_cbranch_scc1 L_slow_143
    buffer_store_dword v7, v6, s[4:7], s24 offen
L_back_144:
    s_mov_b64 exec, -1
    s_load_dwordx2 s[8:9], s[0:1], 88
    s_mov_b32 s10, 1280
    s_mov_b32 s11, 0x20000
    s_waitcnt lgkmcnt(0)
    s_load_dwordx2 s[12:13], s[0:1], 112
    s_mov_b32 s14, 2621440
    s_mov_b32 s15, 0x20000
    s_waitcnt lgkmcnt(0)
    s_mov_b32 s25, 12800
    v_lshlrev_b32 v6, 1, v11
    buffer_load_dwordx2 v[240:241], v11, s[8:11], 0 offen
    buffer_load_dwordx4 v[244:247], v6, s[4:7], s25 offen sc1
    s_mov_b32 s37, s38
L_f_145:
    buffer_load_dword v13, v12, s[4:7], 0 offen sc1
    s_waitcnt vmcnt(0)
    v_cmp_gt_u32 vcc, s26, v13
    s_cbranch_vccz L_fd_146
    s_sub_u32 s37, s37, 1
    s_cbranch_scc1 L_fd_146
    s_branch L_f_145
L_fd_146:
    s_cmp_lt_i32 s37, 0
    s_cselect_b32 s38, 4, s38
    buffer_load_dwordx4 v[176:179], v5, s[4:7], s52 offen offset:0 sc1
    buffer_load_dwordx4 v[180:183], v5, s[4:7], s53 offen offset:0 sc1
    buffer_load_dwordx4 v[184:187], v5, s[4:7], s54 offen offset:0 sc1
    buffer_load_dwordx4 v[188:191], v5, s[4:7], s55 offen offset:0 sc1
    buffer_load_dwordx4 v[192:195], v5, s[4:7], s52 offen offset:1024 sc1
    buffer_load_dwordx4 v[196:199], v5, s[4:7], s53 offen offset:1024 sc1
    buffer_load_dwordx4 v[200:203], v5, s[4:7], s54 offen offset:1024 sc1
    buffer_load_dwordx4 v[204:207], v5, s[4:7], s55 offen offset:1024 sc1
    buffer_load_dwordx4 v[208:211], v5, s[4:7], s52 offen offset:2048 sc1
    buffer_load_dwordx4 v[212:215], v5, s[4:7], s53 offen offset:2048 sc1
    buffer_load_dwordx4 v[216:219], v5, s[4:7], s54 offen offset:2048 sc1
    buffer_load_dwordx4 v[220:223], v5, s[4:7], s55 offen offset:2048 sc1
    buffer_load_dwordx4 v[224:227], v5, s[4:7], s52 offen offset:3072 sc1
    s_add_u32 s52, s52, 4096
    buffer_load_dwordx4 v[228:231], v5, s[4:7], s53 offen offset:3072 sc1
    s_add_u32 s53, s53, 4096
    buffer_load_dwordx4 v[232:235], v5, s[4:7], s54 offen offset:3072 sc1
    s_add_u32 s54, s54, 4096
    buffer_load_dwordx4 v[236:239], v5, s[4:7], s55 offen offset:3072 sc1
    s_add_u32 s55, s55, 4096
    s_waitcnt vmcnt(12)
    v_mfma_f32_16x16x32_bf16 v[96:99], v[16:19], v[176:179], 0
    v_mfma_f32_16x16x32_bf16 v[100:103], v[20:23], v[176:179], 0
    v_mfma_f32_16x16x32_bf16 v[104:107], v[24:27], v[176:179], 0
    v_mfma_f32_16x16x32_bf16 v[108:111], v[28:31], v[176:179], 0
    v_mfma_f32_16x16x32_bf16 v[112:115], v[32:35], v[176:179], 0
    v_mfma_f32_16x16x32_bf16 v[116:119], v[16:19], v[180:183], 0
    v_mfma_f32_16x16x32_bf16 v[120:123], v[20:23], v[180:183], 0
    v_mfma_f32_16x16x32_bf16 v[124:127], v[24:27], v[180:183], 0
    v_mfma_f32_16x16x32_bf16 v[128:131], v[28:31], v[180:183], 0
    v_mfma_f32_16x16x32_bf16 v[132:135], v[32:35], v[180:183], 0
    v_mfma_f32_16x16x32_bf16 v[136:139], v[16:19], v[184:187], 0
    v_mfma_f32_16x16x32_bf16 v[140:143], v[20:23], v[184:187], 0
    v_mfma_f32_16x16x32_bf16 v[144:147], v[24:27], v[184:187], 0
    v_mfma_f32_16x16x32_bf16 v[148:151], v[28:31], v[184:187], 0
    v_mfma_f32_16x16x32_bf16 v[152:155], v[32:35], v[184:187], 0
    v_mfma_f32_16x16x32_bf16 v[156:159], v[16:19], v[188:191], 0
    v_mfma_f32_16x16x32_bf16 v[160:163], v[20:23], v[188:191], 0
    v_mfma_f32_16x16x32_bf16 v[164:167], v[24:27], v[188:191], 0
    v_mfma_f32_16x16x32_bf16 v[168:171], v[28:31], v[188:191], 0
    v_mfma_f32_16x16x32_bf16 v[172:175], v[32:35], v[188:191], 0
    s_waitcnt vmcnt(8)
    v_mfma_f32_16x16x32_bf16 v[96:99], v[36:39], v[192:195], v[96:99]
    buffer_load_dwordx4 v[16:19], v5, s[4:7], s56 offen offset:0
    v_mfma_f32_16x16x32_bf16 v[100:103], v[40:43], v[192:195], v[100:103]
    v_mfma_f32_16x16x32_bf16 v[104:107], v[44:47], v[192:195], v[104:107]
    buffer_load_dwordx4 v[20:23], v5, s[4:7], s57 offen offset:0
    v_mfma_f32_16x16x32_bf16 v[108:111], v[48:51], v[192:195], v[108:111]
    v_mfma_f32_16x16x32_bf16 v[112:115], v[52:55], v[192:195], v[112:115]
    buffer_load_dwordx4 v[24:27], v5, s[4:7], s58 offen offset:0
    v_mfma_f32_16x16x32_bf16 v[116:119], v[36:39], v[196:199], v[116:119]
    v_mfma_f32_16x16x32_bf16 v[120:123], v[40:43], v[196:199], v[120:123]
    buffer_load_dwordx4 v[28:31], v5, s[4:7], s59 offen offset:0
    v_mfma_f32_16x16x32_bf16 v[124:127], v[44:47], v[196:199], v[124:127]
    v_mfma_f32_16x16x32_bf16 v[128:131], v[48:51], v[196:199], v[128:131]
    buffer_load_dwordx4 v[32:35], v5, s[4:7], s60 offen offset:0
    v_mfma_f32_16x16x32_bf16 v[132:135], v[52:55], v[196:199], v[132:135]
    v_mfma_f32_16x16x32_bf16 v[136:139], v[36:39], v[200:203], v[136:139]
    buffer_load_dwordx4 v[176:179], v5, s[4:7], s52 offen offset:0 sc1
    v_mfma_f32_16x16x32_bf16 v[140:143], v[40:43], v[200:203], v[140:143]
    v_mfma_f32_16x16x32_bf16 v[144:147], v[44:47], v[200:203], v[144:147]
    buffer_load_dwordx4 v[180:183], v5, s[4:7], s53 offen offset:0 sc1
    v_mfma_f32_16x16x32_bf16 v[148:151], v[48:51], v[200:203], v[148:151]
    v_mfma_f32_16x16x32_bf16 v[152:155], v[52:55], v[200:203], v[152:155]
    buffer_load_dwordx4 v[184:187], v5, s[4:7], s54 offen offset:0 sc1
    v_mfma_f32_16x16x32_bf16 v[156:159], v[36:39], v[204:207], v[156:159]
    v_mfma_f32_16x16x32_bf16 v[160:163], v[40:43], v[204:207], v[160:163]
    buffer_load_dwordx4 v[188:191], v5, s[4:7], s55 offen offset:0 sc1
    v_mfma_f32_16x16x32_bf16 v[164:167], v[44:47], v[204:207], v[164:167]
    v_mfma_f32_16x16x32_bf16 v[168:171], v[48:51], v[204:207], v[168:171]
    v_mfma_f32_16x16x32_bf16 v[172:175], v[52:55], v[204:207], v[172:175]
    s_waitcnt vmcnt(13)
    v_mfma_f32_16x16x32_bf16 v[96:99], v[56:59], v[208:211], v[96:99]
    buffer_load_dwordx4 v[36:39], v5, s[4:7], s56 offen offset:1024
    v_mfma_f32_16x16x32_bf16 v[100:103], v[60:63], v[208:211], v[100:103]
    v_mfma_f32_16x16x32_bf16 v[104:107], v[64:67], v[208:211], v[104:107]
    buffer_load_dwordx4 v[40:43], v5, s[4:7], s57 offen offset:1024
    v_mfma_f32_16x16x32_bf16 v[108:111], v[68:71], v[208:211], v[108:111]
    v_mfma_f32_16x16x32_bf16 v[112:115], v[72:75], v[208:211], v[112:115]
    buffer_load_dwordx4 v[44:47], v5, s[4:7], s58 offen offset:1024
    v_mfma_f32_16x16x32_bf16 v[116:119], v[56:59], v[212:215], v[116:119]
    v_mfma_f32_16x16x32_bf16 v[120:123], v[60:63], v[212:215], v[120:123]
    buffer_load_dwordx4 v[48:51], v5, s[4:7], s59 offen offset:1024
    v_mfma_f32_16x16x32_bf16 v[124:127], v[64:67], v[212:215], v[124:127]
    v_mfma_f32_16x16x32_bf16 v[128:131], v[68:71], v[212:215], v[128:131]
    buffer_load_dwordx4 v[52:55], v5, s[4:7], s60 offen offset:1024
    v_mfma_f32_16x16x32_bf16 v[132:135], v[72:75], v[212:215], v[132:135]
    v_mfma_f32_16x16x32_bf16 v[136:139], v[56:59], v[216:219], v[136:139]
    buffer_load_dwordx4 v[192:195], v5, s[4:7], s52 offen offset:1024 sc1
    v_mfma_f32_16x16x32_bf16 v[140:143], v[60:63], v[216:219], v[140:143]
    v_mfma_f32_16x16x32_bf16 v[144:147], v[64:67], v[216:219], v[144:147]
    buffer_load_dwordx4 v[196:199], v5, s[4:7], s53 offen offset:1024 sc1
    v_mfma_f32_16x16x32_bf16 v[148:151], v[68:71], v[216:219], v[148:151]
    v_mfma_f32_16x16x32_bf16 v[152:155], v[72:75], v[216:219], v[152:155]
    buffer_load_dwordx4 v[200:203], v5, s[4:7], s54 offen offset:1024 sc1
    v_mfma_f32_16x16x32_bf16 v[156:159], v[56:59], v[220:223], v[156:159]
    v_mfma_f32_16x16x32_bf16 v[160:163], v[60:63], v[220:223], v[160:163]
    buffer_load_dwordx4 v[204:207], v5, s[4:7], s55 offen offset:1024 sc1
    v_mfma_f32_16x16x32_bf16 v[164:167], v[64:67], v[220:223], v[164:167]
    v_mfma_f32_16x16x32_bf16 v[168:171], v[68:71], v[220:223], v[168:171]
    v_mfma_f32_16x16x32_bf16 v[172:175], v[72:75], v[220:223], v[172:175]
    s_waitcnt vmcnt(18)
    v_mfma_f32_16x16x32_bf16 v[96:99], v[76:79], v[224:227], v[96:99]
    buffer_load_dwordx4 v[56:59], v5, s[4:7], s56 offen offset:2048
    v_mfma_f32_16x16x32_bf16 v[100:103], v[80:83], v[224:227], v[100:103]
    v_mfma_f32_16x16x32_bf16 v[104:107], v[84:87], v[224:227], v[104:107]
    buffer_load_dwordx4 v[60:63], v5, s[4:7], s57 offen offset:2048
    v_mfma_f32_16x16x32_bf16 v[108:111], v[88:91], v[224:227], v[108:111]
    v_mfma_f32_16x16x32_bf16 v[112:115], v[92:95], v[224:227], v[112:115]
    buffer_load_dwordx4 v[64:67], v5, s[4:7], s58 offen offset:2048
    v_mfma_f32_16x16x32_bf16 v[116:119], v[76:79], v[228:231], v[116:119]
    v_mfma_f32_16x16x32_bf16 v[120:123], v[80:83], v[228:231], v[120:123]
    buffer_load_dwordx4 v[68:71], v5, s[4:7], s59 offen offset:2048
    v_mfma_f32_16x16x32_bf16 v[124:127], v[84:87], v[228:231], v[124:127]
    v_mfma_f32_16x16x32_bf16 v[128:131], v[88:91], v[228:231], v[128:131]
    buffer_load_dwordx4 v[72:75], v5, s[4:7], s60 offen offset:2048
    v_mfma_f32_16x16x32_bf16 v[132:135], v[92:95], v[228:231], v[132:135]
    v_mfma_f32_16x16x32_bf16 v[136:139], v[76:79], v[232:235], v[136:139]
    buffer_load_dwordx4 v[208:211], v5, s[4:7], s52 offen offset:2048 sc1
    v_mfma_f32_16x16x32_bf16 v[140:143], v[80:83], v[232:235], v[140:143]
    v_mfma_f32_16x16x32_bf16 v[144:147], v[84:87], v[232:235], v[144:147]
    buffer_load_dwordx4 v[212:215], v5, s[4:7], s53 offen offset:2048 sc1
    v_mfma_f32_16x16x32_bf16 v[148:151], v[88:91], v[232:235], v[148:151]
    v_mfma_f32_16x16x32_bf16 v[152:155], v[92:95], v[232:235], v[152:155]
    buffer_load_dwordx4 v[216:219], v5, s[4:7], s54 offen offset:2048 sc1
    v_mfma_f32_16x16x32_bf16 v[156:159], v[76:79], v[236:239], v[156:159]
    v_mfma_f32_16x16x32_bf16 v[160:163], v[80:83], v[236:239], v[160:163]
    buffer_load_dwordx4 v[220:223], v5, s[4:7], s55 offen offset:2048 sc1
    v_mfma_f32_16x16x32_bf16 v[164:167], v[84:87], v[236:239], v[164:167]
    v_mfma_f32_16x16x32_bf16 v[168:171], v[88:91], v[236:239], v[168:171]
    v_mfma_f32_16x16x32_bf16 v[172:175], v[92:95], v[236:239], v[172:175]
    s_waitcnt vmcnt(18)
    v_mfma_f32_16x16x32_bf16 v[96:99], v[16:19], v[176:179], v[96:99]
    buffer_load_dwordx4 v[76:79], v5, s[4:7], s56 offen offset:3072
    s_add_u32 s56, s56, 4096
    v_mfma_f32_16x16x32_bf16 v[100:103], v[20:23], v[176:179], v[100:103]
    v_mfma_f32_16x16x32_bf16 v[104:107], v[24:27], v[176:179], v[104:107]
    buffer_load_dwordx4 v[80:83], v5, s[4:7], s57 offen offset:3072
    s_add_u32 s57, s57, 4096
    v_mfma_f32_16x16x32_bf16 v[108:111], v[28:31], v[176:179], v[108:111]
    v_mfma_f32_16x16x32_bf16 v[112:115], v[32:35], v[176:179], v[112:115]
    buffer_load_dwordx4 v[84:87], v5, s[4:7], s58 offen offset:3072
    s_add_u32 s58, s58, 4096
    v_mfma_f32_16x16x32_bf16 v[116:119], v[16:19], v[180:183], v[116:119]
    v_mfma_f32_16x16x32_bf16 v[120:123], v[20:23], v[180:183], v[120:123]
    buffer_load_dwordx4 v[88:91], v5, s[4:7], s59 offen offset:3072
    s_add_u32 s59, s59, 4096
    v_mfma_f32_16x16x32_bf16 v[124:127], v[24:27], v[180:183], v[124:127]
    v_mfma_f32_16x16x32_bf16 v[128:131], v[28:31], v[180:183], v[128:131]
    buffer_load_dwordx4 v[92:95], v5, s[4:7], s60 offen offset:3072
    s_add_u32 s60, s60, 4096
    v_mfma_f32_16x16x32_bf16 v[132:135], v[32:35], v[180:183], v[132:135]
    v_mfma_f32_16x16x32_bf16 v[136:139], v[16:19], v[184:187], v[136:139]
    buffer_load_dwordx4 v[224:227], v5, s[4:7], s52 offen offset:3072 sc1
    s_add_u32 s52, s52, 4096
    v_mfma_f32_16x16x32_bf16 v[140:143], v[20:23], v[184:187], v[140:143]
    v_mfma_f32_16x16x32_bf16 v[144:147], v[24:27], v[184:187], v[144:147]
    buffer_load_dwordx4 v[228:231], v5, s[4:7], s53 offen offset:3072 sc1
    s_add_u32 s53, s53, 4096
    v_mfma_f32_16x16x32_bf16 v[148:151], v[28:31], v[184:187], v[148:151]
    v_mfma_f32_16x16x32_bf16 v[152:155], v[32:35], v[184:187], v[152:155]
    buffer_load_dwordx4 v[232:235], v5, s[4:7], s54 offen offset:3072 sc1
    s_add_u32 s54, s54, 4096
    v_mfma_f32_16x16x32_bf16 v[156:159], v[16:19], v[188:191], v[156:159]
    v_mfma_f32_16x16x32_bf16 v[160:163], v[20:23], v[188:191], v[160:163]
    buffer_load_dwordx4 v[236:239], v5, s[4:7], s55 offen offset:3072 sc1
    s_add_u32 s55, s55, 4096
    v_mfma_f32_16x16x32_bf16 v[164:167], v[24:27], v[188:191], v[164:167]
    v_mfma_f32_16x16x32_bf16 v[168:171], v[28:31], v[188:191], v[168:171]
    v_mfma_f32_16x16x32_bf16 v[172:175], v[32:35], v[188:191], v[172:175]
    s_waitcnt vmcnt(18)
    v_mfma_f32_16x16x32_bf16 v[96:99], v[36:39], v[192:195], v[96:99]
    buffer_load_dwordx4 v[16:19], v5, s[4:7], s56 offen offset:0
    v_mfma_f32_16x16x32_bf16 v[100:103], v[40:43], v[192:195], v[100:103]
    v_mfma_f32_16x16x32_bf16 v[104:107], v[44:47], v[192:195], v[104:107]
    buffer_load_dwordx4 v[20:23], v5, s[4:7], s57 offen offset:0
    v_mfma_f32_16x16x32_bf16 v[108:111], v[48:51], v[192:195], v[108:111]
    v_mfma_f32_16x16x32_bf16 v[112:115], v[52:55], v[192:195], v[112:115]
    buffer_load_dwordx4 v[24:27], v5, s[4:7], s58 offen offset:0
    v_mfma_f32_16x16x32_bf16 v[116:119], v[36:39], v[196:199], v[116:119]
    v_mfma_f32_16x16x32_bf16 v[120:123], v[40:43], v[196:199], v[120:123]
    buffer_load_dwordx4 v[28:31], v5, s[4:7], s59 offen offset:0
    v_mfma_f32_16x16x32_bf16 v[124:127], v[44:47], v[196:199], v[124:127]
    v_mfma_f32_16x16x32_bf16 v[128:131], v[48:51], v[196:199], v[128:131]
    buffer_load_dwordx4 v[32:35], v5, s[4:7], s60 offen offset:0
    v_mfma_f32_16x16x32_bf16 v[132:135], v[52:55], v[196:199], v[132:135]
    v_mfma_f32_16x16x32_bf16 v[136:139], v[36:39], v[200:203], v[136:139]
    buffer_load_dwordx4 v[176:179], v5, s[4:7], s52 offen offset:0 sc1
    v_mfma_f32_16x16x32_bf16 v[140:143], v[40:43], v[200:203], v[140:143]
    v_mfma_f32_16x16x32_bf16 v[144:147], v[44:47], v[200:203], v[144:147]
    buffer_load_dwordx4 v[180:183], v5, s[4:7], s53 offen offset:0 sc1
    v_mfma_f32_16x16x32_bf16 v[148:151], v[48:51], v[200:203], v[148:151]
    v_mfma_f32_16x16x32_bf16 v[152:155], v[52:55], v[200:203], v[152:155]
    buffer_load_dwordx4 v[184:187], v5, s[4:7], s54 offen offset:0 sc1
    v_mfma_f32_16x16x32_bf16 v[156:159], v[36:39], v[204:207], v[156:159]
    v_mfma_f32_16x16x32_bf16 v[160:163], v[40:43], v[204:207], v[160:163]
    buffer_load_dwordx4 v[188:191], v5, s[4:7], s55 offen offset:0 sc1
    v_mfma_f32_16x16x32_bf16 v[164:167], v[44:47], v[204:207], v[164:167]
    v_mfma_f32_16x16x32_bf16 v[168:171], v[48:51], v[204:207], v[168:171]
    v_mfma_f32_16x16x32_bf16 v[172:175], v[52:55], v[204:207], v[172:175]
    s_waitcnt vmcnt(18)
    v_mfma_f32_16x16x32_bf16 v[96:99], v[56:59], v[208:211], v[96:99]
    buffer_load_dwordx4 v[36:39], v5, s[4:7], s56 offen offset:1024
    v_mfma_f32_16x16x32_bf16 v[100:103], v[60:63], v[208:211], v[100:103]
    v_mfma_f32_16x16x32_bf16 v[104:107], v[64:67], v[208:211], v[104:107]
    buffer_load_dwordx4 v[40:43], v5, s[4:7], s57 offen offset:1024
    v_mfma_f32_16x16x32_bf16 v[108:111], v[68:71], v[208:211], v[108:111]
    v_mfma_f32_16x16x32_bf16 v[112:115], v[72:75], v[208:211], v[112:115]
    buffer_load_dwordx4 v[44:47], v5, s[4:7], s58 offen offset:1024
    v_mfma_f32_16x16x32_bf16 v[116:119], v[56:59], v[212:215], v[116:119]
    v_mfma_f32_16x16x32_bf16 v[120:123], v[60:63], v[212:215], v[120:123]
    buffer_load_dwordx4 v[48:51], v5, s[4:7], s59 offen offset:1024
    v_mfma_f32_16x16x32_bf16 v[124:127], v[64:67], v[212:215], v[124:127]
    v_mfma_f32_16x16x32_bf16 v[128:131], v[68:71], v[212:215], v[128:131]
    buffer_load_dwordx4 v[52:55], v5, s[4:7], s60 offen offset:1024
    v_mfma_f32_16x16x32_bf16 v[132:135], v[72:75], v[212:215], v[132:135]
    v_mfma_f32_16x16x32_bf16 v[136:139], v[56:59], v[216:219], v[136:139]
    buffer_load_dwordx4 v[192:195], v5, s[4:7], s52 offen offset:1024 sc1
    v_mfma_f32_16x16x32_bf16 v[140:143], v[60:63], v[216:219], v[140:143]
    v_mfma_f32_16x16x32_bf16 v[144:147], v[64:67], v[216:219], v[144:147]
    buffer_load_dwordx4 v[196:199], v5, s[4:7], s53 offen offset:1024 sc1
    v_mfma_f32_16x16x32_bf16 v[148:151], v[68:71], v[216:219], v[148:151]
    v_mfma_f32_16x16x32_bf16 v[152:155], v[72:75], v[216:219], v[152:155]
    buffer_load_dwordx4 v[200:203], v5, s[4:7], s54 offen offset:1024 sc1
    v_mfma_f32_16x16x32_bf16 v[156:159], v[56:59], v[220:223], v[156:159]
    v_mfma_f32_16x16x32_bf16 v[160:163], v[60:63], v[220:223], v[160:163]
    buffer_load_dwordx4 v[204:207], v5, s[4:7], s55 offen offset:1024 sc1
    v_mfma_f32_16x16x32_bf16 v[164:167], v[64:67], v[220:223], v[164:167]
    v_mfma_f32_16x16x32_bf16 v[168:171], v[68:71], v[220:223], v[168:171]
    v_mfma_f32_16x16x32_bf16 v[172:175], v[72:75], v[220:223], v[172:175]
    s_waitcnt vmcnt(18)
    v_mfma_f32_16x16x32_bf16 v[96:99], v[76:79], v[224:227], v[96:99]
    buffer_load_dwordx4 v[56:59], v5, s[4:7], s56 offen offset:2048
    v_mfma_f32_16x16x32_bf16 v[100:103], v[80:83], v[224:227], v[100:103]
    v_mfma_f32_16x16x32_bf16 v[104:107], v[84:87], v[224:227], v[104:107]
    buffer_load_dwordx4 v[60:63], v5, s[4:7], s57 offen offset:2048
    v_mfma_f32_16x16x32_bf16 v[108:111], v[88:91], v[224:227], v[108:111]
    v_mfma_f32_16x16x32_bf16 v[112:115], v[92:95], v[224:227], v[112:115]
    buffer_load_dwordx4 v[64:67], v5, s[4:7], s58 offen offset:2048
    v_mfma_f32_16x16x32_bf16 v[116:119], v[76:79], v[228:231], v[116:119]
    v_mfma_f32_16x16x32_bf16 v[120:123], v[80:83], v[228:231], v[120:123]
    buffer_load_dwordx4 v[68:71], v5, s[4:7], s59 offen offset:2048
    v_mfma_f32_16x16x32_bf16 v[124:127], v[84:87], v[228:231], v[124:127]
    v_mfma_f32_16x16x32_bf16 v[128:131], v[88:91], v[228:231], v[128:131]
    buffer_load_dwordx4 v[72:75], v5, s[4:7], s60 offen offset:2048
    v_mfma_f32_16x16x32_bf16 v[132:135], v[92:95], v[228:231], v[132:135]
    v_mfma_f32_16x16x32_bf16 v[136:139], v[76:79], v[232:235], v[136:139]
    buffer_load_dwordx4 v[208:211], v5, s[4:7], s52 offen offset:2048 sc1
    v_mfma_f32_16x16x32_bf16 v[140:143], v[80:83], v[232:235], v[140:143]
    v_mfma_f32_16x16x32_bf16 v[144:147], v[84:87], v[232:235], v[144:147]
    buffer_load_dwordx4 v[212:215], v5, s[4:7], s53 offen offset:2048 sc1
    v_mfma_f32_16x16x32_bf16 v[148:151], v[88:91], v[232:235], v[148:151]
    v_mfma_f32_16x16x32_bf16 v[152:155], v[92:95], v[232:235], v[152:155]
    buffer_load_dwordx4 v[216:219], v5, s[4:7], s54 offen offset:2048 sc1
    v_mfma_f32_16x16x32_bf16 v[156:159], v[76:79], v[236:239], v[156:159]
    v_mfma_f32_16x16x32_bf16 v[160:163], v[80:83], v[236:239], v[160:163]
    buffer_load_dwordx4 v[220:223], v5, s[4:7], s55 offen offset:2048 sc1
    v_mfma_f32_16x16x32_bf16 v[164:167], v[84:87], v[236:239], v[164:167]
    v_mfma_f32_16x16x32_bf16 v[168:171], v[88:91], v[236:239], v[168:171]
    v_mfma_f32_16x16x32_bf16 v[172:175], v[92:95], v[236:239], v[172:175]
    s_waitcnt vmcnt(18)
    v_mfma_f32_16x16x32_bf16 v[96:99], v[16:19], v[176:179], v[96:99]
    buffer_load_dwordx4 v[76:79], v5, s[4:7], s56 offen offset:3072
    s_add_u32 s56, s56, 4096
    v_mfma_f32_16x16x32_bf16 v[100:103], v[20:23], v[176:179], v[100:103]
    v_mfma_f32_16x16x32_bf16 v[104:107], v[24:27], v[176:179], v[104:107]
    buffer_load_dwordx4 v[80:83], v5, s[4:7], s57 offen offset:3072
    s_add_u32 s57, s57, 4096
    v_mfma_f32_16x16x32_bf16 v[108:111], v[28:31], v[176:179], v[108:111]
    v_mfma_f32_16x16x32_bf16 v[112:115], v[32:35], v[176:179], v[112:115]
    buffer_load_dwordx4 v[84:87], v5, s[4:7], s58 offen offset:3072
    s_add_u32 s58, s58, 4096
    v_mfma_f32_16x16x32_bf16 v[116:119], v[16:19], v[180:183], v[116:119]
    v_mfma_f32_16x16x32_bf16 v[120:123], v[20:23], v[180:183], v[120:123]
    buffer_load_dwordx4 v[88:91], v5, s[4:7], s59 offen offset:3072
    s_add_u32 s59, s59, 4096
    v_mfma_f32_16x16x32_bf16 v[124:127], v[24:27], v[180:183], v[124:127]
    v_mfma_f32_16x16x32_bf16 v[128:131], v[28:31], v[180:183], v[128:131]
    buffer_load_dwordx4 v[92:95], v5, s[4:7], s60 offen offset:3072
    s_add_u32 s60, s60, 4096
    v_mfma_f32_16x16x32_bf16 v[132:135], v[32:35], v[180:183], v[132:135]
    v_mfma_f32_16x16x32_bf16 v[136:139], v[16:19], v[184:187], v[136:139]
    buffer_load_dwordx4 v[224:227], v5, s[4:7], s52 offen offset:3072 sc1
    s_add_u32 s52, s52, 4096
    v_mfma_f32_16x16x32_bf16 v[140:143], v[20:23], v[184:187], v[140:143]
    v_mfma_f32_16x16x32_bf16 v[144:147], v[24:27], v[184:187], v[144:147]
    buffer_load_dwordx4 v[228:231], v5, s[4:7], s53 offen offset:3072 sc1
    s_add_u32 s53, s53, 4096
    v_mfma_f32_16x16x32_bf16 v[148:151], v[28:31], v[184:187], v[148:151]
    v_mfma_f32_16x16x32_bf16 v[152:155], v[32:35], v[184:187], v[152:155]
    buffer_load_dwordx4 v[232:235], v5, s[4:7], s54 offen offset:3072 sc1
    s_add_u32 s54, s54, 4096
    v_mfma_f32_16x16x32_bf16 v[156:159], v[16:19], v[188:191], v[156:159]
    v_mfma_f32_16x16x32_bf16 v[160:163], v[20:23], v[188:191], v[160:163]
    buffer_load_dwordx4 v[236:239], v5, s[4:7], s55 offen offset:3072 sc1
    s_add_u32 s55, s55, 4096
    v_mfma_f32_16x16x32_bf16 v[164:167], v[24:27], v[188:191], v[164:167]
    v_mfma_f32_16x16x32_bf16 v[168:171], v[28:31], v[188:191], v[168:171]
    v_mfma_f32_16x16x32_bf16 v[172:175], v[32:35], v[188:191], v[172:175]
    s_waitcnt vmcnt(18)
    v_mfma_f32_16x16x32_bf16 v[96:99], v[36:39], v[192:195], v[96:99]
    v_mfma_f32_16x16x32_bf16 v[100:103], v[40:43], v[192:195], v[100:103]
    v_mfma_f32_16x16x32_bf16 v[104:107], v[44:47], v[192:195], v[104:107]
    v_mfma_f32_16x16x32_bf16 v[108:111], v[48:51], v[192:195], v[108:111]
    v_mfma_f32_16x16x32_bf16 v[112:115], v[52:55], v[192:195], v[112:115]
    v_mfma_f32_16x16x32_bf16 v[116:119], v[36:39], v[196:199], v[116:119]
    v_mfma_f32_16x16x32_bf16 v[120:123], v[40:43], v[196:199], v[120:123]
    v_mfma_f32_16x16x32_bf16 v[124:127], v[44:47], v[196:199], v[124:127]
    v_mfma_f32_16x16x32_bf16 v[128:131], v[48:51], v[196:199], v[128:131]
    v_mfma_f32_16x16x32_bf16 v[132:135], v[52:55], v[196:199], v[132:135]
    v_mfma_f32_16x16x32_bf16 v[136:139], v[36:39], v[200:203], v[136:139]
    v_mfma_f32_16x16x32_bf16 v[140:143], v[40:43], v[200:203], v[140:143]
    v_mfma_f32_16x16x32_bf16 v[144:147], v[44:47], v[200:203], v[144:147]
    v_mfma_f32_16x16x32_bf16 v[148:151], v[48:51], v[200:203], v[148:151]
    v_mfma_f32_16x16x32_bf16 v[152:155], v[52:55], v[200:203], v[152:155]
    v_mfma_f32_16x16x32_bf16 v[156:159], v[36:39], v[204:207], v[156:159]
    v_mfma_f32_16x16x32_bf16 v[160:163], v[40:43], v[204:207], v[160:163]
    v_mfma_f32_16x16x32_bf16 v[164:167], v[44:47], v[204:207], v[164:167]
    v_mfma_f32_16x16x32_bf16 v[168:171], v[48:51], v[204:207], v[168:171]
    v_mfma_f32_16x16x32_bf16 v[172:175], v[52:55], v[204:207], v[172:175]
    s_lshl_b32 s21, s40, 2
    s_add_u32 s21, s21, s16
    s_mul_i32 s24, s21, 20480
    s_add_u32 s24, s24, 6815744
    s_mul_i32 s27, s21, 20480
    s_waitcnt vmcnt(9)
    v_mfma_f32_16x16x32_bf16 v[96:99], v[56:59], v[208:211], v[96:99]
    v_mfma_f32_16x16x32_bf16 v[100:103], v[60:63], v[208:211], v[100:103]
    v_mfma_f32_16x16x32_bf16 v[104:107], v[64:67], v[208:211], v[104:107]
    v_mfma_f32_16x16x32_bf16 v[108:111], v[68:71], v[208:211], v[108:111]
    v_mfma_f32_16x16x32_bf16 v[112:115], v[72:75], v[208:211], v[112:115]
    v_mfma_f32_16x16x32_bf16 v[116:119], v[56:59], v[212:215], v[116:119]
    v_mfma_f32_16x16x32_bf16 v[120:123], v[60:63], v[212:215], v[120:123]
    v_mfma_f32_16x16x32_bf16 v[124:127], v[64:67], v[212:215], v[124:127]
    v_mfma_f32_16x16x32_bf16 v[128:131], v[68:71], v[212:215], v[128:131]
    v_mfma_f32_16x16x32_bf16 v[132:135], v[72:75], v[212:215], v[132:135]
    v_mfma_f32_16x16x32_bf16 v[136:139], v[56:59], v[216:219], v[136:139]
    v_mfma_f32_16x16x32_bf16 v[140:143], v[60:63], v[216:219], v[140:143]
    v_mfma_f32_16x16x32_bf16 v[144:147], v[64:67], v[216:219], v[144:147]
    v_mfma_f32_16x16x32_bf16 v[148:151], v[68:71], v[216:219], v[148:151]
    v_mfma_f32_16x16x32_bf16 v[152:155], v[72:75], v[216:219], v[152:155]
    v_mfma_f32_16x16x32_bf16 v[156:159], v[56:59], v[220:223], v[156:159]
    v_mfma_f32_16x16x32_bf16 v[160:163], v[60:63], v[220:223], v[160:163]
    v_mfma_f32_16x16x32_bf16 v[164:167], v[64:67], v[220:223], v[164:167]
    v_mfma_f32_16x16x32_bf16 v[168:171], v[68:71], v[220:223], v[168:171]
    v_mfma_f32_16x16x32_bf16 v[172:175], v[72:75], v[220:223], v[172:175]
    s_waitcnt vmcnt(0)
    v_mfma_f32_16x16x32_bf16 v[96:99], v[76:79], v[224:227], v[96:99]
    v_mfma_f32_16x16x32_bf16 v[100:103], v[80:83], v[224:227], v[100:103]
    v_mfma_f32_16x16x32_bf16 v[104:107], v[84:87], v[224:227], v[104:107]
    v_mfma_f32_16x16x32_bf16 v[108:111], v[88:91], v[224:227], v[108:111]
    v_mfma_f32_16x16x32_bf16 v[112:115], v[92:95], v[224:227], v[112:115]
    v_mfma_f32_16x16x32_bf16 v[116:119], v[76:79], v[228:231], v[116:119]
    v_mfma_f32_16x16x32_bf16 v[120:123], v[80:83], v[228:231], v[120:123]
    v_mfma_f32_16x16x32_bf16 v[124:127], v[84:87], v[228:231], v[124:127]
    v_mfma_f32_16x16x32_bf16 v[128:131], v[88:91], v[228:231], v[128:131]
    v_mfma_f32_16x16x32_bf16 v[132:135], v[92:95], v[228:231], v[132:135]
    v_mfma_f32_16x16x32_bf16 v[136:139], v[76:79], v[232:235], v[136:139]
    v_mfma_f32_16x16x32_bf16 v[140:143], v[80:83], v[232:235], v[140:143]
    v_mfma_f32_16x16x32_bf16 v[144:147], v[84:87], v[232:235], v[144:147]
    v_mfma_f32_16x16x32_bf16 v[148:151], v[88:91], v[232:235], v[148:151]
    v_mfma_f32_16x16x32_bf16 v[152:155], v[92:95], v[232:235], v[152:155]
    v_mfma_f32_16x16x32_bf16 v[156:159], v[76:79], v[236:239], v[156:159]
    v_mfma_f32_16x16x32_bf16 v[160:163], v[80:83], v[236:239], v[160:163]
    v_mfma_f32_16x16x32_bf16 v[164:167], v[84:87], v[236:239], v[164:167]
    v_mfma_f32_16x16x32_bf16 v[168:171], v[88:91], v[236:239], v[168:171]
    v_mfma_f32_16x16x32_bf16 v[172:175], v[92:95], v[236:239], v[172:175]
    buffer_load_dwordx2 v[16:17], v10, s[4:7], s24 offen offset:0 sc1
    buffer_load_dwordx2 v[18:19], v10, s[4:7], s24 offen offset:48 sc1
    buffer_load_dwordx2 v[20:21], v10, s[4:7], s24 offen offset:96 sc1
    buffer_load_dwordx2 v[22:23], v10, s[4:7], s24 offen offset:144 sc1
    buffer_load_dwordx2 v[24:25], v10, s[4:7], s24 offen offset:192 sc1
    buffer_load_dwordx2 v[26:27], v10, s[4:7], s24 offen offset:240 sc1
    v_mul_u32_u24 v13, 272, v1
    v_lshl_add_u32 v13, v2, 4, v13
    s_mul_i32 s21, s16, 21760
    v_add_u32 v13, s21, v13
    s_barrier
    ds_write_b128 v13, v[96:99] offset:0
    ds_write_b128 v13, v[100:103] offset:1088
    ds_write_b128 v13, v[104:107] offset:2176
    ds_write_b128 v13, v[108:111] offset:3264
    ds_write_b128 v13, v[112:115] offset:4352
    ds_write_b128 v13, v[116:119] offset:5440
    ds_write_b128 v13, v[120:123] offset:6528
    ds_write_b128 v13, v[124:127] offset:7616
    ds_write_b128 v13, v[128:131] offset:8704
    ds_write_b128 v13, v[132:135] offset:9792
    ds_write_b128 v13, v[136:139] offset:10880
    ds_write_b128 v13, v[140:143] offset:11968
    ds_write_b128 v13, v[144:147] offset:13056
    ds_write_b128 v13, v[148:151] offset:14144
    ds_write_b128 v13, v[152:155] offset:15232
    ds_write_b128 v13, v[156:159] offset:16320
    ds_write_b128 v13, v[160:163] offset:17408
    ds_write_b128 v13, v[164:167] offset:18496
    ds_write_b128 v13, v[168:171] offset:19584
    ds_write_b128 v13, v[172:175] offset:20672
    v_lshlrev_b32 v248, 16, v240
    v_and_b32 v249, 0xffff0000, v240
    v_lshlrev_b32 v250, 16, v241
    v_and_b32 v251, 0xffff0000, v241
    s_waitcnt lgkmcnt(0)
    s_barrier
    ds_read_b128 v[96:99], v8 offset:0
    ds_read_b128 v[100:103], v8 offset:21760
    ds_read_b128 v[104:107], v8 offset:43520
    ds_read_b128 v[108:111], v8 offset:65280
    ds_read_b128 v[112:115], v8 offset:48
    ds_read_b128 v[116:119], v8 offset:21808
    ds_read_b128 v[120:123], v8 offset:43568
    ds_read_b128 v[124:127], v8 offset:65328
    ds_read_b128 v[128:131], v8 offset:96
    ds_read_b128 v[132:135], v8 offset:21856
    ds_read_b128 v[136:139], v8 offset:43616
    ds_read_b128 v[140:143], v8 offset:65376
    s_waitcnt vmcnt(0)
    s_mov_b32 exec_hi, 0x0fffffff
    s_waitcnt lgkmcnt(8)
    ds_read_b128 v[144:147], v8 offset:144
    ds_read_b128 v[148:151], v8 offset:21904
    ds_read_b128 v[152:155], v8 offset:43664
    ds_read_b128 v[156:159], v8 offset:65424
    v_pk_add_f32 v[96:97], v[96:97], v[100:101]
    v_pk_add_f32 v[104:105], v[104:105], v[108:109]
    v_lshlrev_b32 v32, 16, v16
    v_pk_add_f32 v[96:97], v[96:97], v[248:249]
    v_and_b32 v33, 0xffff0000, v16
    v_pk_add_f32 v[96:97], v[96:97], v[104:105]
    v_pk_fma_f32 v[96:97], v[96:97], v[244:245], v[32:33]
    v_pk_add_f32 v[98:99], v[98:99], v[102:103]
    v_pk_add_f32 v[106:107], v[106:107], v[110:111]
    v_lshlrev_b32 v32, 16, v17
    v_pk_add_f32 v[98:99], v[98:99], v[250:251]
    v_and_b32 v33, 0xffff0000, v17
    v_pk_add_f32 v[98:99], v[98:99], v[106:107]
    v_pk_fma_f32 v[98:99], v[98:99], v[246:247], v[32:33]
    v_cvt_pk_bf16_f32 v96, v96, v97
    v_cvt_pk_bf16_f32 v97, v98, v99
    buffer_store_dwordx2 v[96:97], v9, s[12:15], s27 offen
    s_add_u32 s27, s27, 3840
    s_waitcnt lgkmcnt(8)
    ds_read_b128 v[160:163], v8 offset:192
    ds_read_b128 v[164:167], v8 offset:21952
    ds_read_b128 v[168:171], v8 offset:43712
    ds_read_b128 v[172:175], v8 offset:65472
    v_pk_add_f32 v[112:113], v[112:113], v[116:117]
    v_pk_add_f32 v[120:121], v[120:121], v[124:125]
    v_lshlrev_b32 v32, 16, v18
    v_pk_add_f32 v[112:113], v[112:113], v[248:249]
    v_and_b32 v33, 0xffff0000, v18
    v_pk_add_f32 v[112:113], v[112:113], v[120:121]
    v_pk_fma_f32 v[112:113], v[112:113], v[244:245], v[32:33]
    v_pk_add_f32 v[114:115], v[114:115], v[118:119]
    v_pk_add_f32 v[122:123], v[122:123], v[126:127]
    v_lshlrev_b32 v32, 16, v19
    v_pk_add_f32 v[114:115], v[114:115], v[250:251]
    v_and_b32 v33, 0xffff0000, v19
    v_pk_add_f32 v[114:115], v[114:115], v[122:123]
    v_pk_fma_f32 v[114:115], v[114:115], v[246:247], v[32:33]
    v_cvt_pk_bf16_f32 v112, v112, v113
    v_cvt_pk_bf16_f32 v113, v114, v115
    buffer_store_dwordx2 v[112:113], v9, s[12:15], s27 offen
    s_add_u32 s27, s27, 3840
    s_waitcnt lgkmcnt(8)
    ds_read_b128 v[176:179], v8 offset:240
    ds_read_b128 v[180:183], v8 offset:22000
    ds_read_b128 v[184:187], v8 offset:43760
    ds_read_b128 v[188:191], v8 offset:65520
    v_pk_add_f32 v[128:129], v[128:129], v[132:133]
    v_pk_add_f32 v[136:137], v[136:137], v[140:141]
    v_lshlrev_b32 v32, 16, v20
    v_pk_add_f32 v[128:129], v[128:129], v[248:249]
    v_and_b32 v33, 0xffff0000, v20
    v_pk_add_f32 v[128:129], v[128:129], v[136:137]
    v_pk_fma_f32 v[128:129], v[128:129], v[244:245], v[32:33]
    v_pk_add_f32 v[130:131], v[130:131], v[134:135]
    v_pk_add_f32 v[138:139], v[138:139], v[142:143]
    v_lshlrev_b32 v32, 16, v21
    v_pk_add_f32 v[130:131], v[130:131], v[250:251]
    v_and_b32 v33, 0xffff0000, v21
    v_pk_add_f32 v[130:131], v[130:131], v[138:139]
    v_pk_fma_f32 v[130:131], v[130:131], v[246:247], v[32:33]
    v_cvt_pk_bf16_f32 v128, v128, v129
    v_cvt_pk_bf16_f32 v129, v130, v131
    buffer_store_dwordx2 v[128:129], v9, s[12:15], s27 offen
    s_add_u32 s27, s27, 3840
    s_waitcnt lgkmcnt(8)
    v_pk_add_f32 v[144:145], v[144:145], v[148:149]
    v_pk_add_f32 v[152:153], v[152:153], v[156:157]
    v_lshlrev_b32 v32, 16, v22
    v_pk_add_f32 v[144:145], v[144:145], v[248:249]
    v_and_b32 v33, 0xffff0000, v22
    v_pk_add_f32 v[144:145], v[144:145], v[152:153]
    v_pk_fma_f32 v[144:145], v[144:145], v[244:245], v[32:33]
    v_pk_add_f32 v[146:147], v[146:147], v[150:151]
    v_pk_add_f32 v[154:155], v[154:155], v[158:159]
    v_lshlrev_b32 v32, 16, v23
    v_pk_add_f32 v[146:147], v[146:147], v[250:251]
    v_and_b32 v33, 0xffff0000, v23
    v_pk_add_f32 v[146:147], v[146:147], v[154:155]
    v_pk_fma_f32 v[146:147], v[146:147], v[246:247], v[32:33]
    v_cvt_pk_bf16_f32 v144, v144, v145
    v_cvt_pk_bf16_f32 v145, v146, v147
    buffer_store_dwordx2 v[144:145], v9, s[12:15], s27 offen
    s_add_u32 s27, s27, 3840
    s_waitcnt lgkmcnt(4)
    v_pk_add_f32 v[160:161], v[160:161], v[164:165]
    v_pk_add_f32 v[168:169], v[168:169], v[172:173]
    v_lshlrev_b32 v32, 16, v24
    v_pk_add_f32 v[160:161], v[160:161], v[248:249]
    v_and_b32 v33, 0xffff0000, v24
    v_pk_add_f32 v[160:161], v[160:161], v[168:169]
    v_pk_fma_f32 v[160:161], v[160:161], v[244:245], v[32:33]
    v_pk_add_f32 v[162:163], v[162:163], v[166:167]
    v_pk_add_f32 v[170:171], v[170:171], v[174:175]
    v_lshlrev_b32 v32, 16, v25
    v_pk_add_f32 v[162:163], v[162:163], v[250:251]
    v_and_b32 v33, 0xffff0000, v25
    v_pk_add_f32 v[162:163], v[162:163], v[170:171]
    v_pk_fma_f32 v[162:163], v[162:163], v[246:247], v[32:33]
    v_cvt_pk_bf16_f32 v160, v160, v161
    v_cvt_pk_bf16_f32 v161, v162, v163
    buffer_store_dwordx2 v[160:161], v9, s[12:15], s27 offen
    s_add_u32 s27, s27, 3840
    s_waitcnt lgkmcnt(0)
    v_pk_add_f32 v[176:177], v[176:177], v[180:181]
    v_pk_add_f32 v[184:185], v[184:185], v[188:189]
    v_lshlrev_b32 v32, 16, v26
    v_pk_add_f32 v[176:177], v[176:177], v[248:249]
    v_and_b32 v33, 0xffff0000, v26
    v_pk_add_f32 v[176:177], v[176:177], v[184:185]
    v_pk_fma_f32 v[176:177], v[176:177], v[244:245], v[32:33]
    v_pk_add_f32 v[178:179], v[178:179], v[182:183]
    v_pk_add_f32 v[186:187], v[186:187], v[190:191]
    v_lshlrev_b32 v32, 16, v27
    v_pk_add_f32 v[178:179], v[178:179], v[250:251]
    v_and_b32 v33, 0xffff0000, v27
    v_pk_add_f32 v[178:179], v[178:179], v[186:187]
    v_pk_fma_f32 v[178:179], v[178:179], v[246:247], v[32:33]
    v_cvt_pk_bf16_f32 v176, v176, v177
    v_cvt_pk_bf16_f32 v177, v178, v179
    s_mov_b64 exec, 0xfffff
    buffer_store_dwordx2 v[176:177], v9, s[12:15], s27 offen
    s_mov_b64 exec, -1
    s_waitcnt vmcnt(0)
    s_endpgm
L_slow_38:
    buffer_store_dword v15, v14, s[4:7], 0 offen sc1
    s_branch L_back_39
L_slow_40:
    buffer_store_dwordx2 v[48:49], v9, s[4:7], s24 offen sc1
    buffer_store_dword v56, v10, s[4:7], s24 offen sc1
    s_branch L_back_41
L_slow_42:
    buffer_store_dwordx2 v[60:61], v9, s[4:7], s25 offen sc1
    buffer_store_dword v60, v10, s[4:7], s25 offen sc1
    s_branch L_back_43
L_slow_45:
    buffer_store_dwordx4 v[56:59], v5, s[4:7], s24 offen offset:0 sc1
    buffer_store_dwordx2 v[60:61], v12, s[4:7], s24 offen offset:1024 sc1
    buffer_store_dwordx4 v[64:67], v5, s[4:7], s24 offen offset:2048 sc1
    buffer_store_dwordx4 v[68:71], v5, s[4:7], s24 offen offset:3072 sc1
    buffer_store_dwordx2 v[72:73], v12, s[4:7], s25 offen sc1
    s_branch L_back_46
L_slow_47:
    buffer_store_dword v10, v9, s[4:7], s44 offen sc1
    s_branch L_back_48
L_slow_51:
    buffer_store_dwordx4 v[28:31], v5, s[4:7], s30 offen sc1
    buffer_store_dword v32, v14, s[4:7], s30 offen offset:1024 sc1
    s_branch L_back_52
L_slow_53:
    buffer_store_dword v13, v10, s[4:7], s45 offen sc1
    s_branch L_back_54
L_slow_110:
    buffer_store_dword v126, v149, s[4:7], 0 offen sc1
    s_branch L_back_111
L_slow_112:
    buffer_store_dwordx2 v[48:49], v121, s[4:7], s35 offen sc1
    s_branch L_back_113
L_slow_114:
    buffer_store_dwordx2 v[124:125], v121, s[4:7], s36 offen sc1
    s_branch L_back_115
L_slow_137:
    buffer_store_dwordx2 v[96:97], v5, s[4:7], s24 offen sc1
    buffer_store_dwordx2 v[100:101], v5, s[4:7], s25 offen sc1
    buffer_store_dwordx2 v[104:105], v5, s[4:7], s26 offen sc1
    buffer_store_dwordx2 v[108:109], v5, s[4:7], s27 offen sc1
    s_branch L_back_138
L_slow_139:
    buffer_store_dwordx2 v[112:113], v5, s[4:7], s24 offen sc1
    buffer_store_dwordx2 v[116:117], v5, s[4:7], s25 offen sc1
    buffer_store_dwordx2 v[120:121], v5, s[4:7], s26 offen sc1
    buffer_store_dwordx2 v[124:125], v5, s[4:7], s27 offen sc1
    s_branch L_back_140
L_slow_141:
    buffer_store_dwordx2 v[128:129], v5, s[4:7], s24 offen sc1
    buffer_store_dwordx2 v[132:133], v5, s[4:7], s25 offen sc1
    buffer_store_dwordx2 v[136:137], v5, s[4:7], s26 offen sc1
    buffer_store_dwordx2 v[140:141], v5, s[4:7], s27 offen sc1
    s_branch L_back_142
L_slow_143:
    buffer_store_dword v7, v6, s[4:7], s24 offen sc1
    s_branch L_back_144
L_gr_55:
    s_mov_b32 s37, s38
L_g_56:
    s_mov_b64 exec, vcc
    buffer_load_dwordx4 v[32:35], v5, s[4:7], s28 offen offset:0 sc1
    buffer_load_dwordx4 v[36:39], v5, s[4:7], s28 offen offset:1024 sc1
    buffer_load_dwordx4 v[40:43], v5, s[4:7], s28 offen offset:2048 sc1
    buffer_load_dwordx4 v[44:47], v5, s[4:7], s28 offen offset:3072 sc1
    s_sub_u32 s37, s37, 1
    s_cbranch_scc1 L_gx_57
    s_waitcnt vmcnt(0)
    v_max3_u32 v14, v32, v33, v34
    v_max_u32 v14, v14, v35
    v_max3_u32 v14, v14, v36, v37
    v_max3_u32 v14, v14, v38, v39
    v_max3_u32 v14, v14, v40, v41
    v_max3_u32 v14, v14, v42, v43
    v_max3_u32 v14, v14, v44, v45
    v_max3_u32 v14, v14, v46, v47
    v_cmp_eq_u32 vcc, -1, v14
    s_cbranch_vccnz L_g_56
L_gx_57:
    s_mov_b64 exec, -1
    s_cmp_lt_i32 s37, 0
    s_cselect_b32 s38, 4, s38
    v_mfma_f32_16x16x32_bf16 v[48:51], v[20:23], v[32:35], 0
    v_mfma_f32_16x16x32_bf16 v[48:51], v[20:23], v[36:39], v[48:51]
    v_mfma_f32_16x16x32_bf16 v[48:51], v[20:23], v[40:43], v[48:51]
    v_mfma_f32_16x16x32_bf16 v[48:51], v[20:23], v[44:47], v[48:51]
    s_nop 1
    s_branch L_gd_58
L_gr_66:
    s_mov_b32 s37, s38
L_g_67:
    s_mov_b64 exec, vcc
    buffer_load_dwordx4 v[56:59], v8, s[4:7], s24 offen offset:0 sc1
    buffer_load_dwordx4 v[72:75], v8, s[4:7], s25 offen offset:0 sc1
    buffer_load_dwordx4 v[88:91], v8, s[4:7], s26 offen offset:0 sc1
    s_sub_u32 s37, s37, 1
    s_cbranch_scc1 L_gx_68
    s_waitcnt vmcnt(6)
    v_max3_u32 v11, v56, v57, v58
    v_max_u32 v11, v11, v59
    v_max3_u32 v11, v11, v72, v73
    v_max3_u32 v11, v11, v74, v75
    v_max3_u32 v11, v11, v88, v89
    v_max3_u32 v11, v11, v90, v91
    v_cmp_eq_u32 vcc, -1, v11
    s_cbranch_vccnz L_g_67
L_gx_68:
    s_mov_b64 exec, -1
    s_cmp_lt_i32 s37, 0
    s_cselect_b32 s38, 4, s38
    s_branch L_gd_69
L_gr_70:
    s_mov_b32 s37, s38
L_g_71:
    s_mov_b64 exec, vcc
    buffer_load_dwordx4 v[60:63], v8, s[4:7], s24 offen offset:0 sc1
    buffer_load_dwordx4 v[76:79], v8, s[4:7], s25 offen offset:0 sc1
    buffer_load_dwordx4 v[92:95], v8, s[4:7], s26 offen offset:0 sc1
    s_sub_u32 s37, s37, 1
    s_cbranch_scc1 L_gx_72
    s_waitcnt vmcnt(6)
    v_max3_u32 v11, v60, v61, v62
    v_max_u32 v11, v11, v63
    v_max3_u32 v11, v11, v76, v77
    v_max3_u32 v11, v11, v78, v79
    v_max3_u32 v11, v11, v92, v93
    v_max3_u32 v11, v11, v94, v95
    v_cmp_eq_u32 vcc, -1, v11
    s_cbranch_vccnz L_g_71
L_gx_72:
    s_mov_b64 exec, -1
    s_cmp_lt_i32 s37, 0
    s_cselect_b32 s38, 4, s38
    s_branch L_gd_73
L_gr_74:
    s_mov_b32 s37, s38
L_g_75:
    s_mov_b64 exec, vcc
    buffer_load_dwordx4 v[64:67], v8, s[4:7], s24 offen offset:0 sc1
    buffer_load_dwordx4 v[80:83], v8, s[4:7], s25 offen offset:0 sc1
    s_sub_u32 s37, s37, 1
    s_cbranch_scc1 L_gx_76
    s_waitcnt vmcnt(4)
    v_max3_u32 v11, v64, v65, v66
    v_max_u32 v11, v11, v67
    v_max3_u32 v11, v11, v80, v81
    v_max3_u32 v11, v11, v82, v83
    v_cmp_eq_u32 vcc, -1, v11
    s_cbranch_vccnz L_g_75
L_gx_76:
    s_mov_b64 exec, -1
    s_cmp_lt_i32 s37, 0
    s_cselect_b32 s38, 4, s38
    s_branch L_gd_77
L_gr_78:
    s_mov_b32 s37, s38
L_g_79:
    s_mov_b64 exec, vcc
    buffer_load_dwordx4 v[68:71], v8, s[4:7], s24 offen offset:0 sc1
    buffer_load_dwordx4 v[84:87], v8, s[4:7], s25 offen offset:0 sc1
    s_sub_u32 s37, s37, 1
    s_cbranch_scc1 L_gx_80
    s_waitcnt vmcnt(4)
    v_max3_u32 v11, v68, v69, v70
    v_max_u32 v11, v11, v71
    v_max3_u32 v11, v11, v84, v85
    v_max3_u32 v11, v11, v86, v87
    v_cmp_eq_u32 vcc, -1, v11
    s_cbranch_vccnz L_g_79
L_gx_80:
    s_mov_b64 exec, -1
    s_cmp_lt_i32 s37, 0
    s_cselect_b32 s38, 4, s38
    s_branch L_gd_81
L_gr_87:
    s_mov_b32 s37, s38
L_g_88:
    s_mov_b64 exec, vcc
    buffer_load_dwordx4 v[44:47], v8, s[4:7], s24 offen offset:3072 sc1
    buffer_load_dwordx4 v[32:35], v5, s[4:7], s24 offen offset:0 sc1
    buffer_load_dwordx4 v[36:39], v5, s[4:7], s24 offen offset:1024 sc1
    buffer_load_dwordx4 v[40:43], v5, s[4:7], s24 offen offset:2048 sc1
    s_sub_u32 s37, s37, 1
    s_cbranch_scc1 L_gx_89
    s_waitcnt vmcnt(8)
    v_max3_u32 v12, v44, v45, v46
    v_max_u32 v12, v12, v47
    v_max3_u32 v12, v12, v32, v33
    v_max3_u32 v12, v12, v34, v35
    v_max3_u32 v12, v12, v36, v37
    v_max3_u32 v12, v12, v38, v39
    v_max3_u32 v12, v12, v40, v41
    v_max3_u32 v12, v12, v42, v43
    v_cmp_eq_u32 vcc, -1, v12
    s_cbranch_vccnz L_g_88
L_gx_89:
    s_mov_b64 exec, -1
    s_cmp_lt_i32 s37, 0
    s_cselect_b32 s38, 4, s38
    v_mfma_f32_16x16x32_bf16 v[56:59], v[16:19], v[44:47], 0
    v_mfma_f32_16x16x32_bf16 v[48:51], v[20:23], v[32:35], 0
    v_mfma_f32_16x16x32_bf16 v[52:55], v[20:23], v[36:39], 0
    v_mfma_f32_16x16x32_bf16 v[48:51], v[24:27], v[40:43], v[48:51]
    v_mfma_f32_16x16x32_bf16 v[52:55], v[28:31], v[40:43], v[52:55]
    s_nop 1
    s_branch L_gd_90
LV_ys0:
    s_mov_b32 s37, s38
L_lw_91:
    ds_read_b128 v[116:119], v123 offset:48
    ds_read_b64 v[84:85], v10 offset:0
    ds_read_b64 v[86:87], v10 offset:512
    s_sub_u32 s37, s37, 1
    s_cbranch_scc1 L_lwd_92
    s_waitcnt lgkmcnt(0)
    v_min3_u32 v116, v116, v117, v118
    v_min_u32 v116, v116, v119
    v_cmp_gt_u32 vcc, s27, v116
    s_cbranch_vccnz L_lw_91
L_lwd_92:
    s_branch LV_yb0
L_gr_99:
    s_mov_b32 s37, s38
L_g_100:
    s_mov_b64 exec, vcc
    buffer_load_dwordx4 v[44:47], v8, s[4:7], s24 offen offset:3072 sc1
    buffer_load_dwordx4 v[32:35], v5, s[4:7], s24 offen offset:0 sc1
    buffer_load_dwordx4 v[36:39], v5, s[4:7], s24 offen offset:1024 sc1
    buffer_load_dwordx4 v[40:43], v5, s[4:7], s24 offen offset:2048 sc1
    s_sub_u32 s37, s37, 1
    s_cbranch_scc1 L_gx_101
    s_waitcnt vmcnt(8)
    v_max3_u32 v12, v44, v45, v46
    v_max_u32 v12, v12, v47
    v_max3_u32 v12, v12, v32, v33
    v_max3_u32 v12, v12, v34, v35
    v_max3_u32 v12, v12, v36, v37
    v_max3_u32 v12, v12, v38, v39
    v_max3_u32 v12, v12, v40, v41
    v_max3_u32 v12, v12, v42, v43
    v_cmp_eq_u32 vcc, -1, v12
    s_cbranch_vccnz L_g_100
L_gx_101:
    s_mov_b64 exec, -1
    s_cmp_lt_i32 s37, 0
    s_cselect_b32 s38, 4, s38
    v_mfma_f32_16x16x32_bf16 v[56:59], v[16:19], v[44:47], 0
    v_mfma_f32_16x16x32_bf16 v[48:51], v[20:23], v[32:35], 0
    v_mfma_f32_16x16x32_bf16 v[52:55], v[20:23], v[36:39], 0
    v_mfma_f32_16x16x32_bf16 v[48:51], v[24:27], v[40:43], v[48:51]
    v_mfma_f32_16x16x32_bf16 v[52:55], v[28:31], v[40:43], v[52:55]
    s_nop 1
    s_branch L_gd_102
LV_ys1:
    s_mov_b32 s37, s38
L_lw_103:
    ds_read_b128 v[116:119], v123 offset:48
    ds_read_b64 v[84:85], v10 offset:0
    ds_read_b64 v[86:87], v10 offset:512
    s_sub_u32 s37, s37, 1
    s_cbranch_scc1 L_lwd_104
    s_waitcnt lgkmcnt(0)
    v_min3_u32 v116, v116, v117, v118
    v_min_u32 v116, v116, v119
    v_cmp_gt_u32 vcc, s27, v116
    s_cbranch_vccnz L_lw_103
L_lwd_104:
    s_branch LV_yb1
L_gr_106:
    s_mov_b32 s37, s38
L_g_107:
    s_mov_b64 exec, vcc
    buffer_load_dwordx4 v[132:135], v5, s[4:7], s34 offen offset:0 sc1
    buffer_load_dwordx4 v[136:139], v5, s[4:7], s34 offen offset:1024 sc1
    buffer_load_dwordx4 v[140:143], v5, s[4:7], s34 offen offset:2048 sc1
    buffer_load_dwordx4 v[144:147], v5, s[4:7], s34 offen offset:3072 sc1
    s_sub_u32 s37, s37, 1
    s_cbranch_scc1 L_gx_108
    s_waitcnt vmcnt(4)
    v_max3_u32 v12, v132, v133, v134
    v_max_u32 v12, v12, v135
    v_max3_u32 v12, v12, v136, v137
    v_max3_u32 v12, v12, v138, v139
    v_max3_u32 v12, v12, v140, v141
    v_max3_u32 v12, v12, v142, v143
    v_max3_u32 v12, v12, v144, v145
    v_max3_u32 v12, v12, v146, v147
    v_cmp_eq_u32 vcc, -1, v12
    s_cbranch_vccnz L_g_107
L_gx_108:
    s_mov_b64 exec, -1
    s_cmp_lt_i32 s37, 0
    s_cselect_b32 s38, 4, s38
    v_mfma_f32_16x16x32_bf16 v[48:51], v[20:23], v[132:135], 0
    v_mfma_f32_16x16x32_bf16 v[48:51], v[20:23], v[136:139], v[48:51]
    v_mfma_f32_16x16x32_bf16 v[48:51], v[20:23], v[140:143], v[48:51]
    v_mfma_f32_16x16x32_bf16 v[48:51], v[20:23], v[144:147], v[48:51]
    s_nop 1
    s_branch L_gd_109
L_gr_133:
    s_mov_b32 s37, s38
L_g_134:
    s_mov_b64 exec, vcc
    s_sleep 2
    buffer_load_dwordx4 v[16:19], v5, s[4:7], s24 offen offset:0 sc1
    buffer_load_dwordx4 v[20:23], v5, s[4:7], s24 offen offset:1024 sc1
    buffer_load_dwordx4 v[24:27], v5, s[4:7], s24 offen offset:2048 sc1
    buffer_load_dwordx4 v[28:31], v5, s[4:7], s24 offen offset:3072 sc1
    buffer_load_dwordx4 v[32:35], v5, s[4:7], s25 offen offset:0 sc1
    buffer_load_dwordx4 v[36:39], v5, s[4:7], s25 offen offset:1024 sc1
    buffer_load_dwordx4 v[40:43], v5, s[4:7], s25 offen offset:2048 sc1
    buffer_load_dwordx4 v[44:47], v5, s[4:7], s25 offen offset:3072 sc1
    buffer_load_dwordx4 v[48:51], v5, s[4:7], s26 offen offset:0 sc1
    buffer_load_dwordx4 v[52:55], v5, s[4:7], s26 offen offset:1024 sc1
    buffer_load_dwordx4 v[56:59], v5, s[4:7], s26 offen offset:2048 sc1
    buffer_load_dwordx4 v[60:63], v5, s[4:7], s26 offen offset:3072 sc1
    buffer_load_dwordx4 v[64:67], v5, s[4:7], s27 offen offset:0 sc1
    buffer_load_dwordx4 v[68:71], v5, s[4:7], s27 offen offset:1024 sc1
    buffer_load_dwordx4 v[72:75], v5, s[4:7], s27 offen offset:2048 sc1
    buffer_load_dwordx4 v[76:79], v5, s[4:7], s27 offen offset:3072 sc1
    buffer_load_dwordx4 v[80:83], v5, s[4:7], s28 offen offset:0 sc1
    buffer_load_dwordx4 v[84:87], v5, s[4:7], s28 offen offset:1024 sc1
    buffer_load_dwordx4 v[88:91], v5, s[4:7], s28 offen offset:2048 sc1
    buffer_load_dwordx4 v[92:95], v5, s[4:7], s28 offen offset:3072 sc1
    s_sub_u32 s37, s37, 1
    s_cbranch_scc1 L_gx_135
    s_waitcnt vmcnt(0)
    v_max3_u32 v12, v16, v17, v18
    v_max_u32 v12, v12, v19
    v_max3_u32 v12, v12, v20, v21
    v_max3_u32 v12, v12, v22, v23
    v_max3_u32 v12, v12, v24, v25
    v_max3_u32 v12, v12, v26, v27
    v_max3_u32 v12, v12, v28, v29
    v_max3_u32 v12, v12, v30, v31
    v_max3_u32 v12, v12, v32, v33
    v_max3_u32 v12, v12, v34, v35
    v_max3_u32 v12, v12, v36, v37
    v_max3_u32 v12, v12, v38, v39
    v_max3_u32 v12, v12, v40, v41
    v_max3_u32 v12, v12, v42, v43
    v_max3_u32 v12, v12, v44, v45
    v_max3_u32 v12, v12, v46, v47
    v_max3_u32 v12, v12, v48, v49
    v_max3_u32 v12, v12, v50, v51
    v_max3_u32 v12, v12, v52, v53
    v_max3_u32 v12, v12, v54, v55
    v_max3_u32 v12, v12, v56, v57
    v_max3_u32 v12, v12, v58, v59
    v_max3_u32 v12, v12, v60, v61
    v_max3_u32 v12, v12, v62, v63
    v_max3_u32 v12, v12, v64, v65
    v_max3_u32 v12, v12, v66, v67
    v_max3_u32 v12, v12, v68, v69
    v_max3_u32 v12, v12, v70, v71
    v_max3_u32 v12, v12, v72, v73
    v_max3_u32 v12, v12, v74, v75
    v_max3_u32 v12, v12, v76, v77
    v_max3_u32 v12, v12, v78, v79
    v_max3_u32 v12, v12, v80, v81
    v_max3_u32 v12, v12, v82, v83
    v_max3_u32 v12, v12, v84, v85
    v_max3_u32 v12, v12, v86, v87
    v_max3_u32 v12, v12, v88, v89
    v_max3_u32 v12, v12, v90, v91
    v_max3_u32 v12, v12, v92, v93
    v_max3_u32 v12, v12, v94, v95
    v_cmp_eq_u32 vcc, -1, v12
    s_cbranch_vccnz L_g_134
L_gx_135:
    s_mov_b64 exec, -1
    s_cmp_lt_i32 s37, 0
    s_cselect_b32 s38, 4, s38
    v_mfma_f32_16x16x32_bf16 v[144:147], v[152:155], v[16:19], 0
    v_mfma_f32_16x16x32_bf16 v[148:151], v[16:19], v[16:19], 0
    v_mfma_f32_16x16x32_bf16 v[144:147], v[152:155], v[20:23], v[144:147]
    v_mfma_f32_16x16x32_bf16 v[148:151], v[20:23], v[20:23], v[148:151]
    v_mfma_f32_16x16x32_bf16 v[144:147], v[152:155], v[24:27], v[144:147]
    v_mfma_f32_16x16x32_bf16 v[148:151], v[24:27], v[24:27], v[148:151]
    v_mfma_f32_16x16x32_bf16 v[144:147], v[152:155], v[28:31], v[144:147]
    v_mfma_f32_16x16x32_bf16 v[148:151], v[28:31], v[28:31], v[148:151]
    v_mfma_f32_16x16x32_bf16 v[144:147], v[152:155], v[32:35], v[144:147]
    v_mfma_f32_16x16x32_bf16 v[148:151], v[32:35], v[32:35], v[148:151]
    v_mfma_f32_16x16x32_bf16 v[144:147], v[152:155], v[36:39], v[144:147]
    v_mfma_f32_16x16x32_bf16 v[148:151], v[36:39], v[36:39], v[148:151]
    v_mfma_f32_16x16x32_bf16 v[144:147], v[152:155], v[40:43], v[144:147]
    v_mfma_f32_16x16x32_bf16 v[148:151], v[40:43], v[40:43], v[148:151]
    v_mfma_f32_16x16x32_bf16 v[144:147], v[152:155], v[44:47], v[144:147]
    v_mfma_f32_16x16x32_bf16 v[148:151], v[44:47], v[44:47], v[148:151]
    v_mfma_f32_16x16x32_bf16 v[144:147], v[152:155], v[48:51], v[144:147]
    v_mfma_f32_16x16x32_bf16 v[148:151], v[48:51], v[48:51], v[148:151]
    v_mfma_f32_16x16x32_bf16 v[144:147], v[152:155], v[52:55], v[144:147]
    v_mfma_f32_16x16x32_bf16 v[148:151], v[52:55], v[52:55], v[148:151]
    v_mfma_f32_16x16x32_bf16 v[144:147], v[152:155], v[56:59], v[144:147]
    v_mfma_f32_16x16x32_bf16 v[148:151], v[56:59], v[56:59], v[148:151]
    v_mfma_f32_16x16x32_bf16 v[144:147], v[152:155], v[60:63], v[144:147]
    v_mfma_f32_16x16x32_bf16 v[148:151], v[60:63], v[60:63], v[148:151]
    v_mfma_f32_16x16x32_bf16 v[144:147], v[152:155], v[64:67], v[144:147]
    v_mfma_f32_16x16x32_bf16 v[148:151], v[64:67], v[64:67], v[148:151]
    v_mfma_f32_16x16x32_bf16 v[144:147], v[152:155], v[68:71], v[144:147]
    v_mfma_f32_16x16x32_bf16 v[148:151], v[68:71], v[68:71], v[148:151]
    v_mfma_f32_16x16x32_bf16 v[144:147], v[152:155], v[72:75], v[144:147]
    v_mfma_f32_16x16x32_bf16 v[148:151], v[72:75], v[72:75], v[148:151]
    v_mfma_f32_16x16x32_bf16 v[144:147], v[152:155], v[76:79], v[144:147]
    v_mfma_f32_16x16x32_bf16 v[148:151], v[76:79], v[76:79], v[148:151]
    v_mfma_f32_16x16x32_bf16 v[144:147], v[152:155], v[80:83], v[144:147]
    v_mfma_f32_16x16x32_bf16 v[148:151], v[80:83], v[80:83], v[148:151]
    v_mfma_f32_16x16x32_bf16 v[144:147], v[152:155], v[84:87], v[144:147]
    v_mfma_f32_16x16x32_bf16 v[148:151], v[84:87], v[84:87], v[148:151]
    v_mfma_f32_16x16x32_bf16 v[144:147], v[152:155], v[88:91], v[144:147]
    v_mfma_f32_16x16x32_bf16 v[148:151], v[88:91], v[88:91], v[148:151]
    v_mfma_f32_16x16x32_bf16 v[144:147], v[152:155], v[92:95], v[144:147]
    v_mfma_f32_16x16x32_bf16 v[148:151], v[92:95], v[92:95], v[148:151]
    s_nop 1
    s_branch L_gd_136
LM_codeend:
    s_endpgm
.section .rodata,"a"
.p2align 6
.amdhsa_kernel adaLN_cond__memory_aug_recurrent_mem_tr__dense_activation_gelu__prompt_kernel
  .amdhsa_next_free_vgpr 256
  .amdhsa_next_free_sgpr 100
  .amdhsa_accum_offset 256
  .amdhsa_group_segment_fixed_size 0
  .amdhsa_kernarg_size 136
  .amdhsa_user_sgpr_count 2
  .amdhsa_user_sgpr_kernarg_segment_ptr 1
  .amdhsa_system_sgpr_workgroup_id_x 1
.end_amdhsa_kernel
```
